```python
import torch

def _softmax(x, axis=-1):
    return torch.softmax(x, dim=axis)
def _gelu(x):
    return torch.nn.functional.gelu(x, approximate="tanh")
def _silu(x):
    return torch.nn.functional.silu(x)
def _sigmoid(x):
    return torch.sigmoid(x)
def _layernorm(x, axis=-1, eps=1e-5):
    m = x.mean(dim=axis, keepdim=True)
    v = x.var(dim=axis, keepdim=True, unbiased=False)
    return (x - m) / torch.sqrt(v + eps)
def _scatter_add(tgt, idx, src, axis=0):
    return tgt.clone().index_add_(axis, idx, src)
def _segment_sum(src, seg, n):
    out = torch.zeros((n,) + src.shape[1:], dtype=src.dtype)
    return out.index_add_(0, seg, src)
def _pad(x, pw):
    flat = tuple(v for pair in reversed(pw) for v in pair)
    return torch.nn.functional.pad(x, flat)

kernel_name = 'parallel_sum__linear_attn_block__dense_activation_relu__prompt'

def setup_inputs():

    _w = (lambda a: (lambda t: t.to(torch.bfloat16) if t.is_floating_point() else t)(torch.as_tensor(a)))
    def _A_setup():
        B, S, D = 1, 2048, 640
        return {
            "x": _w((lambda *s: torch.randn(*s, dtype=torch.bfloat16) * 0.05)(B, S, D)),
            "wqkv": _w((lambda *s: torch.randn(*s, dtype=torch.bfloat16) * 0.2)(D, 3 * D)),
            "wo": _w((lambda *s: torch.randn(*s, dtype=torch.bfloat16) * 0.2)(D, D)),
        }
    _A_in = _A_setup()

    def _B_setup():
        B, S, D, Dff = 1, 2048, 640, 1536
        return {
            "x": _w((lambda *s: torch.randn(*s, dtype=torch.bfloat16) * 0.05)(B, S, D)),
            "w1": _w((lambda *s: torch.randn(*s, dtype=torch.bfloat16) * 0.05)(D, Dff)),
            "w2": _w((lambda *s: torch.randn(*s, dtype=torch.bfloat16) * 0.05)(Dff, D)),
        }
    _B_in = _B_setup()

    return {
        "A_x": _A_in["x"],
        "A_wqkv": _A_in["wqkv"],
        "A_wo": _A_in["wo"],
        "B_x": _B_in["x"],
        "B_w1": _B_in["w1"],
        "B_w2": _B_in["w2"],
    }

def reference(A_x, A_wqkv, A_wo, B_x, B_w1, B_w2):
    def _A_ref(x, wqkv, wo):
        B, S, D = x.shape
        H = 32; Dh = D // H
        qkv = (lambda x, *d: x.permute(*d))((x @ wqkv).reshape(B, S, 3, H, Dh), 2, 0, 3, 1, 4)
        q, k, v = qkv[0], qkv[1], qkv[2]
        phi = lambda t: torch.where(t > 0, t + 1, torch.exp(t)) + 1e-6
        pq, pk = phi(q), phi(k)
        kv = torch.einsum("bhsd,bhse->bhde", pk, v)
        z = torch.einsum("bhsd->bhd", pk)
        num = torch.einsum("bhqd,bhde->bhqe", pq, kv)
        den = torch.einsum("bhqd,bhd->bhq", pq, z)[..., None] + 1e-6
        o = num / den
        return (lambda x, *d: x.permute(*d))(o, 0, 2, 1, 3).reshape(B, S, D) @ wo

    def _B_ref(x, w1, w2):
        h = torch.einsum("bsd,df->bsf", x, w1)
        zero = torch.zeros_like(h)
        h = torch.maximum(h, zero)
        return torch.einsum("bsf,fd->bsd", h, w2)

    x = A_x
    xn = _layernorm(x, axis=-1)
    return x + _A_ref(xn, A_wqkv, A_wo) + _B_ref(xn, B_w1, B_w2)
```

```asm
; @launch grid=(256,1,1) block=(512,1,1) lds=163840
.amdgcn_target "amdgcn-amd-amdhsa--gfx950"
.text
.globl parallel_sum__linear_attn_block__dense_activation_relu__prompt_kernel
.p2align 8
.type parallel_sum__linear_attn_block__dense_activation_relu__prompt_kernel,@function
parallel_sum__linear_attn_block__dense_activation_relu__prompt_kernel:
    s_load_dwordx4 s[44:47], s[0:1], 0
    s_load_dwordx2 s[48:49], s[0:1], 16
    s_load_dwordx4 s[52:55], s[0:1], 32
    s_load_dwordx2 s[50:51], s[0:1], 48
    s_load_dwordx2 s[56:57], s[0:1], 56
    s_load_dwordx2 s[58:59], s[0:1], 64
    s_cmp_ge_u32 s2, 256
    s_cbranch_scc1 L_exit
    v_and_b32 v1, 63, v0
    v_lshrrev_b32 v10, 6, v0
    v_lshrrev_b32 v2, 5, v1
    v_readfirstlane_b32 s42, v10
    v_and_b32 v3, 31, v1
    v_lshlrev_b32 v3, 2, v3
    s_and_b32 s39, s2, 1
    s_lshl_b32 s39, s39, 3
    s_bfe_u32 s41, s2, 0x30003
    s_add_u32 s37, s39, s41
    s_bfe_u32 s39, s2, 0x20001
    s_lshl_b32 s39, s39, 2
    s_lshr_b32 s40, s2, 6
    s_add_u32 s88, s39, s40
    s_lshr_b32 s38, s88, 1
    s_and_b32 s39, s2, 7
    s_lshl_b32 s39, s39, 2
    s_bfe_u32 s89, s2, 0x20003
    s_add_u32 s89, s89, s39
    s_bfe_u32 s90, s2, 0x10005
    s_and_b32 s39, s88, 2
    s_or_b32 s90, s90, s39
    s_and_b32 s36, s42, 3
    s_lshr_b32 s80, s42, 2
    s_mul_i32 s83, s88, 3
    s_add_u32 s83, s83, s37
    s_mul_i32 s41, s83, 205
    s_lshr_b32 s41, s41, 11
    s_mul_i32 s41, s41, 10
    s_sub_u32 s83, s83, s41
    s_lshl_b32 s74, s37, 4
    s_add_u32 s74, s74, s88
    s_lshl_b32 s74, s74, 3
    s_add_u32 s74, s74, s42
    s_lshl_b32 s74, s74, 4
    s_add_u32 s74, s74, 13697024
    v_mov_b32 v10, 1073741824
    v_cmp_eq_u32 vcc, 0, v1
    v_lshlrev_b32 v5, 4, v1
    v_add_u32 v6, 4096, v5
    v_cndmask_b32 v4, v10, 0, vcc
    s_mov_b32 s81, 176
    s_mov_b32 s65, 0x35c1a2a0
    s_mov_b32 s66, 0x3f317218
    s_mov_b32 s67, 0xffff0000
    s_mov_b32 s70, 0
    s_mov_b32 s71, -1
    s_mov_b32 s72, 0xffff0000
    s_mov_b32 s73, 0xffff0000
    s_and_b32 s39, s88, 1
    s_lshl_b32 s39, s39, 2
    s_lshr_b32 s40, s42, 1
    s_add_u32 s39, s39, s40
    s_cmp_eq_u32 s39, 2
    s_cbranch_scc1 L_LKV
    s_cmp_eq_u32 s39, 6
    s_cbranch_scc1 L_LQ
    s_cmp_eq_u32 s39, 3
    s_cbranch_scc1 L_SKV
    s_cmp_eq_u32 s39, 7
    s_cbranch_scc1 L_SQ
    s_cmp_ge_u32 s39, 4
    s_cbranch_scc1 L_CQ
L_CKV:
    s_getpc_b64 s[32:33]
L_CKV_pc:
    s_mov_b32 s34, L_SKV_end-L_CKV_pc
    s_mov_b32 s35, 0x00020000
    v_lshlrev_b32 v10, 7, v0
    buffer_load_dword v255, v10, s[32:35], 0 offen
    v_mov_b32 v32, 0
    v_mov_b32 v33, 0
    v_mov_b32 v34, 0
    v_mov_b32 v35, 0
    s_mul_i32 s39, s37, 10
    s_add_u32 s39, s39, s83
    s_lshl_b32 s39, s39, 10
    s_add_u32 s39, s39, 13762560
    s_cmp_lt_u32 s88, 10
    s_cselect_b32 s39, s39, 1073741824
    s_mul_i32 s40, s88, 10
    s_add_u32 s40, s40, s83
    s_lshl_b32 s40, s40, 11
    s_add_u32 s40, s40, 12845056
    s_cmp_lt_u32 s37, 10
    s_cselect_b32 s40, s40, 1073741824
    s_cmp_eq_u32 s36, 0
    s_cselect_b32 s39, s39, 1073741824
    s_cselect_b32 s40, s40, 1073741824
    s_and_b32 s41, s74, 0xffffff80
    v_mov_b32 v11, 1073741824
    v_cmp_gt_u32 vcc, 8, v0
    s_lshl_b32 s42, s38, 13
    s_lshl_b32 s69, s37, 10
    s_add_u32 s42, s42, s69
    s_add_u32 s42, s42, 12582912
    s_cmp_lt_u32 s37, 7
    s_cselect_b32 s42, s42, 1073741824
    s_cmp_eq_u32 s36, 0
    s_cselect_b32 s42, s42, 1073741824
    v_cndmask_b32 v10, v11, v5, vcc
    s_waitcnt lgkmcnt(0)
    s_mov_b32 s20, s58
    s_mov_b32 s21, s59
    s_mov_b32 s22, 14680064
    s_mov_b32 s23, 0x00020000
    buffer_store_dwordx4 v[32:35], v10, s[20:23], s41 offen sc1
    buffer_store_dwordx4 v[32:35], v5, s[20:23], s39 offen sc1
    buffer_store_dwordx4 v[32:35], v5, s[20:23], s40 offen sc1
    buffer_store_dwordx4 v[32:35], v5, s[20:23], s42 offen sc1
    s_mov_b32 s8, s44
    s_mov_b32 s9, s45
    s_mov_b32 s10, 2621440
    s_mov_b32 s11, 0x00020000
    s_mov_b32 s84, s50
    s_mov_b32 s85, s51
    s_mov_b32 s86, 2621440
    s_mov_b32 s87, 0x00020000
    s_mov_b32 s24, s56
    s_mov_b32 s25, s57
    s_mov_b32 s26, 256
    s_mov_b32 s27, 0x00020000
    v_and_b32 v10, 31, v1
    v_bfe_u32 v11, v1, 1, 3
    v_xor_b32 v11, v11, v2
    s_lshl_b32 s39, s36, 12
    v_lshl_add_u32 v10, v10, 7, s39
    v_xor_b32 v12, 0, v11
    v_lshl_add_u32 v18, v12, 4, v10
    v_xor_b32 v12, 2, v11
    v_lshl_add_u32 v19, v12, 4, v10
    v_xor_b32 v12, 4, v11
    v_lshl_add_u32 v20, v12, 4, v10
    v_xor_b32 v12, 6, v11
    v_lshl_add_u32 v21, v12, 4, v10
    v_bfe_u32 v10, v1, 2, 2
    v_and_b32 v11, 3, v1
    v_lshlrev_b32 v11, 3, v11
    v_and_b32 v12, 16, v1
    v_lshl_add_u32 v11, v12, 1, v11
    v_lshl_add_u32 v12, v2, 3, v10
    v_mul_u32_u24 v22, 320, v12
    v_add_u32 v22, v22, v11
    v_add_u32 v22, 16384, v22
    v_and_b32 v10, 15, v1
    v_lshlrev_b32 v10, 4, v10
    v_lshl_add_u32 v10, v2, 8, v10
    v_and_b32 v11, 16, v1
    v_lshl_add_u32 v10, v11, 6, v10
    s_and_b32 s39, s36, 1
    s_lshl_b32 s39, s39, 11
    v_add_u32 v24, s39, v10
    s_lshr_b32 s39, s36, 1
    s_lshl_b32 s40, s37, 1
    s_add_u32 s39, s39, s40
    s_mul_i32 s68, s39, 278528
    v_mov_b32 v36, 0
    v_mov_b32 v37, 0
    v_mov_b32 v38, 0
    v_mov_b32 v39, 0
    v_mov_b32 v40, 0
    v_mov_b32 v41, 0
    v_mov_b32 v42, 0
    v_mov_b32 v43, 0
    v_mov_b32 v44, 0
    v_mov_b32 v45, 0
    v_mov_b32 v46, 0
    v_mov_b32 v47, 0
    v_mov_b32 v48, 0
    v_mov_b32 v49, 0
    v_mov_b32 v50, 0
    v_mov_b32 v51, 0
    v_mov_b32 v52, 0
    v_mov_b32 v53, 0
    v_mov_b32 v54, 0
    v_mov_b32 v55, 0
    v_mov_b32 v56, 0
    v_mov_b32 v57, 0
    v_mov_b32 v58, 0
    v_mov_b32 v59, 0
    v_mov_b32 v60, 0
    v_mov_b32 v61, 0
    v_mov_b32 v62, 0
    v_mov_b32 v63, 0
    v_mov_b32 v64, 0
    v_mov_b32 v65, 0
    v_mov_b32 v66, 0
    v_mov_b32 v67, 0
    v_mov_b32 v68, 0
    v_mov_b32 v69, 0
    v_mov_b32 v70, 0
    v_mov_b32 v71, 0
    v_mov_b32 v72, 0
    v_mov_b32 v73, 0
    v_mov_b32 v74, 0
    v_mov_b32 v75, 0
    v_mov_b32 v76, 0
    v_mov_b32 v77, 0
    v_mov_b32 v78, 0
    v_mov_b32 v79, 0
    v_mov_b32 v80, 0
    v_mov_b32 v81, 0
    v_mov_b32 v82, 0
    v_mov_b32 v83, 0
    v_mov_b32 v84, 0
    v_mov_b32 v85, 0
    v_mov_b32 v86, 0
    v_mov_b32 v87, 0
    v_mov_b32 v88, 0
    v_mov_b32 v89, 0
    v_mov_b32 v90, 0
    v_mov_b32 v91, 0
    v_mov_b32 v92, 0
    v_mov_b32 v93, 0
    v_mov_b32 v94, 0
    v_mov_b32 v95, 0
    v_mov_b32 v96, 0
    v_mov_b32 v97, 0
    v_mov_b32 v98, 0
    v_mov_b32 v99, 0
    v_mov_b32 v100, 0
    v_mov_b32 v101, 0
    v_mov_b32 v102, 0
    v_mov_b32 v103, 0
    v_mov_b32 v104, 0
    v_mov_b32 v105, 0
    v_mov_b32 v106, 0
    v_mov_b32 v107, 0
    v_mov_b32 v108, 0
    v_mov_b32 v109, 0
    v_mov_b32 v110, 0
    v_mov_b32 v111, 0
    v_mov_b32 v164, 0
    v_mov_b32 v165, 0
    v_mov_b32 v166, 0
    v_mov_b32 v167, 0
    v_mov_b32 v168, 0
    v_mov_b32 v169, 0
    v_mov_b32 v170, 0
    v_mov_b32 v171, 0
    v_mov_b32 v172, 0
    v_mov_b32 v173, 0
    v_mov_b32 v174, 0
    v_mov_b32 v175, 0
    v_mov_b32 v176, 0
    v_mov_b32 v177, 0
    v_mov_b32 v178, 0
    v_mov_b32 v179, 0
    v_mov_b32 v180, 0
    v_mov_b32 v181, 0
    v_mov_b32 v182, 0
    v_mov_b32 v183, 0
    v_mov_b32 v188, 0
    v_mov_b32 v189, 0
    v_mov_b32 v190, 0
    v_mov_b32 v191, 0
    v_mov_b32 v246, 0
    v_mov_b32 v247, 0
    v_lshlrev_b32 v25, 1, v3
    v_add_u32 v25, 159744, v25
    s_mul_i32 s39, s36, 768
    s_add_u32 s39, s39, 156672
    v_lshl_add_u32 v26, v3, 2, s39
    v_lshl_add_u32 v27, v2, 4, s39
    s_and_b32 s39, s2, 1
    s_lshl_b32 s39, s39, 7
    v_mov_b32 v10, s39
    v_mov_b32 v11, 1073741824
    v_cmp_eq_u32 vcc, 0, v0
    v_mov_b32 v12, 1
    s_nop 0
    v_cndmask_b32 v10, v11, v10, vcc
    s_waitcnt vmcnt(0)
    buffer_atomic_add v12, v10, s[24:27], 0 offen
    s_mov_b32 s93, 0
    s_mov_b32 s96, 0
    .p2align 3
L_CKV_p1:
    s_waitcnt lgkmcnt(0)
    s_barrier
    v_mfma_f32_32x32x16_bf16 v[32:47], v[188:191], v[164:167], v[32:47]
    ds_read_b128 v[184:187], v18
    ds_read_b64_tr_b16 v[144:145], v22 offset:0
    ds_read_b64_tr_b16 v[146:147], v22 offset:1280
    ds_read_b64_tr_b16 v[148:149], v22 offset:64
    v_mfma_f32_32x32x16_bf16 v[48:63], v[188:191], v[168:171], v[48:63]
    ds_read_b64_tr_b16 v[150:151], v22 offset:1344
    ds_read_b64_tr_b16 v[152:153], v22 offset:128
    ds_read_b64_tr_b16 v[154:155], v22 offset:1408
    ds_read_b64_tr_b16 v[156:157], v22 offset:192
    v_mfma_f32_32x32x16_bf16 v[64:79], v[188:191], v[172:175], v[64:79]
    ds_read_b64_tr_b16 v[158:159], v22 offset:1472
    ds_read_b64_tr_b16 v[160:161], v22 offset:256
    ds_read_b64_tr_b16 v[162:163], v22 offset:1536
    v_mfma_f32_32x32x16_bf16 v[80:95], v[188:191], v[176:179], v[80:95]
    v_mfma_f32_32x32x16_bf16 v[96:111], v[188:191], v[180:183], v[96:111]
    s_waitcnt lgkmcnt(0)
    v_mfma_f32_32x32x16_bf16 v[32:47], v[184:187], v[144:147], v[32:47]
    ds_read_b128 v[188:191], v19
    ds_read_b64_tr_b16 v[164:165], v22 offset:5120
    ds_read_b64_tr_b16 v[166:167], v22 offset:6400
    ds_read_b64_tr_b16 v[168:169], v22 offset:5184
    v_mfma_f32_32x32x16_bf16 v[48:63], v[184:187], v[148:151], v[48:63]
    ds_read_b64_tr_b16 v[170:171], v22 offset:6464
    ds_read_b64_tr_b16 v[172:173], v22 offset:5248
    ds_read_b64_tr_b16 v[174:175], v22 offset:6528
    ds_read_b64_tr_b16 v[176:177], v22 offset:5312
    v_mfma_f32_32x32x16_bf16 v[64:79], v[184:187], v[152:155], v[64:79]
    ds_read_b64_tr_b16 v[178:179], v22 offset:6592
    ds_read_b64_tr_b16 v[180:181], v22 offset:5376
    ds_read_b64_tr_b16 v[182:183], v22 offset:6656
    v_mfma_f32_32x32x16_bf16 v[80:95], v[184:187], v[156:159], v[80:95]
    v_mfma_f32_32x32x16_bf16 v[96:111], v[184:187], v[160:163], v[96:111]
    s_waitcnt lgkmcnt(0)
    v_mfma_f32_32x32x16_bf16 v[32:47], v[188:191], v[164:167], v[32:47]
    ds_read_b128 v[184:187], v20
    ds_read_b64_tr_b16 v[144:145], v22 offset:10240
    ds_read_b64_tr_b16 v[146:147], v22 offset:11520
    ds_read_b64_tr_b16 v[148:149], v22 offset:10304
    v_mfma_f32_32x32x16_bf16 v[48:63], v[188:191], v[168:171], v[48:63]
    ds_read_b64_tr_b16 v[150:151], v22 offset:11584
    ds_read_b64_tr_b16 v[152:153], v22 offset:10368
    ds_read_b64_tr_b16 v[154:155], v22 offset:11648
    ds_read_b64_tr_b16 v[156:157], v22 offset:10432
    v_mfma_f32_32x32x16_bf16 v[64:79], v[188:191], v[172:175], v[64:79]
    ds_read_b64_tr_b16 v[158:159], v22 offset:11712
    ds_read_b64_tr_b16 v[160:161], v22 offset:10496
    ds_read_b64_tr_b16 v[162:163], v22 offset:11776
    v_mfma_f32_32x32x16_bf16 v[80:95], v[188:191], v[176:179], v[80:95]
    v_mfma_f32_32x32x16_bf16 v[96:111], v[188:191], v[180:183], v[96:111]
    s_add_u32 s96, s96, 1
    s_cmp_eq_u32 s96, 3
    s_cselect_b32 s96, 0, s96
    s_mov_b32 s97, 45056
    s_cselect_b32 s97, 0xfffea000, s97
    s_add_u32 s93, s93, 1
    s_cmp_lt_u32 s93, 10
    s_waitcnt lgkmcnt(0)
    v_mfma_f32_32x32x16_bf16 v[32:47], v[184:187], v[144:147], v[32:47]
    ds_read_b128 v[188:191], v21
    ds_read_b64_tr_b16 v[164:165], v22 offset:15360
    ds_read_b64_tr_b16 v[166:167], v22 offset:16640
    ds_read_b64_tr_b16 v[168:169], v22 offset:15424
    v_mfma_f32_32x32x16_bf16 v[48:63], v[184:187], v[148:151], v[48:63]
    ds_read_b64_tr_b16 v[170:171], v22 offset:16704
    ds_read_b64_tr_b16 v[172:173], v22 offset:15488
    ds_read_b64_tr_b16 v[174:175], v22 offset:16768
    ds_read_b64_tr_b16 v[176:177], v22 offset:15552
    v_mfma_f32_32x32x16_bf16 v[64:79], v[184:187], v[152:155], v[64:79]
    ds_read_b64_tr_b16 v[178:179], v22 offset:16832
    ds_read_b64_tr_b16 v[180:181], v22 offset:15616
    ds_read_b64_tr_b16 v[182:183], v22 offset:16896
    v_mfma_f32_32x32x16_bf16 v[80:95], v[184:187], v[156:159], v[80:95]
    v_mfma_f32_32x32x16_bf16 v[96:111], v[184:187], v[160:163], v[96:111]
    v_add_u32 v18, s97, v18
    v_add_u32 v19, s97, v19
    v_add_u32 v20, s97, v20
    v_add_u32 v21, s97, v21
    v_add_u32 v22, s97, v22
    s_cbranch_scc1 L_CKV_p1
    s_waitcnt lgkmcnt(0)
    s_barrier
    ds_read_b128 v[248:251], v26
    ds_read_b64 v[204:205], v25 offset:768
    ds_read_b64 v[208:209], v25 offset:1024
    ds_read_b64 v[200:201], v25 offset:512
    ds_read_b64 v[192:193], v25 offset:0
    ds_read_b64 v[196:197], v25 offset:256
    ds_read_b128 v[128:131], v27 offset:640
    ds_read_b128 v[132:135], v27 offset:672
    ds_read_b128 v[136:139], v27 offset:704
    ds_read_b128 v[140:143], v27 offset:736
    ds_read_b128 v[112:115], v27 offset:512
    ds_read_b128 v[116:119], v27 offset:544
    ds_read_b128 v[120:123], v27 offset:576
    ds_read_b128 v[124:127], v27 offset:608
    v_mfma_f32_32x32x16_bf16 v[80:95], v[188:191], v[176:179], v[80:95]
    v_mov_b32 v206, 0
    v_mov_b32 v207, 0
    v_mov_b32 v210, 0
    v_mov_b32 v211, 0
    v_mov_b32 v202, 0
    v_mfma_f32_32x32x16_bf16 v[96:111], v[188:191], v[180:183], v[96:111]
    v_mov_b32 v203, 0
    v_mov_b32 v194, 0
    v_mov_b32 v195, 0
    v_mov_b32 v198, 0
    v_mov_b32 v199, 0
    v_mfma_f32_32x32x16_bf16 v[64:79], v[188:191], v[172:175], v[64:79]
    v_mfma_f32_32x32x16_bf16 v[32:47], v[188:191], v[164:167], v[32:47]
    v_mfma_f32_32x32x16_bf16 v[48:63], v[188:191], v[168:171], v[48:63]
    s_waitcnt lgkmcnt(8)
    v_lshrrev_b32 v14, 16, v248
    v_cndmask_b32 v244, v248, 0, s[70:71]
    v_cndmask_b32 v245, v14, 0, s[70:71]
    s_nop 1
    v_mfma_f32_32x32x16_bf16 v[80:95], v[244:247], v[204:207], v[80:95]
    v_mfma_f32_32x32x16_bf16 v[96:111], v[244:247], v[208:211], v[96:111]
    v_mfma_f32_32x32x16_bf16 v[64:79], v[244:247], v[200:203], v[64:79]
    v_mfma_f32_32x32x16_bf16 v[32:47], v[244:247], v[192:195], v[32:47]
    v_mfma_f32_32x32x16_bf16 v[48:63], v[244:247], v[196:199], v[48:63]
    v_mul_u32_u24 v28, 21, v2
    v_and_b32 v29, 31, v1
    v_cmp_eq_u32 vcc, 0, v29
    v_add_u32 v30, 20, v28
    v_add_u32 v28, v28, v29
    v_subrev_u32 v31, 12, v28
    v_cndmask_b32 v30, v31, v30, vcc
    v_add_u32 v29, v2, v29
    s_mul_i32 s39, s36, 6784
    s_add_u32 s39, s39, 0
    v_lshl_add_u32 v28, v28, 4, s39
    v_lshl_add_u32 v29, v29, 4, s39
    v_lshl_add_u32 v30, v30, 4, s39
    v_add_u32 v31, 28672, v5
    s_waitcnt lgkmcnt(0)
    v_mul_f32 v10, v80, v128
    v_mul_f32 v11, v81, v129
    v_mul_f32 v12, v82, v130
    v_mul_f32 v13, v83, v131
    v_cvt_pk_bf16_f32 v144, v10, v11
    v_cvt_pk_bf16_f32 v145, v12, v13
    v_mul_f32 v10, v84, v132
    v_mul_f32 v11, v85, v133
    v_mul_f32 v12, v86, v134
    v_mul_f32 v13, v87, v135
    v_cvt_pk_bf16_f32 v146, v10, v11
    v_cvt_pk_bf16_f32 v147, v12, v13
    v_mul_f32 v10, v88, v136
    v_mul_f32 v11, v89, v137
    v_mul_f32 v12, v90, v138
    v_mul_f32 v13, v91, v139
    v_cvt_pk_bf16_f32 v148, v10, v11
    v_cvt_pk_bf16_f32 v149, v12, v13
    v_mul_f32 v10, v92, v140
    v_mul_f32 v11, v93, v141
    v_mul_f32 v12, v94, v142
    v_mul_f32 v13, v95, v143
    v_cvt_pk_bf16_f32 v150, v10, v11
    v_cvt_pk_bf16_f32 v151, v12, v13
    v_mul_f32 v10, v96, v128
    v_mul_f32 v11, v97, v129
    v_mul_f32 v12, v98, v130
    v_mul_f32 v13, v99, v131
    v_cvt_pk_bf16_f32 v152, v10, v11
    v_cvt_pk_bf16_f32 v153, v12, v13
    v_mul_f32 v10, v100, v132
    v_mul_f32 v11, v101, v133
    v_mul_f32 v12, v102, v134
    v_mul_f32 v13, v103, v135
    v_cvt_pk_bf16_f32 v154, v10, v11
    v_cvt_pk_bf16_f32 v155, v12, v13
    v_mul_f32 v10, v104, v136
    v_mul_f32 v11, v105, v137
    v_mul_f32 v12, v106, v138
    v_mul_f32 v13, v107, v139
    v_cvt_pk_bf16_f32 v156, v10, v11
    v_cvt_pk_bf16_f32 v157, v12, v13
    v_mul_f32 v10, v108, v140
    v_mul_f32 v11, v109, v141
    v_mul_f32 v12, v110, v142
    v_mul_f32 v13, v111, v143
    v_cvt_pk_bf16_f32 v158, v10, v11
    v_cvt_pk_bf16_f32 v159, v12, v13
    v_mul_f32 v10, v64, v128
    v_mul_f32 v11, v65, v129
    v_mul_f32 v12, v66, v130
    v_mul_f32 v13, v67, v131
    v_cvt_pk_bf16_f32 v160, v10, v11
    v_cvt_pk_bf16_f32 v161, v12, v13
    v_mul_f32 v10, v68, v132
    v_mul_f32 v11, v69, v133
    v_mul_f32 v12, v70, v134
    v_mul_f32 v13, v71, v135
    v_cvt_pk_bf16_f32 v162, v10, v11
    v_cvt_pk_bf16_f32 v163, v12, v13
    v_mul_f32 v10, v72, v136
    v_mul_f32 v11, v73, v137
    v_mul_f32 v12, v74, v138
    v_mul_f32 v13, v75, v139
    v_cvt_pk_bf16_f32 v164, v10, v11
    v_cvt_pk_bf16_f32 v165, v12, v13
    v_mul_f32 v10, v76, v140
    v_mul_f32 v11, v77, v141
    v_mul_f32 v12, v78, v142
    v_mul_f32 v13, v79, v143
    v_cvt_pk_bf16_f32 v166, v10, v11
    v_cvt_pk_bf16_f32 v167, v12, v13
    v_mov_b32 v10, 0x3f803f80
    v_cndmask_b32 v160, v10, v160, s[72:73]
    v_cndmask_b32 v161, v10, v161, s[72:73]
    v_cndmask_b32 v162, v10, v162, s[72:73]
    v_cndmask_b32 v163, v10, v163, s[72:73]
    v_cndmask_b32 v164, v10, v164, s[72:73]
    v_cndmask_b32 v165, v10, v165, s[72:73]
    v_cndmask_b32 v166, v10, v166, s[72:73]
    v_cndmask_b32 v167, v10, v167, s[72:73]
    v_fma_f32 v10, v32, v112, s65
    v_fma_f32 v12, v33, v113, s65
    v_exp_f32 v11, v10 clamp
    v_exp_f32 v13, v12 clamp
    v_max_f32 v10, s65, v10
    v_max_f32 v12, s65, v12
    v_fma_f32 v10, v10, s66, v11
    v_fma_f32 v12, v12, s66, v13
    v_cvt_pk_bf16_f32 v168, v10, v12
    v_fma_f32 v10, v34, v114, s65
    v_fma_f32 v12, v35, v115, s65
    v_exp_f32 v11, v10 clamp
    v_exp_f32 v13, v12 clamp
    v_max_f32 v10, s65, v10
    v_max_f32 v12, s65, v12
    v_fma_f32 v10, v10, s66, v11
    v_fma_f32 v12, v12, s66, v13
    v_cvt_pk_bf16_f32 v169, v10, v12
    v_fma_f32 v10, v36, v116, s65
    v_fma_f32 v12, v37, v117, s65
    v_exp_f32 v11, v10 clamp
    v_exp_f32 v13, v12 clamp
    v_max_f32 v10, s65, v10
    v_max_f32 v12, s65, v12
    v_fma_f32 v10, v10, s66, v11
    v_fma_f32 v12, v12, s66, v13
    v_cvt_pk_bf16_f32 v170, v10, v12
    v_fma_f32 v10, v38, v118, s65
    v_fma_f32 v12, v39, v119, s65
    v_exp_f32 v11, v10 clamp
    v_exp_f32 v13, v12 clamp
    v_max_f32 v10, s65, v10
    v_max_f32 v12, s65, v12
    v_fma_f32 v10, v10, s66, v11
    v_fma_f32 v12, v12, s66, v13
    v_cvt_pk_bf16_f32 v171, v10, v12
    v_fma_f32 v10, v40, v120, s65
    v_fma_f32 v12, v41, v121, s65
    v_exp_f32 v11, v10 clamp
    v_exp_f32 v13, v12 clamp
    v_max_f32 v10, s65, v10
    v_max_f32 v12, s65, v12
    v_fma_f32 v10, v10, s66, v11
    v_fma_f32 v12, v12, s66, v13
    v_cvt_pk_bf16_f32 v172, v10, v12
    v_fma_f32 v10, v42, v122, s65
    v_fma_f32 v12, v43, v123, s65
    v_exp_f32 v11, v10 clamp
    v_exp_f32 v13, v12 clamp
    v_max_f32 v10, s65, v10
    v_max_f32 v12, s65, v12
    v_fma_f32 v10, v10, s66, v11
    v_fma_f32 v12, v12, s66, v13
    v_cvt_pk_bf16_f32 v173, v10, v12
    v_fma_f32 v10, v44, v124, s65
    v_fma_f32 v12, v45, v125, s65
    v_exp_f32 v11, v10 clamp
    v_exp_f32 v13, v12 clamp
    v_max_f32 v10, s65, v10
    v_max_f32 v12, s65, v12
    v_fma_f32 v10, v10, s66, v11
    v_fma_f32 v12, v12, s66, v13
    v_cvt_pk_bf16_f32 v174, v10, v12
    v_fma_f32 v10, v46, v126, s65
    v_fma_f32 v12, v47, v127, s65
    v_exp_f32 v11, v10 clamp
    v_exp_f32 v13, v12 clamp
    v_max_f32 v10, s65, v10
    v_max_f32 v12, s65, v12
    v_fma_f32 v10, v10, s66, v11
    v_fma_f32 v12, v12, s66, v13
    v_cvt_pk_bf16_f32 v175, v10, v12
    v_fma_f32 v10, v48, v112, s65
    v_fma_f32 v12, v49, v113, s65
    v_exp_f32 v11, v10 clamp
    v_exp_f32 v13, v12 clamp
    v_max_f32 v10, s65, v10
    v_max_f32 v12, s65, v12
    v_fma_f32 v10, v10, s66, v11
    v_fma_f32 v12, v12, s66, v13
    v_cvt_pk_bf16_f32 v176, v10, v12
    v_mfma_f32_32x32x16_bf16 v[80:95], v[168:171], v[144:147], 0
    v_mfma_f32_32x32x16_bf16 v[96:111], v[168:171], v[152:155], 0
    v_fma_f32 v10, v50, v114, s65
    v_fma_f32 v12, v51, v115, s65
    v_exp_f32 v11, v10 clamp
    v_exp_f32 v13, v12 clamp
    v_max_f32 v10, s65, v10
    v_max_f32 v12, s65, v12
    v_fma_f32 v10, v10, s66, v11
    v_fma_f32 v12, v12, s66, v13
    v_cvt_pk_bf16_f32 v177, v10, v12
    v_mfma_f32_32x32x16_bf16 v[128:143], v[168:171], v[160:163], 0
    v_mfma_f32_32x32x16_bf16 v[80:95], v[172:175], v[148:151], v[80:95]
    v_fma_f32 v10, v52, v116, s65
    v_fma_f32 v12, v53, v117, s65
    v_exp_f32 v11, v10 clamp
    v_exp_f32 v13, v12 clamp
    v_max_f32 v10, s65, v10
    v_max_f32 v12, s65, v12
    v_fma_f32 v10, v10, s66, v11
    v_fma_f32 v12, v12, s66, v13
    v_cvt_pk_bf16_f32 v178, v10, v12
    v_mfma_f32_32x32x16_bf16 v[96:111], v[172:175], v[156:159], v[96:111]
    v_mfma_f32_32x32x16_bf16 v[128:143], v[172:175], v[164:167], v[128:143]
    v_fma_f32 v10, v54, v118, s65
    v_fma_f32 v12, v55, v119, s65
    v_exp_f32 v11, v10 clamp
    v_exp_f32 v13, v12 clamp
    v_max_f32 v10, s65, v10
    v_max_f32 v12, s65, v12
    v_fma_f32 v10, v10, s66, v11
    v_fma_f32 v12, v12, s66, v13
    v_cvt_pk_bf16_f32 v179, v10, v12
    v_fma_f32 v10, v56, v120, s65
    v_fma_f32 v12, v57, v121, s65
    v_exp_f32 v11, v10 clamp
    v_exp_f32 v13, v12 clamp
    v_max_f32 v10, s65, v10
    v_max_f32 v12, s65, v12
    v_fma_f32 v10, v10, s66, v11
    v_fma_f32 v12, v12, s66, v13
    v_cvt_pk_bf16_f32 v180, v10, v12
    s_mov_b32 s94, 0xfffff
    s_mov_b32 s95, 0xfffff
    v_cndmask_b32 v16, v31, v28, s[94:95]
    ds_write_b128 v16, v[80:83] offset:0
    s_mov_b32 s94, 0xfffff
    s_mov_b32 s95, 0xfffff
    v_cndmask_b32 v17, v31, v28, s[94:95]
    ds_write_b128 v17, v[84:87] offset:672
    s_mov_b32 s94, 0xfffff
    s_mov_b32 s95, 0xfff00000
    v_cndmask_b32 v16, v31, v29, s[94:95]
    ds_write_b128 v16, v[88:91] offset:1344
    v_fma_f32 v10, v58, v122, s65
    v_fma_f32 v12, v59, v123, s65
    v_exp_f32 v11, v10 clamp
    v_exp_f32 v13, v12 clamp
    v_max_f32 v10, s65, v10
    v_max_f32 v12, s65, v12
    v_fma_f32 v10, v10, s66, v11
    v_fma_f32 v12, v12, s66, v13
    v_cvt_pk_bf16_f32 v181, v10, v12
    s_mov_b32 s94, 0xfff00000
    s_mov_b32 s95, 0xfff00000
    v_cndmask_b32 v17, v31, v28, s[94:95]
    ds_write_b128 v17, v[92:95] offset:1696
    s_mov_b32 s94, 0x0
    s_mov_b32 s95, 0xff
    v_cndmask_b32 v16, v31, v29, s[94:95]
    ds_write_b128 v16, v[104:107] offset:1856
    s_mov_b32 s94, 0xff
    s_mov_b32 s95, 0xff
    v_cndmask_b32 v17, v31, v28, s[94:95]
    ds_write_b128 v17, v[108:111] offset:2208
    v_fma_f32 v10, v60, v124, s65
    v_fma_f32 v12, v61, v125, s65
    v_exp_f32 v11, v10 clamp
    v_exp_f32 v13, v12 clamp
    v_max_f32 v10, s65, v10
    v_max_f32 v12, s65, v12
    v_fma_f32 v10, v10, s66, v11
    v_fma_f32 v12, v12, s66, v13
    v_cvt_pk_bf16_f32 v182, v10, v12
    s_mov_b32 s94, 0x1
    s_mov_b32 s95, 0x1
    v_cndmask_b32 v16, v31, v30, s[94:95]
    ds_write_b128 v16, v[128:131] offset:0
    s_mov_b32 s94, 0x1
    s_mov_b32 s95, 0x1
    v_cndmask_b32 v17, v31, v30, s[94:95]
    ds_write_b128 v17, v[132:135] offset:672
    v_fma_f32 v10, v62, v126, s65
    v_fma_f32 v12, v63, v127, s65
    v_exp_f32 v11, v10 clamp
    v_exp_f32 v13, v12 clamp
    v_max_f32 v10, s65, v10
    v_max_f32 v12, s65, v12
    v_fma_f32 v10, v10, s66, v11
    v_fma_f32 v12, v12, s66, v13
    v_cvt_pk_bf16_f32 v183, v10, v12
    s_mov_b32 s94, 0x1
    s_mov_b32 s95, 0x1
    v_cndmask_b32 v16, v31, v30, s[94:95]
    ds_write_b128 v16, v[136:139] offset:1344
    s_mov_b32 s94, 0x1
    s_mov_b32 s95, 0x1
    v_cndmask_b32 v17, v31, v30, s[94:95]
    ds_write_b128 v17, v[140:143] offset:2016
    v_fma_f32 v10, v64, v112, s65
    v_fma_f32 v12, v65, v113, s65
    v_exp_f32 v11, v10 clamp
    v_exp_f32 v13, v12 clamp
    v_max_f32 v10, s65, v10
    v_max_f32 v12, s65, v12
    v_fma_f32 v10, v10, s66, v11
    v_fma_f32 v12, v12, s66, v13
    v_cvt_pk_bf16_f32 v212, v10, v12
    v_mfma_f32_32x32x16_bf16 v[80:95], v[176:179], v[144:147], 0
    v_mfma_f32_32x32x16_bf16 v[96:111], v[176:179], v[152:155], 0
    v_fma_f32 v10, v66, v114, s65
    v_fma_f32 v12, v67, v115, s65
    v_exp_f32 v11, v10 clamp
    v_exp_f32 v13, v12 clamp
    v_max_f32 v10, s65, v10
    v_max_f32 v12, s65, v12
    v_fma_f32 v10, v10, s66, v11
    v_fma_f32 v12, v12, s66, v13
    v_cvt_pk_bf16_f32 v213, v10, v12
    v_mfma_f32_32x32x16_bf16 v[128:143], v[176:179], v[160:163], 0
    v_mfma_f32_32x32x16_bf16 v[80:95], v[180:183], v[148:151], v[80:95]
    v_fma_f32 v10, v68, v116, s65
    v_fma_f32 v12, v69, v117, s65
    v_exp_f32 v11, v10 clamp
    v_exp_f32 v13, v12 clamp
    v_max_f32 v10, s65, v10
    v_max_f32 v12, s65, v12
    v_fma_f32 v10, v10, s66, v11
    v_fma_f32 v12, v12, s66, v13
    v_cvt_pk_bf16_f32 v214, v10, v12
    v_mfma_f32_32x32x16_bf16 v[96:111], v[180:183], v[156:159], v[96:111]
    v_mfma_f32_32x32x16_bf16 v[128:143], v[180:183], v[164:167], v[128:143]
    v_fma_f32 v10, v70, v118, s65
    v_fma_f32 v12, v71, v119, s65
    v_exp_f32 v11, v10 clamp
    v_exp_f32 v13, v12 clamp
    v_max_f32 v10, s65, v10
    v_max_f32 v12, s65, v12
    v_fma_f32 v10, v10, s66, v11
    v_fma_f32 v12, v12, s66, v13
    v_cvt_pk_bf16_f32 v215, v10, v12
    v_fma_f32 v10, v72, v120, s65
    v_fma_f32 v12, v73, v121, s65
    v_exp_f32 v11, v10 clamp
    v_exp_f32 v13, v12 clamp
    v_max_f32 v10, s65, v10
    v_max_f32 v12, s65, v12
    v_fma_f32 v10, v10, s66, v11
    v_fma_f32 v12, v12, s66, v13
    v_cvt_pk_bf16_f32 v216, v10, v12
    s_mov_b32 s94, 0xfff00000
    s_mov_b32 s95, 0xfff00000
    v_cndmask_b32 v16, v31, v28, s[94:95]
    ds_write_b128 v16, v[80:83] offset:2368
    s_mov_b32 s94, 0xff
    s_mov_b32 s95, 0xff
    v_cndmask_b32 v16, v31, v28, s[94:95]
    ds_write_b128 v16, v[96:99] offset:2880
    s_mov_b32 s94, 0xfffff00
    s_mov_b32 s95, 0xfffff00
    v_cndmask_b32 v17, v31, v28, s[94:95]
    ds_write_b128 v17, v[100:103] offset:3232
    v_fma_f32 v10, v74, v122, s65
    v_fma_f32 v12, v75, v123, s65
    v_exp_f32 v11, v10 clamp
    v_exp_f32 v13, v12 clamp
    v_max_f32 v10, s65, v10
    v_max_f32 v12, s65, v12
    v_fma_f32 v10, v10, s66, v11
    v_fma_f32 v12, v12, s66, v13
    v_cvt_pk_bf16_f32 v217, v10, v12
    s_mov_b32 s94, 0xfffff00
    s_mov_b32 s95, 0xfffff00
    v_cndmask_b32 v16, v31, v28, s[94:95]
    ds_write_b128 v16, v[104:107] offset:3904
    s_mov_b32 s94, 0xfffff00
    s_mov_b32 s95, 0xf0000000
    v_cndmask_b32 v17, v31, v29, s[94:95]
    ds_write_b128 v17, v[108:111] offset:4576
    v_fma_f32 v10, v76, v124, s65
    v_fma_f32 v12, v77, v125, s65
    v_exp_f32 v11, v10 clamp
    v_exp_f32 v13, v12 clamp
    v_max_f32 v10, s65, v10
    v_max_f32 v12, s65, v12
    v_fma_f32 v10, v10, s66, v11
    v_fma_f32 v12, v12, s66, v13
    v_cvt_pk_bf16_f32 v218, v10, v12
    s_mov_b32 s94, 0x1
    s_mov_b32 s95, 0x1
    v_cndmask_b32 v16, v31, v30, s[94:95]
    ds_write_b128 v16, v[128:131] offset:2688
    s_mov_b32 s94, 0x1
    s_mov_b32 s95, 0x1
    v_cndmask_b32 v17, v31, v30, s[94:95]
    ds_write_b128 v17, v[132:135] offset:3360
    v_fma_f32 v10, v78, v126, s65
    v_fma_f32 v12, v79, v127, s65
    v_exp_f32 v11, v10 clamp
    v_exp_f32 v13, v12 clamp
    v_max_f32 v10, s65, v10
    v_max_f32 v12, s65, v12
    v_fma_f32 v10, v10, s66, v11
    v_fma_f32 v12, v12, s66, v13
    v_cvt_pk_bf16_f32 v219, v10, v12
    s_mov_b32 s94, 0x1
    s_mov_b32 s95, 0x1
    v_cndmask_b32 v16, v31, v30, s[94:95]
    ds_write_b128 v16, v[136:139] offset:4032
    s_mov_b32 s94, 0x1
    s_mov_b32 s95, 0xffff0001
    v_cndmask_b32 v17, v31, v30, s[94:95]
    ds_write_b128 v17, v[140:143] offset:4704
    s_nop 1
    v_mfma_f32_32x32x16_bf16 v[96:111], v[212:215], v[152:155], 0
    v_mfma_f32_32x32x16_bf16 v[128:143], v[212:215], v[160:163], 0
    v_mfma_f32_32x32x16_bf16 v[96:111], v[216:219], v[156:159], v[96:111]
    v_mfma_f32_32x32x16_bf16 v[128:143], v[216:219], v[164:167], v[128:143]
    s_nop 7
    s_nop 7
    s_mov_b32 s94, 0xf0000000
    s_mov_b32 s95, 0xf0000000
    v_cndmask_b32 v16, v31, v28, s[94:95]
    ds_write_b128 v16, v[96:99] offset:4928
    s_mov_b32 s94, 0xf0000000
    s_mov_b32 s95, 0xf0000000
    v_cndmask_b32 v17, v31, v28, s[94:95]
    ds_write_b128 v17, v[100:103] offset:5600
    s_mov_b32 s94, 0xffff0001
    s_mov_b32 s95, 0xffff0001
    v_cndmask_b32 v16, v31, v30, s[94:95]
    ds_write_b128 v16, v[128:131] offset:5376
    s_mov_b32 s94, 0xffff0001
    s_mov_b32 s95, 0xffff0001
    v_cndmask_b32 v17, v31, v30, s[94:95]
    ds_write_b128 v17, v[132:135] offset:6048
    s_waitcnt lgkmcnt(0)
    s_barrier
    s_lshl_b32 s39, s36, 10
    s_add_u32 s39, s39, 45056
    v_add_u32 v18, s39, v5
    v_add_u32 v19, 45056, v6
    s_waitcnt lgkmcnt(0)
    s_barrier
    ds_read_b128 v[64:67], v18 offset:0
    ds_read_b128 v[68:71], v19 offset:0
    ds_read_b128 v[72:75], v19 offset:1024
    ds_read_b128 v[76:79], v19 offset:2048
    ds_read_b128 v[80:83], v19 offset:3072
    ds_read_b128 v[84:87], v19 offset:4096
    ds_read_b128 v[88:91], v19 offset:5120
    ds_read_b128 v[92:95], v18 offset:10240
    ds_read_b128 v[96:99], v19 offset:10240
    ds_read_b128 v[100:103], v19 offset:11264
    ds_read_b128 v[104:107], v19 offset:12288
    ds_read_b128 v[108:111], v19 offset:13312
    ds_read_b128 v[112:115], v19 offset:14336
    ds_read_b128 v[116:119], v19 offset:15360
    s_lshl_b32 s39, s89, 6
    s_lshl_b32 s40, s36, 4
    s_add_u32 s39, s39, s40
    s_mul_i32 s41, s39, 1280
    s_mul_i32 s42, s90, 320
    s_add_u32 s41, s41, s42
    s_add_u32 s41, s41, 0
    s_lshl_b32 s76, s39, 2
    s_add_u32 s76, s76, 13631488
    s_mul_i32 s40, s36, 6400
    s_add_u32 s40, s40, 45056
    v_add_u32 v10, 0, v1
    v_mul_u32_u24 v11, 5462, v10
    v_lshrrev_b32 v11, 16, v11
    v_mul_u32_u24 v12, 12, v11
    v_sub_u32 v12, v10, v12
    v_mul_u32_u24 v13, 1280, v11
    v_lshl_add_u32 v13, v12, 4, v13
    v_add_u32 v192, s41, v13
    v_mul_u32_u24 v13, 400, v11
    v_lshl_add_u32 v13, v12, 5, v13
    v_add_u32 v196, s40, v13
    v_lshlrev_b32 v200, 2, v11
    v_add_u32 v10, 64, v1
    v_mul_u32_u24 v11, 5462, v10
    v_lshrrev_b32 v11, 16, v11
    v_mul_u32_u24 v12, 12, v11
    v_sub_u32 v12, v10, v12
    v_mul_u32_u24 v13, 1280, v11
    v_lshl_add_u32 v13, v12, 4, v13
    s_waitcnt lgkmcnt(0)
    ds_read_b128 v[120:123], v18 offset:20480
    ds_read_b128 v[124:127], v19 offset:20480
    v_mfma_f32_16x16x32_bf16 v[32:35], v[68:71], v[64:67], 0
    ds_read_b128 v[128:131], v19 offset:21504
    v_mfma_f32_16x16x32_bf16 v[36:39], v[72:75], v[64:67], 0
    ds_read_b128 v[132:135], v19 offset:22528
    v_mfma_f32_16x16x32_bf16 v[40:43], v[76:79], v[64:67], 0
    ds_read_b128 v[136:139], v19 offset:23552
    v_mfma_f32_16x16x32_bf16 v[44:47], v[80:83], v[64:67], 0
    ds_read_b128 v[140:143], v19 offset:24576
    v_mfma_f32_16x16x32_bf16 v[48:51], v[84:87], v[64:67], 0
    ds_read_b128 v[144:147], v19 offset:25600
    v_mfma_f32_16x16x32_bf16 v[52:55], v[88:91], v[64:67], 0
    ds_read_b128 v[148:151], v18 offset:30720
    v_mfma_f32_16x16x32_bf16 v[32:35], v[96:99], v[92:95], v[32:35]
    ds_read_b128 v[152:155], v19 offset:30720
    v_mfma_f32_16x16x32_bf16 v[36:39], v[100:103], v[92:95], v[36:39]
    ds_read_b128 v[156:159], v19 offset:31744
    v_mfma_f32_16x16x32_bf16 v[40:43], v[104:107], v[92:95], v[40:43]
    ds_read_b128 v[160:163], v19 offset:32768
    v_mfma_f32_16x16x32_bf16 v[44:47], v[108:111], v[92:95], v[44:47]
    ds_read_b128 v[164:167], v19 offset:33792
    v_mfma_f32_16x16x32_bf16 v[48:51], v[112:115], v[92:95], v[48:51]
    ds_read_b128 v[168:171], v19 offset:34816
    v_mfma_f32_16x16x32_bf16 v[52:55], v[116:119], v[92:95], v[52:55]
    ds_read_b128 v[172:175], v19 offset:35840
    v_add_u32 v193, s41, v13
    v_mul_u32_u24 v13, 400, v11
    v_lshl_add_u32 v13, v12, 5, v13
    v_add_u32 v197, s40, v13
    v_lshlrev_b32 v201, 2, v11
    v_add_u32 v10, 128, v1
    v_mul_u32_u24 v11, 5462, v10
    v_lshrrev_b32 v11, 16, v11
    v_mul_u32_u24 v12, 12, v11
    v_sub_u32 v12, v10, v12
    v_mul_u32_u24 v13, 1280, v11
    v_lshl_add_u32 v13, v12, 4, v13
    v_add_u32 v194, s41, v13
    v_mul_u32_u24 v13, 400, v11
    v_lshl_add_u32 v13, v12, 5, v13
    v_add_u32 v198, s40, v13
    v_lshlrev_b32 v202, 2, v11
    v_and_b32 v10, 15, v1
    v_mul_u32_u24 v10, 400, v10
    v_lshrrev_b32 v11, 4, v1
    v_lshl_add_u32 v10, v11, 4, v10
    v_add_u32 v208, s40, v10
    v_add_u32 v18, 0xb000, v18
    v_add_u32 v19, 0xb000, v19
    s_mov_b32 s93, 1
    s_mov_b32 s96, 1
    .p2align 3
L_CKV_g2:
    s_waitcnt lgkmcnt(0)
    s_barrier
    ds_read_b128 v[64:67], v18 offset:0
    ds_read_b128 v[68:71], v19 offset:0
    v_mfma_f32_16x16x32_bf16 v[32:35], v[124:127], v[120:123], v[32:35]
    ds_read_b128 v[72:75], v19 offset:1024
    v_mfma_f32_16x16x32_bf16 v[36:39], v[128:131], v[120:123], v[36:39]
    ds_read_b128 v[76:79], v19 offset:2048
    v_mfma_f32_16x16x32_bf16 v[40:43], v[132:135], v[120:123], v[40:43]
    ds_read_b128 v[80:83], v19 offset:3072
    v_mfma_f32_16x16x32_bf16 v[44:47], v[136:139], v[120:123], v[44:47]
    ds_read_b128 v[84:87], v19 offset:4096
    v_mfma_f32_16x16x32_bf16 v[48:51], v[140:143], v[120:123], v[48:51]
    ds_read_b128 v[88:91], v19 offset:5120
    v_mfma_f32_16x16x32_bf16 v[52:55], v[144:147], v[120:123], v[52:55]
    ds_read_b128 v[92:95], v18 offset:10240
    v_mfma_f32_16x16x32_bf16 v[32:35], v[152:155], v[148:151], v[32:35]
    ds_read_b128 v[96:99], v19 offset:10240
    v_mfma_f32_16x16x32_bf16 v[36:39], v[156:159], v[148:151], v[36:39]
    ds_read_b128 v[100:103], v19 offset:11264
    v_mfma_f32_16x16x32_bf16 v[40:43], v[160:163], v[148:151], v[40:43]
    ds_read_b128 v[104:107], v19 offset:12288
    v_mfma_f32_16x16x32_bf16 v[44:47], v[164:167], v[148:151], v[44:47]
    ds_read_b128 v[108:111], v19 offset:13312
    v_mfma_f32_16x16x32_bf16 v[48:51], v[168:171], v[148:151], v[48:51]
    ds_read_b128 v[112:115], v19 offset:14336
    v_mfma_f32_16x16x32_bf16 v[52:55], v[172:175], v[148:151], v[52:55]
    ds_read_b128 v[116:119], v19 offset:15360
    s_waitcnt lgkmcnt(7)
    ds_read_b128 v[120:123], v18 offset:20480
    ds_read_b128 v[124:127], v19 offset:20480
    v_mfma_f32_16x16x32_bf16 v[32:35], v[68:71], v[64:67], v[32:35]
    ds_read_b128 v[128:131], v19 offset:21504
    v_mfma_f32_16x16x32_bf16 v[36:39], v[72:75], v[64:67], v[36:39]
    ds_read_b128 v[132:135], v19 offset:22528
    v_mfma_f32_16x16x32_bf16 v[40:43], v[76:79], v[64:67], v[40:43]
    ds_read_b128 v[136:139], v19 offset:23552
    v_mfma_f32_16x16x32_bf16 v[44:47], v[80:83], v[64:67], v[44:47]
    ds_read_b128 v[140:143], v19 offset:24576
    v_mfma_f32_16x16x32_bf16 v[48:51], v[84:87], v[64:67], v[48:51]
    ds_read_b128 v[144:147], v19 offset:25600
    v_mfma_f32_16x16x32_bf16 v[52:55], v[88:91], v[64:67], v[52:55]
    ds_read_b128 v[148:151], v18 offset:30720
    s_waitcnt lgkmcnt(8)
    v_mfma_f32_16x16x32_bf16 v[32:35], v[96:99], v[92:95], v[32:35]
    ds_read_b128 v[152:155], v19 offset:30720
    v_mfma_f32_16x16x32_bf16 v[36:39], v[100:103], v[92:95], v[36:39]
    ds_read_b128 v[156:159], v19 offset:31744
    v_mfma_f32_16x16x32_bf16 v[40:43], v[104:107], v[92:95], v[40:43]
    ds_read_b128 v[160:163], v19 offset:32768
    v_mfma_f32_16x16x32_bf16 v[44:47], v[108:111], v[92:95], v[44:47]
    ds_read_b128 v[164:167], v19 offset:33792
    v_mfma_f32_16x16x32_bf16 v[48:51], v[112:115], v[92:95], v[48:51]
    ds_read_b128 v[168:171], v19 offset:34816
    v_mfma_f32_16x16x32_bf16 v[52:55], v[116:119], v[92:95], v[52:55]
    ds_read_b128 v[172:175], v19 offset:35840
    s_mov_b32 s97, 0xb000
    s_cmp_eq_u32 s96, 1
    s_cselect_b32 s97, 0xfffea000, s97
    s_cmp_eq_u32 s96, 2
    s_cselect_b32 s97, 0xb000, s97
    s_cselect_b32 s96, -1, s96
    s_add_u32 s96, s96, 1
    v_add_u32 v18, s97, v18
    v_add_u32 v19, s97, v19
    s_add_u32 s93, s93, 1
    s_cmp_lt_u32 s93, 15
    s_cbranch_scc1 L_CKV_g2
    buffer_load_dwordx4 v[212:215], v192, s[8:11], 0 offen
    buffer_load_dword v204, v200, s[20:23], s76 offen sc1
    buffer_load_dwordx4 v[216:219], v193, s[8:11], 0 offen
    buffer_load_dword v205, v201, s[20:23], s76 offen sc1
    buffer_load_dwordx4 v[220:223], v194, s[8:11], 0 offen
    buffer_load_dword v206, v202, s[20:23], s76 offen sc1
    .p2align 3
L_CKV_g2e:
    s_waitcnt lgkmcnt(0)
    s_barrier
    ds_read_b128 v[64:67], v18 offset:0
    ds_read_b128 v[68:71], v19 offset:0
    v_mfma_f32_16x16x32_bf16 v[32:35], v[124:127], v[120:123], v[32:35]
    ds_read_b128 v[72:75], v19 offset:1024
    v_mfma_f32_16x16x32_bf16 v[36:39], v[128:131], v[120:123], v[36:39]
    ds_read_b128 v[76:79], v19 offset:2048
    v_mfma_f32_16x16x32_bf16 v[40:43], v[132:135], v[120:123], v[40:43]
    ds_read_b128 v[80:83], v19 offset:3072
    v_mfma_f32_16x16x32_bf16 v[44:47], v[136:139], v[120:123], v[44:47]
    ds_read_b128 v[84:87], v19 offset:4096
    v_mfma_f32_16x16x32_bf16 v[48:51], v[140:143], v[120:123], v[48:51]
    ds_read_b128 v[88:91], v19 offset:5120
    v_mfma_f32_16x16x32_bf16 v[52:55], v[144:147], v[120:123], v[52:55]
    ds_read_b128 v[92:95], v18 offset:10240
    v_mfma_f32_16x16x32_bf16 v[32:35], v[152:155], v[148:151], v[32:35]
    ds_read_b128 v[96:99], v19 offset:10240
    v_mfma_f32_16x16x32_bf16 v[36:39], v[156:159], v[148:151], v[36:39]
    ds_read_b128 v[100:103], v19 offset:11264
    v_mfma_f32_16x16x32_bf16 v[40:43], v[160:163], v[148:151], v[40:43]
    ds_read_b128 v[104:107], v19 offset:12288
    v_mfma_f32_16x16x32_bf16 v[44:47], v[164:167], v[148:151], v[44:47]
    ds_read_b128 v[108:111], v19 offset:13312
    v_mfma_f32_16x16x32_bf16 v[48:51], v[168:171], v[148:151], v[48:51]
    ds_read_b128 v[112:115], v19 offset:14336
    v_mfma_f32_16x16x32_bf16 v[52:55], v[172:175], v[148:151], v[52:55]
    ds_read_b128 v[116:119], v19 offset:15360
    s_waitcnt lgkmcnt(7)
    ds_read_b128 v[120:123], v18 offset:20480
    ds_read_b128 v[124:127], v19 offset:20480
    v_mfma_f32_16x16x32_bf16 v[32:35], v[68:71], v[64:67], v[32:35]
    ds_read_b128 v[128:131], v19 offset:21504
    v_mfma_f32_16x16x32_bf16 v[36:39], v[72:75], v[64:67], v[36:39]
    ds_read_b128 v[132:135], v19 offset:22528
    v_mfma_f32_16x16x32_bf16 v[40:43], v[76:79], v[64:67], v[40:43]
    ds_read_b128 v[136:139], v19 offset:23552
    v_mfma_f32_16x16x32_bf16 v[44:47], v[80:83], v[64:67], v[44:47]
    ds_read_b128 v[140:143], v19 offset:24576
    v_mfma_f32_16x16x32_bf16 v[48:51], v[84:87], v[64:67], v[48:51]
    ds_read_b128 v[144:147], v19 offset:25600
    v_mfma_f32_16x16x32_bf16 v[52:55], v[88:91], v[64:67], v[52:55]
    ds_read_b128 v[148:151], v18 offset:30720
    s_waitcnt lgkmcnt(8)
    v_mfma_f32_16x16x32_bf16 v[32:35], v[96:99], v[92:95], v[32:35]
    ds_read_b128 v[152:155], v19 offset:30720
    v_mfma_f32_16x16x32_bf16 v[36:39], v[100:103], v[92:95], v[36:39]
    ds_read_b128 v[156:159], v19 offset:31744
    v_mfma_f32_16x16x32_bf16 v[40:43], v[104:107], v[92:95], v[40:43]
    ds_read_b128 v[160:163], v19 offset:32768
    v_mfma_f32_16x16x32_bf16 v[44:47], v[108:111], v[92:95], v[44:47]
    ds_read_b128 v[164:167], v19 offset:33792
    v_mfma_f32_16x16x32_bf16 v[48:51], v[112:115], v[92:95], v[48:51]
    ds_read_b128 v[168:171], v19 offset:34816
    v_mfma_f32_16x16x32_bf16 v[52:55], v[116:119], v[92:95], v[52:55]
    ds_read_b128 v[172:175], v19 offset:35840
    s_mov_b32 s97, 0xb000
    s_cmp_eq_u32 s96, 1
    s_cselect_b32 s97, 0xfffea000, s97
    s_cmp_eq_u32 s96, 2
    s_cselect_b32 s97, 0xb000, s97
    s_cselect_b32 s96, -1, s96
    s_add_u32 s96, s96, 1
    v_add_u32 v18, s97, v18
    v_add_u32 v19, s97, v19
    s_add_u32 s93, s93, 1
    s_cmp_lt_u32 s93, 17
    s_cbranch_scc1 L_CKV_g2e
    s_waitcnt lgkmcnt(0)
    v_mfma_f32_16x16x32_bf16 v[32:35], v[124:127], v[120:123], v[32:35]
    v_mfma_f32_16x16x32_bf16 v[36:39], v[128:131], v[120:123], v[36:39]
    v_mfma_f32_16x16x32_bf16 v[40:43], v[132:135], v[120:123], v[40:43]
    v_mfma_f32_16x16x32_bf16 v[44:47], v[136:139], v[120:123], v[44:47]
    v_mfma_f32_16x16x32_bf16 v[48:51], v[140:143], v[120:123], v[48:51]
    v_mfma_f32_16x16x32_bf16 v[52:55], v[144:147], v[120:123], v[52:55]
    v_mfma_f32_16x16x32_bf16 v[32:35], v[152:155], v[148:151], v[32:35]
    v_mfma_f32_16x16x32_bf16 v[36:39], v[156:159], v[148:151], v[36:39]
    v_mfma_f32_16x16x32_bf16 v[40:43], v[160:163], v[148:151], v[40:43]
    v_mfma_f32_16x16x32_bf16 v[44:47], v[164:167], v[148:151], v[44:47]
    v_mfma_f32_16x16x32_bf16 v[48:51], v[168:171], v[148:151], v[48:51]
    v_mfma_f32_16x16x32_bf16 v[52:55], v[172:175], v[148:151], v[52:55]
    s_nop 7
    ds_write_b128 v208, v[32:35] offset:0
    ds_write_b128 v208, v[36:39] offset:64
    ds_write_b128 v208, v[40:43] offset:128
    ds_write_b128 v208, v[44:47] offset:192
    ds_write_b128 v208, v[48:51] offset:256
    ds_write_b128 v208, v[52:55] offset:320
    s_waitcnt lgkmcnt(0)
    ds_read_b128 v[64:67], v196 offset:0
    ds_read_b128 v[68:71], v196 offset:16
    ds_read_b128 v[72:75], v197 offset:0
    ds_read_b128 v[76:79], v197 offset:16
    ds_read_b128 v[80:83], v198 offset:0
    ds_read_b128 v[84:87], v198 offset:16
    s_waitcnt vmcnt(0)
    s_waitcnt lgkmcnt(4)
    v_lshlrev_b32 v10, 16, v212
    v_and_b32 v11, s67, v212
    v_fma_f32 v10, v64, v204, v10
    v_fma_f32 v11, v65, v204, v11
    v_cvt_pk_bf16_f32 v228, v10, v11
    v_lshlrev_b32 v10, 16, v213
    v_and_b32 v11, s67, v213
    v_fma_f32 v10, v66, v204, v10
    v_fma_f32 v11, v67, v204, v11
    v_cvt_pk_bf16_f32 v229, v10, v11
    v_lshlrev_b32 v10, 16, v214
    v_and_b32 v11, s67, v214
    v_fma_f32 v10, v68, v204, v10
    v_fma_f32 v11, v69, v204, v11
    v_cvt_pk_bf16_f32 v230, v10, v11
    v_lshlrev_b32 v10, 16, v215
    v_and_b32 v11, s67, v215
    v_fma_f32 v10, v70, v204, v10
    v_fma_f32 v11, v71, v204, v11
    v_cvt_pk_bf16_f32 v231, v10, v11
    buffer_store_dwordx4 v[228:231], v192, s[84:87], 0 offen
    s_waitcnt lgkmcnt(2)
    v_lshlrev_b32 v10, 16, v216
    v_and_b32 v11, s67, v216
    v_fma_f32 v10, v72, v205, v10
    v_fma_f32 v11, v73, v205, v11
    v_cvt_pk_bf16_f32 v232, v10, v11
    v_lshlrev_b32 v10, 16, v217
    v_and_b32 v11, s67, v217
    v_fma_f32 v10, v74, v205, v10
    v_fma_f32 v11, v75, v205, v11
    v_cvt_pk_bf16_f32 v233, v10, v11
    v_lshlrev_b32 v10, 16, v218
    v_and_b32 v11, s67, v218
    v_fma_f32 v10, v76, v205, v10
    v_fma_f32 v11, v77, v205, v11
    v_cvt_pk_bf16_f32 v234, v10, v11
    v_lshlrev_b32 v10, 16, v219
    v_and_b32 v11, s67, v219
    v_fma_f32 v10, v78, v205, v10
    v_fma_f32 v11, v79, v205, v11
    v_cvt_pk_bf16_f32 v235, v10, v11
    buffer_store_dwordx4 v[232:235], v193, s[84:87], 0 offen
    s_waitcnt lgkmcnt(0)
    v_lshlrev_b32 v10, 16, v220
    v_and_b32 v11, s67, v220
    v_fma_f32 v10, v80, v206, v10
    v_fma_f32 v11, v81, v206, v11
    v_cvt_pk_bf16_f32 v236, v10, v11
    v_lshlrev_b32 v10, 16, v221
    v_and_b32 v11, s67, v221
    v_fma_f32 v10, v82, v206, v10
    v_fma_f32 v11, v83, v206, v11
    v_cvt_pk_bf16_f32 v237, v10, v11
    v_lshlrev_b32 v10, 16, v222
    v_and_b32 v11, s67, v222
    v_fma_f32 v10, v84, v206, v10
    v_fma_f32 v11, v85, v206, v11
    v_cvt_pk_bf16_f32 v238, v10, v11
    v_lshlrev_b32 v10, 16, v223
    v_and_b32 v11, s67, v223
    v_fma_f32 v10, v86, v206, v10
    v_fma_f32 v11, v87, v206, v11
    v_cvt_pk_bf16_f32 v239, v10, v11
    buffer_store_dwordx4 v[236:239], v194, s[84:87], 0 offen
    s_endpgm
L_LKV:
    v_lshrrev_b32 v10, 3, v1
    v_and_b32 v11, 7, v1
    v_lshrrev_b32 v12, 1, v10
    v_xor_b32 v11, v11, v12
    v_xor_b32 v12, 4, v11
    v_mul_u32_u24 v10, 1280, v10
    v_lshl_add_u32 v18, v11, 4, v10
    v_lshl_add_u32 v19, v12, 4, v10
    v_add_u32 v19, 10240, v19
    v_add_u32 v20, 20480, v18
    v_add_u32 v21, 20480, v19
    s_lshl_b32 s42, s36, 1
    s_lshl_b32 s39, s37, 2
    s_add_u32 s39, s39, s42
    s_mul_i32 s60, s39, 40960
    s_add_u32 s43, s60, 1280
    s_lshl_b32 s39, s83, 7
    s_add_u32 s60, s60, s39
    s_lshl_b32 s63, s42, 12
    s_lshl_b32 s40, s83, 2
    s_add_u32 s40, s40, s42
    s_mul_i32 s61, s40, 61440
    s_mul_i32 s62, s40, 61440
    s_mul_i32 s64, s42, 5120
    s_mul_i32 s75, s42, 0
    s_add_u32 s77, s60, 40960
    v_mov_b32 v45, 1073741824
    s_mul_i32 s39, s38, 160
    v_mov_b32 v14, 2528
    v_mov_b32 v15, 2368
    v_mov_b32 v16, 1280
    v_add_u32 v10, 0, v1
    v_mul_u32_u24 v11, 3277, v10
    v_lshrrev_b32 v11, 16, v11
    v_mul_u32_u24 v12, 20, v11
    v_sub_u32 v12, v10, v12
    v_cmp_lt_u32 vcc, 9, v12
    v_mul_u32_u24 v11, 3840, v11
    v_lshl_add_u32 v11, v12, 4, v11
    v_cndmask_b32 v13, v16, v14, vcc
    v_cmp_lt_u32 vcc, 11, v12
    v_add_u32 v11, s39, v11
    s_nop 0
    v_cndmask_b32 v13, v13, v15, vcc
    v_add_u32 v22, v11, v13
    v_add_u32 v10, 64, v1
    v_mul_u32_u24 v11, 3277, v10
    v_lshrrev_b32 v11, 16, v11
    v_mul_u32_u24 v12, 20, v11
    v_sub_u32 v12, v10, v12
    v_cmp_lt_u32 vcc, 9, v12
    v_mul_u32_u24 v11, 3840, v11
    v_lshl_add_u32 v11, v12, 4, v11
    v_cndmask_b32 v13, v16, v14, vcc
    v_cmp_lt_u32 vcc, 11, v12
    v_add_u32 v11, s39, v11
    s_nop 0
    v_cndmask_b32 v13, v13, v15, vcc
    v_add_u32 v23, v11, v13
    v_add_u32 v10, 128, v1
    v_mul_u32_u24 v11, 3277, v10
    v_lshrrev_b32 v11, 16, v11
    v_mul_u32_u24 v12, 20, v11
    v_sub_u32 v12, v10, v12
    v_cmp_lt_u32 vcc, 9, v12
    v_mul_u32_u24 v11, 3840, v11
    v_lshl_add_u32 v11, v12, 4, v11
    v_cndmask_b32 v13, v16, v14, vcc
    v_cmp_lt_u32 vcc, 11, v12
    v_add_u32 v11, s39, v11
    s_nop 0
    v_cndmask_b32 v13, v13, v15, vcc
    v_add_u32 v24, v11, v13
    v_add_u32 v10, 192, v1
    v_mul_u32_u24 v11, 3277, v10
    v_lshrrev_b32 v11, 16, v11
    v_mul_u32_u24 v12, 20, v11
    v_sub_u32 v12, v10, v12
    v_cmp_lt_u32 vcc, 9, v12
    v_mul_u32_u24 v11, 3840, v11
    v_lshl_add_u32 v11, v12, 4, v11
    v_cndmask_b32 v13, v16, v14, vcc
    v_cmp_lt_u32 vcc, 11, v12
    v_add_u32 v11, s39, v11
    s_nop 0
    v_cndmask_b32 v13, v13, v15, vcc
    v_add_u32 v25, v11, v13
    v_add_u32 v10, 256, v1
    v_mul_u32_u24 v11, 3277, v10
    v_lshrrev_b32 v11, 16, v11
    v_mul_u32_u24 v12, 20, v11
    v_sub_u32 v12, v10, v12
    v_cmp_lt_u32 vcc, 9, v12
    v_mul_u32_u24 v11, 3840, v11
    v_lshl_add_u32 v11, v12, 4, v11
    v_cndmask_b32 v13, v16, v14, vcc
    v_cmp_lt_u32 vcc, 11, v12
    v_add_u32 v11, s39, v11
    s_nop 0
    v_cndmask_b32 v13, v13, v15, vcc
    v_add_u32 v26, v11, v13
    s_waitcnt lgkmcnt(0)
    s_mov_b32 s8, s44
    s_mov_b32 s9, s45
    s_mov_b32 s10, 2621440
    s_mov_b32 s11, 0x00020000
    s_mov_b32 s12, s46
    s_mov_b32 s13, s47
    s_mov_b32 s14, 2457600
    s_mov_b32 s15, 0x00020000
    s_mov_b32 s16, s52
    s_mov_b32 s17, s53
    s_mov_b32 s18, 1966080
    s_mov_b32 s19, 0x00020000
    s_mov_b32 s20, s58
    s_mov_b32 s21, s59
    s_mov_b32 s22, 14680064
    s_mov_b32 s23, 0x00020000
    s_add_u32 s49, s61, 61440
    s_add_u32 s48, s62, 61440
    s_lshl_b32 s56, s36, 12
    s_add_u32 m0, s63, 0
    s_nop 0
    buffer_load_dwordx4 v18, s[8:11], s60 offen lds
    s_add_u32 m0, s63, 1024
    s_nop 0
    buffer_load_dwordx4 v19, s[8:11], s60 offen lds
    s_add_u32 m0, s63, 2048
    s_nop 0
    buffer_load_dwordx4 v20, s[8:11], s60 offen lds
    s_add_u32 m0, s63, 3072
    s_nop 0
    buffer_load_dwordx4 v21, s[8:11], s60 offen lds
    s_add_u32 m0, s64, 16384
    s_nop 0
    buffer_load_dwordx4 v22, s[12:15], s61 offen lds
    s_add_u32 m0, s64, 17408
    s_nop 0
    buffer_load_dwordx4 v23, s[12:15], s61 offen lds
    s_add_u32 m0, s64, 18432
    s_nop 0
    buffer_load_dwordx4 v24, s[12:15], s61 offen lds
    s_add_u32 m0, s64, 19456
    s_nop 0
    buffer_load_dwordx4 v25, s[12:15], s61 offen lds
    s_add_u32 m0, s64, 20480
    s_nop 0
    buffer_load_dwordx4 v26, s[12:15], s61 offen lds
    s_add_u32 m0, s63, 4096
    s_nop 0
    buffer_load_dwordx4 v18, s[8:11], s77 offen lds
    s_add_u32 m0, s63, 5120
    s_nop 0
    buffer_load_dwordx4 v19, s[8:11], s77 offen lds
    v_bfe_u32 v10, v1, 2, 2
    v_and_b32 v11, 3, v1
    v_lshlrev_b32 v11, 3, v11
    v_and_b32 v12, 16, v1
    v_lshl_add_u32 v11, v12, 1, v11
    v_lshl_add_u32 v12, v2, 3, v10
    v_mul_u32_u24 v58, 320, v12
    v_add_u32 v58, v58, v11
    s_mul_i32 s39, s36, 64
    s_add_u32 s39, s39, 16384
    v_add_u32 v32, s39, v58
    s_lshl_b32 s96, s36, 7
    v_add_u32 v33, 16640, v58
    s_mov_b32 s97, 512
    s_add_u32 m0, s63, 6144
    s_nop 0
    buffer_load_dwordx4 v20, s[8:11], s77 offen lds
    v_and_b32 v10, 31, v1
    v_bfe_u32 v11, v1, 1, 3
    v_xor_b32 v11, v11, v2
    s_lshl_b32 s39, s36, 12
    v_lshl_add_u32 v10, v10, 7, s39
    v_xor_b32 v12, 0, v11
    v_lshl_add_u32 v112, v12, 4, v10
    v_xor_b32 v12, 2, v11
    v_lshl_add_u32 v113, v12, 4, v10
    v_xor_b32 v12, 4, v11
    v_lshl_add_u32 v114, v12, 4, v10
    v_xor_b32 v12, 6, v11
    v_lshl_add_u32 v115, v12, 4, v10
    s_add_u32 m0, s63, 7168
    s_nop 0
    buffer_load_dwordx4 v21, s[8:11], s77 offen lds
    s_lshl_b32 s42, s36, 1
    s_mul_i32 s76, s89, 68
    s_add_u32 s76, s76, s42
    s_lshl_b32 s76, s76, 12
    s_mul_i32 s79, s90, 68
    s_add_u32 s79, s79, s42
    s_mul_i32 s79, s79, 10240
    s_add_u32 s79, s79, 9437184
    s_mul_i32 s57, s42, 10240
    s_add_u32 m0, s64, 21504
    s_nop 0
    buffer_load_dwordx4 v22, s[12:15], s49 offen lds
    s_mov_b32 s47, 0
    s_mov_b32 s50, 0
    s_add_u32 m0, s64, 22528
    s_nop 0
    buffer_load_dwordx4 v23, s[12:15], s49 offen lds
    s_lshr_b32 s39, s90, 1
    s_lshl_b32 s39, s39, 8
    s_and_b32 s40, s90, 1
    s_lshl_b32 s40, s40, 13
    s_add_u32 s39, s39, s40
    s_add_u32 s39, s39, 13697120
    v_and_b32 v10, 3, v1
    v_lshl_add_u32 v10, v10, 11, s39
    v_and_b32 v11, 4, v1
    v_lshl_add_u32 v10, v11, 12, v10
    v_and_b32 v11, 8, v1
    v_lshl_add_u32 v10, v11, 4, v10
    v_and_b32 v11, 48, v1
    v_lshl_add_u32 v46, v11, 5, v10
    v_mov_b32 v47, 2
    s_add_u32 m0, s64, 23552
    s_nop 0
    buffer_load_dwordx4 v24, s[12:15], s49 offen lds
    s_lshr_b32 s39, s89, 1
    s_lshl_b32 s39, s39, 11
    s_and_b32 s40, s89, 1
    s_lshl_b32 s40, s40, 5
    s_add_u32 s39, s39, s40
    s_add_u32 s39, s39, 13697152
    v_lshrrev_b32 v10, 1, v1
    v_and_b32 v11, 1, v1
    v_lshl_add_u32 v11, v11, 4, s39
    v_lshl_add_u32 v12, v10, 8, v11
    v_cmp_gt_u32 vcc, 16, v1
    v_mov_b32 v13, 1
    s_nop 0
    v_cndmask_b32 v48, v45, v12, vcc
    v_cndmask_b32 v49, 0, v13, vcc
    s_add_u32 m0, s64, 24576
    s_nop 0
    buffer_load_dwordx4 v25, s[12:15], s49 offen lds
    s_add_u32 m0, s64, 25600
    s_nop 0
    buffer_load_dwordx4 v26, s[12:15], s49 offen lds
    s_add_u32 s60, s60, 128
    s_cmp_ge_u32 s60, s43
    s_cselect_b32 s69, 1280, 0
    s_sub_u32 s60, s60, s69
    s_add_u32 s77, s60, 40960
    s_add_u32 s61, s61, 245760
    s_cmp_ge_u32 s61, 2457600
    s_cselect_b32 s69, 2457600, 0
    s_sub_u32 s61, s61, s69
    s_add_u32 s49, s61, 61440
    s_add_u32 m0, s63, 45056
    s_nop 0
    buffer_load_dwordx4 v18, s[8:11], s60 offen lds
    s_add_u32 m0, s63, 46080
    s_nop 0
    buffer_load_dwordx4 v19, s[8:11], s60 offen lds
    s_add_u32 m0, s63, 47104
    s_nop 0
    buffer_load_dwordx4 v20, s[8:11], s60 offen lds
    s_add_u32 m0, s63, 48128
    s_nop 0
    buffer_load_dwordx4 v21, s[8:11], s60 offen lds
    s_add_u32 m0, s64, 61440
    s_nop 0
    buffer_load_dwordx4 v22, s[12:15], s61 offen lds
    s_add_u32 m0, s64, 62464
    s_nop 0
    buffer_load_dwordx4 v23, s[12:15], s61 offen lds
    s_add_u32 m0, s64, 63488
    s_nop 0
    buffer_load_dwordx4 v24, s[12:15], s61 offen lds
    s_add_u32 m0, s64, 64512
    s_nop 0
    buffer_load_dwordx4 v25, s[12:15], s61 offen lds
    s_add_u32 m0, s64, 65536
    s_nop 0
    buffer_load_dwordx4 v26, s[12:15], s61 offen lds
    s_add_u32 m0, s63, 49152
    s_nop 0
    buffer_load_dwordx4 v18, s[8:11], s77 offen lds
    s_add_u32 m0, s63, 50176
    s_nop 0
    buffer_load_dwordx4 v19, s[8:11], s77 offen lds
    s_add_u32 m0, s63, 51200
    s_nop 0
    buffer_load_dwordx4 v20, s[8:11], s77 offen lds
    s_add_u32 m0, s63, 52224
    s_nop 0
    buffer_load_dwordx4 v21, s[8:11], s77 offen lds
    s_add_u32 m0, s64, 66560
    s_nop 0
    buffer_load_dwordx4 v22, s[12:15], s49 offen lds
    s_add_u32 m0, s64, 67584
    s_nop 0
    buffer_load_dwordx4 v23, s[12:15], s49 offen lds
    s_add_u32 m0, s64, 68608
    s_nop 0
    buffer_load_dwordx4 v24, s[12:15], s49 offen lds
    s_add_u32 m0, s64, 69632
    s_nop 0
    buffer_load_dwordx4 v25, s[12:15], s49 offen lds
    s_add_u32 m0, s64, 70656
    s_nop 0
    buffer_load_dwordx4 v26, s[12:15], s49 offen lds
    s_add_u32 s60, s60, 128
    s_cmp_ge_u32 s60, s43
    s_cselect_b32 s69, 1280, 0
    s_sub_u32 s60, s60, s69
    s_add_u32 s77, s60, 40960
    s_add_u32 s61, s61, 245760
    s_cmp_ge_u32 s61, 2457600
    s_cselect_b32 s69, 2457600, 0
    s_sub_u32 s61, s61, s69
    s_add_u32 s49, s61, 61440
    s_waitcnt vmcnt(18) lgkmcnt(0)
    s_barrier
    ds_read_b128 v[120:123], v112
    ds_read_b128 v[124:127], v113
    ds_read_b128 v[128:131], v114
    ds_read_b128 v[132:135], v115
    ds_read_b64_tr_b16 v[64:65], v32 offset:0
    ds_read_b64_tr_b16 v[66:67], v32 offset:1280
    ds_read_b64_tr_b16 v[68:69], v32 offset:5120
    ds_read_b64_tr_b16 v[70:71], v32 offset:6400
    ds_read_b64_tr_b16 v[72:73], v32 offset:10240
    ds_read_b64_tr_b16 v[74:75], v32 offset:11520
    ds_read_b64_tr_b16 v[76:77], v32 offset:15360
    ds_read_b64_tr_b16 v[78:79], v32 offset:16640
    ds_read_b64_tr_b16 v[80:81], v33 offset:0
    ds_read_b64_tr_b16 v[82:83], v33 offset:1280
    ds_read_b64_tr_b16 v[84:85], v33 offset:5120
    ds_read_b64_tr_b16 v[86:87], v33 offset:6400
    ds_read_b64_tr_b16 v[88:89], v33 offset:10240
    ds_read_b64_tr_b16 v[90:91], v33 offset:11520
    ds_read_b64_tr_b16 v[92:93], v33 offset:15360
    ds_read_b64_tr_b16 v[94:95], v33 offset:16640
    s_add_u32 m0, s63, 90112
    s_nop 0
    buffer_load_dwordx4 v18, s[8:11], s60 offen lds
    s_add_u32 m0, s63, 91136
    s_nop 0
    buffer_load_dwordx4 v19, s[8:11], s60 offen lds
    s_waitcnt lgkmcnt(0)
    s_add_u32 m0, s63, 92160
    s_nop 0
    buffer_load_dwordx4 v20, s[8:11], s60 offen lds
    v_mov_b32 v116, 0
    v_mov_b32 v117, 0
    v_mov_b32 v118, 0
    v_mov_b32 v119, 0
    v_mov_b32 v36, 0
    v_mov_b32 v37, 0
    v_mov_b32 v38, 0
    v_mov_b32 v39, 0
    s_add_u32 m0, s63, 93184
    s_nop 0
    buffer_load_dwordx4 v21, s[8:11], s60 offen lds
    v_lshlrev_b32 v58, 16, v120
    v_and_b32 v59, s67, v120
    v_lshlrev_b32 v60, 16, v121
    v_and_b32 v61, s67, v121
    v_add_f32 v116, v116, v58
    v_add_f32 v117, v117, v59
    v_fmac_f32 v118, v58, v58
    v_fmac_f32 v119, v59, v59
    v_add_f32 v116, v116, v60
    v_add_f32 v117, v117, v61
    v_fmac_f32 v118, v60, v60
    v_fmac_f32 v119, v61, v61
    s_add_u32 m0, s64, 106496
    s_nop 0
    buffer_load_dwordx4 v22, s[12:15], s61 offen lds
    v_lshlrev_b32 v58, 16, v122
    v_and_b32 v59, s67, v122
    v_lshlrev_b32 v60, 16, v123
    v_and_b32 v61, s67, v123
    v_add_f32 v116, v116, v58
    v_add_f32 v117, v117, v59
    v_fmac_f32 v118, v58, v58
    v_fmac_f32 v119, v59, v59
    v_add_f32 v116, v116, v60
    v_add_f32 v117, v117, v61
    v_fmac_f32 v118, v60, v60
    v_fmac_f32 v119, v61, v61
    s_add_u32 m0, s64, 107520
    s_nop 0
    buffer_load_dwordx4 v23, s[12:15], s61 offen lds
    v_lshlrev_b32 v58, 16, v124
    v_and_b32 v59, s67, v124
    v_lshlrev_b32 v60, 16, v125
    v_and_b32 v61, s67, v125
    v_add_f32 v116, v116, v58
    v_add_f32 v117, v117, v59
    v_fmac_f32 v118, v58, v58
    v_fmac_f32 v119, v59, v59
    v_add_f32 v116, v116, v60
    v_add_f32 v117, v117, v61
    v_fmac_f32 v118, v60, v60
    v_fmac_f32 v119, v61, v61
    s_add_u32 m0, s64, 108544
    s_nop 0
    buffer_load_dwordx4 v24, s[12:15], s61 offen lds
    v_lshlrev_b32 v58, 16, v126
    v_and_b32 v59, s67, v126
    v_lshlrev_b32 v60, 16, v127
    v_and_b32 v61, s67, v127
    v_add_f32 v116, v116, v58
    v_add_f32 v117, v117, v59
    v_fmac_f32 v118, v58, v58
    v_fmac_f32 v119, v59, v59
    v_add_f32 v116, v116, v60
    v_add_f32 v117, v117, v61
    v_fmac_f32 v118, v60, v60
    v_fmac_f32 v119, v61, v61
    s_add_u32 m0, s64, 109568
    s_nop 0
    buffer_load_dwordx4 v25, s[12:15], s61 offen lds
    v_lshlrev_b32 v58, 16, v128
    v_and_b32 v59, s67, v128
    v_lshlrev_b32 v60, 16, v129
    v_and_b32 v61, s67, v129
    v_add_f32 v116, v116, v58
    v_add_f32 v117, v117, v59
    v_fmac_f32 v118, v58, v58
    v_fmac_f32 v119, v59, v59
    v_add_f32 v116, v116, v60
    v_add_f32 v117, v117, v61
    v_fmac_f32 v118, v60, v60
    v_fmac_f32 v119, v61, v61
    s_add_u32 m0, s64, 110592
    s_nop 0
    buffer_load_dwordx4 v26, s[12:15], s61 offen lds
    v_lshlrev_b32 v58, 16, v130
    v_and_b32 v59, s67, v130
    v_lshlrev_b32 v60, 16, v131
    v_and_b32 v61, s67, v131
    v_add_f32 v116, v116, v58
    v_add_f32 v117, v117, v59
    v_fmac_f32 v118, v58, v58
    v_fmac_f32 v119, v59, v59
    v_add_f32 v116, v116, v60
    v_add_f32 v117, v117, v61
    v_fmac_f32 v118, v60, v60
    v_fmac_f32 v119, v61, v61
    s_add_u32 m0, s63, 94208
    s_nop 0
    buffer_load_dwordx4 v18, s[8:11], s77 offen lds
    v_lshlrev_b32 v58, 16, v132
    v_and_b32 v59, s67, v132
    v_lshlrev_b32 v60, 16, v133
    v_and_b32 v61, s67, v133
    v_add_f32 v116, v116, v58
    v_add_f32 v117, v117, v59
    v_fmac_f32 v118, v58, v58
    v_fmac_f32 v119, v59, v59
    v_add_f32 v116, v116, v60
    v_add_f32 v117, v117, v61
    v_fmac_f32 v118, v60, v60
    v_fmac_f32 v119, v61, v61
    s_add_u32 m0, s63, 95232
    s_nop 0
    buffer_load_dwordx4 v19, s[8:11], s77 offen lds
    v_lshlrev_b32 v58, 16, v134
    v_and_b32 v59, s67, v134
    v_lshlrev_b32 v60, 16, v135
    v_and_b32 v61, s67, v135
    v_add_f32 v116, v116, v58
    v_add_f32 v117, v117, v59
    v_fmac_f32 v118, v58, v58
    v_fmac_f32 v119, v59, v59
    v_add_f32 v116, v116, v60
    v_add_f32 v117, v117, v61
    v_fmac_f32 v118, v60, v60
    v_fmac_f32 v119, v61, v61
    s_add_u32 m0, s63, 96256
    s_nop 0
    buffer_load_dwordx4 v20, s[8:11], s77 offen lds
    v_lshlrev_b32 v58, 16, v64
    v_and_b32 v59, s67, v64
    v_lshlrev_b32 v60, 16, v80
    v_and_b32 v61, s67, v80
    v_add_f32 v36, v36, v58
    v_add_f32 v37, v37, v59
    v_add_f32 v38, v38, v60
    v_add_f32 v39, v39, v61
    s_add_u32 m0, s63, 97280
    s_nop 0
    buffer_load_dwordx4 v21, s[8:11], s77 offen lds
    v_lshlrev_b32 v58, 16, v65
    v_and_b32 v59, s67, v65
    v_lshlrev_b32 v60, 16, v81
    v_and_b32 v61, s67, v81
    v_add_f32 v36, v36, v58
    v_add_f32 v37, v37, v59
    v_add_f32 v38, v38, v60
    v_add_f32 v39, v39, v61
    s_add_u32 m0, s64, 111616
    s_nop 0
    buffer_load_dwordx4 v22, s[12:15], s49 offen lds
    v_lshlrev_b32 v58, 16, v66
    v_and_b32 v59, s67, v66
    v_lshlrev_b32 v60, 16, v82
    v_and_b32 v61, s67, v82
    v_add_f32 v36, v36, v58
    v_add_f32 v37, v37, v59
    v_add_f32 v38, v38, v60
    v_add_f32 v39, v39, v61
    s_add_u32 m0, s64, 112640
    s_nop 0
    buffer_load_dwordx4 v23, s[12:15], s49 offen lds
    v_lshlrev_b32 v58, 16, v67
    v_and_b32 v59, s67, v67
    v_lshlrev_b32 v60, 16, v83
    v_and_b32 v61, s67, v83
    v_add_f32 v36, v36, v58
    v_add_f32 v37, v37, v59
    v_add_f32 v38, v38, v60
    v_add_f32 v39, v39, v61
    s_add_u32 m0, s64, 113664
    s_nop 0
    buffer_load_dwordx4 v24, s[12:15], s49 offen lds
    s_add_u32 m0, s64, 114688
    s_nop 0
    buffer_load_dwordx4 v25, s[12:15], s49 offen lds
    s_add_u32 m0, s64, 115712
    s_nop 0
    buffer_load_dwordx4 v26, s[12:15], s49 offen lds
    s_add_u32 s60, s60, 128
    s_cmp_ge_u32 s60, s43
    s_cselect_b32 s69, 1280, 0
    s_sub_u32 s60, s60, s69
    s_add_u32 s77, s60, 40960
    s_add_u32 s61, s61, 245760
    s_cmp_ge_u32 s61, 2457600
    s_cselect_b32 s69, 2457600, 0
    s_sub_u32 s61, s61, s69
    s_add_u32 s49, s61, 61440
    s_waitcnt vmcnt(18) lgkmcnt(0)
    s_barrier
    s_add_u32 m0, s63, 0
    s_nop 0
    buffer_load_dwordx4 v18, s[8:11], s60 offen lds
    v_lshlrev_b32 v58, 16, v68
    v_and_b32 v59, s67, v68
    v_lshlrev_b32 v60, 16, v84
    v_and_b32 v61, s67, v84
    v_add_f32 v36, v36, v58
    v_add_f32 v37, v37, v59
    v_add_f32 v38, v38, v60
    v_add_f32 v39, v39, v61
    s_add_u32 m0, s63, 1024
    s_nop 0
    buffer_load_dwordx4 v19, s[8:11], s60 offen lds
    v_lshlrev_b32 v58, 16, v69
    v_and_b32 v59, s67, v69
    v_lshlrev_b32 v60, 16, v85
    v_and_b32 v61, s67, v85
    v_add_f32 v36, v36, v58
    v_add_f32 v37, v37, v59
    v_add_f32 v38, v38, v60
    v_add_f32 v39, v39, v61
    s_add_u32 m0, s63, 2048
    s_nop 0
    buffer_load_dwordx4 v20, s[8:11], s60 offen lds
    v_lshlrev_b32 v58, 16, v70
    v_and_b32 v59, s67, v70
    v_lshlrev_b32 v60, 16, v86
    v_and_b32 v61, s67, v86
    v_add_f32 v36, v36, v58
    v_add_f32 v37, v37, v59
    v_add_f32 v38, v38, v60
    v_add_f32 v39, v39, v61
    s_add_u32 m0, s63, 3072
    s_nop 0
    buffer_load_dwordx4 v21, s[8:11], s60 offen lds
    v_lshlrev_b32 v58, 16, v71
    v_and_b32 v59, s67, v71
    v_lshlrev_b32 v60, 16, v87
    v_and_b32 v61, s67, v87
    v_add_f32 v36, v36, v58
    v_add_f32 v37, v37, v59
    v_add_f32 v38, v38, v60
    v_add_f32 v39, v39, v61
    s_add_u32 m0, s64, 16384
    s_nop 0
    buffer_load_dwordx4 v22, s[12:15], s61 offen lds
    v_lshlrev_b32 v58, 16, v72
    v_and_b32 v59, s67, v72
    v_lshlrev_b32 v60, 16, v88
    v_and_b32 v61, s67, v88
    v_add_f32 v36, v36, v58
    v_add_f32 v37, v37, v59
    v_add_f32 v38, v38, v60
    v_add_f32 v39, v39, v61
    s_add_u32 m0, s64, 17408
    s_nop 0
    buffer_load_dwordx4 v23, s[12:15], s61 offen lds
    v_lshlrev_b32 v58, 16, v73
    v_and_b32 v59, s67, v73
    v_lshlrev_b32 v60, 16, v89
    v_and_b32 v61, s67, v89
    v_add_f32 v36, v36, v58
    v_add_f32 v37, v37, v59
    v_add_f32 v38, v38, v60
    v_add_f32 v39, v39, v61
    s_add_u32 m0, s64, 18432
    s_nop 0
    buffer_load_dwordx4 v24, s[12:15], s61 offen lds
    v_lshlrev_b32 v58, 16, v74
    v_and_b32 v59, s67, v74
    v_lshlrev_b32 v60, 16, v90
    v_and_b32 v61, s67, v90
    v_add_f32 v36, v36, v58
    v_add_f32 v37, v37, v59
    v_add_f32 v38, v38, v60
    v_add_f32 v39, v39, v61
    s_add_u32 m0, s64, 19456
    s_nop 0
    buffer_load_dwordx4 v25, s[12:15], s61 offen lds
    v_lshlrev_b32 v58, 16, v75
    v_and_b32 v59, s67, v75
    v_lshlrev_b32 v60, 16, v91
    v_and_b32 v61, s67, v91
    v_add_f32 v36, v36, v58
    v_add_f32 v37, v37, v59
    v_add_f32 v38, v38, v60
    v_add_f32 v39, v39, v61
    s_add_u32 m0, s64, 20480
    s_nop 0
    buffer_load_dwordx4 v26, s[12:15], s61 offen lds
    v_lshlrev_b32 v58, 16, v76
    v_and_b32 v59, s67, v76
    v_lshlrev_b32 v60, 16, v92
    v_and_b32 v61, s67, v92
    v_add_f32 v36, v36, v58
    v_add_f32 v37, v37, v59
    v_add_f32 v38, v38, v60
    v_add_f32 v39, v39, v61
    s_add_u32 m0, s63, 4096
    s_nop 0
    buffer_load_dwordx4 v18, s[8:11], s77 offen lds
    v_lshlrev_b32 v58, 16, v77
    v_and_b32 v59, s67, v77
    v_lshlrev_b32 v60, 16, v93
    v_and_b32 v61, s67, v93
    v_add_f32 v36, v36, v58
    v_add_f32 v37, v37, v59
    v_add_f32 v38, v38, v60
    v_add_f32 v39, v39, v61
    s_add_u32 m0, s63, 5120
    s_nop 0
    buffer_load_dwordx4 v19, s[8:11], s77 offen lds
    v_lshlrev_b32 v58, 16, v78
    v_and_b32 v59, s67, v78
    v_lshlrev_b32 v60, 16, v94
    v_and_b32 v61, s67, v94
    v_add_f32 v36, v36, v58
    v_add_f32 v37, v37, v59
    v_add_f32 v38, v38, v60
    v_add_f32 v39, v39, v61
    s_add_u32 m0, s63, 6144
    s_nop 0
    buffer_load_dwordx4 v20, s[8:11], s77 offen lds
    v_lshlrev_b32 v58, 16, v79
    v_and_b32 v59, s67, v79
    v_lshlrev_b32 v60, 16, v95
    v_and_b32 v61, s67, v95
    v_add_f32 v36, v36, v58
    v_add_f32 v37, v37, v59
    v_add_f32 v38, v38, v60
    v_add_f32 v39, v39, v61
    s_add_u32 m0, s63, 7168
    s_nop 0
    buffer_load_dwordx4 v21, s[8:11], s77 offen lds
    v_add_f32 v116, v116, v117
    v_add_f32 v117, v118, v119
    v_add_f32 v36, v36, v37
    v_add_f32 v38, v38, v39
    v_mov_b32 v58, v116
    v_mov_b32 v59, v117
    v_mov_b32 v60, v36
    v_mov_b32 v61, v38
    s_nop 1
    v_permlane32_swap_b32 v116, v58
    v_permlane32_swap_b32 v117, v59
    v_permlane32_swap_b32 v36, v60
    v_permlane32_swap_b32 v38, v61
    s_nop 1
    v_add_f32 v116, v116, v58
    v_add_f32 v117, v117, v59
    v_add_f32 v36, v36, v60
    v_add_f32 v38, v38, v61
    v_max_u32 v116, 1, v116
    v_max_u32 v117, 1, v117
    v_max_u32 v36, 1, v36
    v_max_u32 v38, 1, v38
    s_add_u32 m0, s64, 21504
    s_nop 0
    buffer_load_dwordx4 v22, s[12:15], s49 offen lds
    s_add_u32 m0, s64, 22528
    s_nop 0
    buffer_load_dwordx4 v23, s[12:15], s49 offen lds
    s_add_u32 m0, s64, 23552
    s_nop 0
    buffer_load_dwordx4 v24, s[12:15], s49 offen lds
    s_add_u32 m0, s64, 24576
    s_nop 0
    buffer_load_dwordx4 v25, s[12:15], s49 offen lds
    s_add_u32 m0, s64, 25600
    s_nop 0
    buffer_load_dwordx4 v26, s[12:15], s49 offen lds
    s_add_u32 s60, s60, 128
    s_cmp_ge_u32 s60, s43
    s_cselect_b32 s69, 1280, 0
    s_sub_u32 s60, s60, s69
    s_add_u32 s77, s60, 40960
    s_add_u32 s61, s61, 245760
    s_cmp_ge_u32 s61, 2457600
    s_cselect_b32 s69, 2457600, 0
    s_sub_u32 s61, s61, s69
    s_add_u32 s49, s61, 61440
    s_mul_i32 s39, s37, 10
    s_add_u32 s39, s39, s83
    s_lshl_b32 s39, s39, 10
    s_add_u32 s39, s39, 13762560
    s_cmp_lt_u32 s88, 10
    s_cselect_b32 s39, s39, 1073741824
    s_mul_i32 s42, s88, 10
    s_add_u32 s42, s42, s83
    s_lshl_b32 s42, s42, 11
    s_add_u32 s42, s42, 12845056
    s_cmp_lt_u32 s37, 10
    s_cselect_b32 s42, s42, 1073741824
    s_lshl_b32 s40, s36, 8
    s_add_u32 s39, s39, s40
    v_lshlrev_b32 v58, 1, v3
    v_cndmask_b32 v58, v58, v45, s[70:71]
    buffer_store_dwordx2 v[116:117], v58, s[20:23], s39 offen sc1
    v_add_u32 v59, s96, v3
    v_add_u32 v60, s97, v3
    v_cndmask_b32 v59, v59, v60, s[70:71]
    v_cndmask_b32 v36, v36, v38, s[70:71]
    buffer_store_dword v36, v59, s[20:23], s42 offen sc1
    s_waitcnt vmcnt(20) lgkmcnt(0)
    s_barrier
    s_add_u32 m0, s63, 45056
    s_nop 0
    buffer_load_dwordx4 v18, s[8:11], s60 offen lds
    s_add_u32 m0, s63, 46080
    s_nop 0
    buffer_load_dwordx4 v19, s[8:11], s60 offen lds
    s_add_u32 m0, s63, 47104
    s_nop 0
    buffer_load_dwordx4 v20, s[8:11], s60 offen lds
    s_add_u32 m0, s63, 48128
    s_nop 0
    buffer_load_dwordx4 v21, s[8:11], s60 offen lds
    s_add_u32 m0, s64, 61440
    s_nop 0
    buffer_load_dwordx4 v22, s[12:15], s61 offen lds
    s_add_u32 m0, s64, 62464
    s_nop 0
    buffer_load_dwordx4 v23, s[12:15], s61 offen lds
    s_add_u32 m0, s64, 63488
    s_nop 0
    buffer_load_dwordx4 v24, s[12:15], s61 offen lds
    s_add_u32 m0, s64, 64512
    s_nop 0
    buffer_load_dwordx4 v25, s[12:15], s61 offen lds
    s_add_u32 m0, s64, 65536
    s_nop 0
    buffer_load_dwordx4 v26, s[12:15], s61 offen lds
    s_add_u32 m0, s63, 49152
    s_nop 0
    buffer_load_dwordx4 v18, s[8:11], s77 offen lds
    s_add_u32 m0, s63, 50176
    s_nop 0
    buffer_load_dwordx4 v19, s[8:11], s77 offen lds
    s_add_u32 m0, s63, 51200
    s_nop 0
    buffer_load_dwordx4 v20, s[8:11], s77 offen lds
    s_add_u32 m0, s63, 52224
    s_nop 0
    buffer_load_dwordx4 v21, s[8:11], s77 offen lds
    s_add_u32 m0, s64, 66560
    s_nop 0
    buffer_load_dwordx4 v22, s[12:15], s49 offen lds
    s_add_u32 m0, s64, 67584
    s_nop 0
    buffer_load_dwordx4 v23, s[12:15], s49 offen lds
    s_add_u32 m0, s64, 68608
    s_nop 0
    buffer_load_dwordx4 v24, s[12:15], s49 offen lds
    s_add_u32 m0, s64, 69632
    s_nop 0
    buffer_load_dwordx4 v25, s[12:15], s49 offen lds
    s_add_u32 m0, s64, 70656
    s_nop 0
    buffer_load_dwordx4 v26, s[12:15], s49 offen lds
    s_add_u32 s60, s60, 128
    s_cmp_ge_u32 s60, s43
    s_cselect_b32 s69, 1280, 0
    s_sub_u32 s60, s60, s69
    s_add_u32 s77, s60, 40960
    s_add_u32 s61, s61, 245760
    s_cmp_ge_u32 s61, 2457600
    s_cselect_b32 s69, 2457600, 0
    s_sub_u32 s61, s61, s69
    s_add_u32 s49, s61, 61440
    s_waitcnt vmcnt(20) lgkmcnt(0)
    s_barrier
    s_add_u32 m0, s63, 90112
    s_nop 0
    buffer_load_dwordx4 v18, s[8:11], s60 offen lds
    s_add_u32 m0, s63, 91136
    s_nop 0
    buffer_load_dwordx4 v19, s[8:11], s60 offen lds
    s_add_u32 m0, s63, 92160
    s_nop 0
    buffer_load_dwordx4 v20, s[8:11], s60 offen lds
    s_add_u32 m0, s63, 93184
    s_nop 0
    buffer_load_dwordx4 v21, s[8:11], s60 offen lds
    s_add_u32 m0, s64, 106496
    s_nop 0
    buffer_load_dwordx4 v22, s[12:15], s61 offen lds
    s_add_u32 m0, s64, 107520
    s_nop 0
    buffer_load_dwordx4 v23, s[12:15], s61 offen lds
    s_add_u32 m0, s64, 108544
    s_nop 0
    buffer_load_dwordx4 v24, s[12:15], s61 offen lds
    s_add_u32 m0, s64, 109568
    s_nop 0
    buffer_load_dwordx4 v25, s[12:15], s61 offen lds
    s_add_u32 m0, s64, 110592
    s_nop 0
    buffer_load_dwordx4 v26, s[12:15], s61 offen lds
    s_add_u32 m0, s63, 94208
    s_nop 0
    buffer_load_dwordx4 v18, s[8:11], s77 offen lds
    s_add_u32 m0, s63, 95232
    s_nop 0
    buffer_load_dwordx4 v19, s[8:11], s77 offen lds
    s_add_u32 m0, s63, 96256
    s_nop 0
    buffer_load_dwordx4 v20, s[8:11], s77 offen lds
    s_add_u32 m0, s63, 97280
    s_nop 0
    buffer_load_dwordx4 v21, s[8:11], s77 offen lds
    s_add_u32 m0, s64, 111616
    s_nop 0
    buffer_load_dwordx4 v22, s[12:15], s49 offen lds
    s_add_u32 m0, s64, 112640
    s_nop 0
    buffer_load_dwordx4 v23, s[12:15], s49 offen lds
    s_add_u32 m0, s64, 113664
    s_nop 0
    buffer_load_dwordx4 v24, s[12:15], s49 offen lds
    s_add_u32 m0, s64, 114688
    s_nop 0
    buffer_load_dwordx4 v25, s[12:15], s49 offen lds
    s_add_u32 m0, s64, 115712
    s_nop 0
    buffer_load_dwordx4 v26, s[12:15], s49 offen lds
    s_add_u32 s60, s60, 128
    s_cmp_ge_u32 s60, s43
    s_cselect_b32 s69, 1280, 0
    s_sub_u32 s60, s60, s69
    s_add_u32 s77, s60, 40960
    s_add_u32 s61, s61, 245760
    s_cmp_ge_u32 s61, 2457600
    s_cselect_b32 s69, 2457600, 0
    s_sub_u32 s61, s61, s69
    s_add_u32 s49, s61, 61440
    s_waitcnt vmcnt(18) lgkmcnt(0)
    s_barrier
    s_add_u32 m0, s63, 0
    s_nop 0
    buffer_load_dwordx4 v18, s[8:11], s60 offen lds
    s_add_u32 m0, s63, 1024
    s_nop 0
    buffer_load_dwordx4 v19, s[8:11], s60 offen lds
    s_add_u32 m0, s63, 2048
    s_nop 0
    buffer_load_dwordx4 v20, s[8:11], s60 offen lds
    s_add_u32 m0, s63, 3072
    s_nop 0
    buffer_load_dwordx4 v21, s[8:11], s60 offen lds
    s_add_u32 m0, s64, 16384
    s_nop 0
    buffer_load_dwordx4 v22, s[12:15], s61 offen lds
    s_add_u32 m0, s64, 17408
    s_nop 0
    buffer_load_dwordx4 v23, s[12:15], s61 offen lds
    s_add_u32 m0, s64, 18432
    s_nop 0
    buffer_load_dwordx4 v24, s[12:15], s61 offen lds
    s_add_u32 m0, s64, 19456
    s_nop 0
    buffer_load_dwordx4 v25, s[12:15], s61 offen lds
    s_add_u32 m0, s64, 20480
    s_nop 0
    buffer_load_dwordx4 v26, s[12:15], s61 offen lds
    s_add_u32 m0, s63, 4096
    s_nop 0
    buffer_load_dwordx4 v18, s[8:11], s77 offen lds
    s_add_u32 m0, s63, 5120
    s_nop 0
    buffer_load_dwordx4 v19, s[8:11], s77 offen lds
    s_add_u32 m0, s63, 6144
    s_nop 0
    buffer_load_dwordx4 v20, s[8:11], s77 offen lds
    s_add_u32 m0, s63, 7168
    s_nop 0
    buffer_load_dwordx4 v21, s[8:11], s77 offen lds
    s_add_u32 m0, s64, 21504
    s_nop 0
    buffer_load_dwordx4 v22, s[12:15], s49 offen lds
    s_add_u32 m0, s64, 22528
    s_nop 0
    buffer_load_dwordx4 v23, s[12:15], s49 offen lds
    s_add_u32 m0, s64, 23552
    s_nop 0
    buffer_load_dwordx4 v24, s[12:15], s49 offen lds
    s_add_u32 m0, s64, 24576
    s_nop 0
    buffer_load_dwordx4 v25, s[12:15], s49 offen lds
    s_add_u32 m0, s64, 25600
    s_nop 0
    buffer_load_dwordx4 v26, s[12:15], s49 offen lds
    s_add_u32 s60, s60, 128
    s_cmp_ge_u32 s60, s43
    s_cselect_b32 s69, 1280, 0
    s_sub_u32 s60, s60, s69
    s_add_u32 s77, s60, 40960
    s_add_u32 s61, s61, 245760
    s_cmp_ge_u32 s61, 2457600
    s_cselect_b32 s69, 2457600, 0
    s_sub_u32 s61, s61, s69
    s_add_u32 s49, s61, 61440
    s_waitcnt vmcnt(18) lgkmcnt(0)
    s_barrier
    s_add_u32 m0, s63, 45056
    s_nop 0
    buffer_load_dwordx4 v18, s[8:11], s60 offen lds
    s_add_u32 m0, s63, 46080
    s_nop 0
    buffer_load_dwordx4 v19, s[8:11], s60 offen lds
    s_add_u32 m0, s63, 47104
    s_nop 0
    buffer_load_dwordx4 v20, s[8:11], s60 offen lds
    s_add_u32 m0, s63, 48128
    s_nop 0
    buffer_load_dwordx4 v21, s[8:11], s60 offen lds
    s_add_u32 m0, s64, 61440
    s_nop 0
    buffer_load_dwordx4 v22, s[12:15], s61 offen lds
    s_add_u32 m0, s64, 62464
    s_nop 0
    buffer_load_dwordx4 v23, s[12:15], s61 offen lds
    s_add_u32 m0, s64, 63488
    s_nop 0
    buffer_load_dwordx4 v24, s[12:15], s61 offen lds
    s_add_u32 m0, s64, 64512
    s_nop 0
    buffer_load_dwordx4 v25, s[12:15], s61 offen lds
    s_add_u32 m0, s64, 65536
    s_nop 0
    buffer_load_dwordx4 v26, s[12:15], s61 offen lds
    s_add_u32 m0, s63, 49152
    s_nop 0
    buffer_load_dwordx4 v18, s[8:11], s77 offen lds
    s_add_u32 m0, s63, 50176
    s_nop 0
    buffer_load_dwordx4 v19, s[8:11], s77 offen lds
    s_add_u32 m0, s63, 51200
    s_nop 0
    buffer_load_dwordx4 v20, s[8:11], s77 offen lds
    s_add_u32 m0, s63, 52224
    s_nop 0
    buffer_load_dwordx4 v21, s[8:11], s77 offen lds
    s_add_u32 m0, s64, 66560
    s_nop 0
    buffer_load_dwordx4 v22, s[12:15], s49 offen lds
    s_add_u32 m0, s64, 67584
    s_nop 0
    buffer_load_dwordx4 v23, s[12:15], s49 offen lds
    s_add_u32 m0, s64, 68608
    s_nop 0
    buffer_load_dwordx4 v24, s[12:15], s49 offen lds
    s_add_u32 m0, s64, 69632
    s_nop 0
    buffer_load_dwordx4 v25, s[12:15], s49 offen lds
    s_add_u32 m0, s64, 70656
    s_nop 0
    buffer_load_dwordx4 v26, s[12:15], s49 offen lds
    s_add_u32 s60, s60, 128
    s_cmp_ge_u32 s60, s43
    s_cselect_b32 s69, 1280, 0
    s_sub_u32 s60, s60, s69
    s_add_u32 s77, s60, 40960
    s_add_u32 s61, s61, 245760
    s_cmp_ge_u32 s61, 2457600
    s_cselect_b32 s69, 2457600, 0
    s_sub_u32 s61, s61, s69
    s_add_u32 s49, s61, 61440
    s_waitcnt vmcnt(18) lgkmcnt(0)
    s_barrier
    s_add_u32 m0, s63, 90112
    s_nop 0
    buffer_load_dwordx4 v18, s[8:11], s60 offen lds
    s_add_u32 m0, s63, 91136
    s_nop 0
    buffer_load_dwordx4 v19, s[8:11], s60 offen lds
    s_add_u32 m0, s63, 92160
    s_nop 0
    buffer_load_dwordx4 v20, s[8:11], s60 offen lds
    s_add_u32 m0, s63, 93184
    s_nop 0
    buffer_load_dwordx4 v21, s[8:11], s60 offen lds
    s_add_u32 m0, s64, 106496
    s_nop 0
    buffer_load_dwordx4 v22, s[12:15], s61 offen lds
    s_add_u32 m0, s64, 107520
    s_nop 0
    buffer_load_dwordx4 v23, s[12:15], s61 offen lds
    s_add_u32 m0, s64, 108544
    s_nop 0
    buffer_load_dwordx4 v24, s[12:15], s61 offen lds
    s_add_u32 m0, s64, 109568
    s_nop 0
    buffer_load_dwordx4 v25, s[12:15], s61 offen lds
    s_add_u32 m0, s64, 110592
    s_nop 0
    buffer_load_dwordx4 v26, s[12:15], s61 offen lds
    s_add_u32 m0, s63, 94208
    s_nop 0
    buffer_load_dwordx4 v18, s[8:11], s77 offen lds
    s_add_u32 m0, s63, 95232
    s_nop 0
    buffer_load_dwordx4 v19, s[8:11], s77 offen lds
    s_add_u32 m0, s63, 96256
    s_nop 0
    buffer_load_dwordx4 v20, s[8:11], s77 offen lds
    s_add_u32 m0, s63, 97280
    s_nop 0
    buffer_load_dwordx4 v21, s[8:11], s77 offen lds
    s_add_u32 m0, s64, 111616
    s_nop 0
    buffer_load_dwordx4 v22, s[12:15], s49 offen lds
    s_add_u32 m0, s64, 112640
    s_nop 0
    buffer_load_dwordx4 v23, s[12:15], s49 offen lds
    s_add_u32 m0, s64, 113664
    s_nop 0
    buffer_load_dwordx4 v24, s[12:15], s49 offen lds
    s_add_u32 m0, s64, 114688
    s_nop 0
    buffer_load_dwordx4 v25, s[12:15], s49 offen lds
    s_add_u32 m0, s64, 115712
    s_nop 0
    buffer_load_dwordx4 v26, s[12:15], s49 offen lds
    s_add_u32 s60, s60, 128
    s_cmp_ge_u32 s60, s43
    s_cselect_b32 s69, 1280, 0
    s_sub_u32 s60, s60, s69
    s_add_u32 s77, s60, 40960
    s_add_u32 s61, s61, 245760
    s_cmp_ge_u32 s61, 2457600
    s_cselect_b32 s69, 2457600, 0
    s_sub_u32 s61, s61, s69
    s_add_u32 s49, s61, 61440
    s_waitcnt vmcnt(18) lgkmcnt(0)
    s_barrier
    s_add_u32 m0, s63, 0
    s_nop 0
    buffer_load_dwordx4 v18, s[8:11], s60 offen lds
    s_add_u32 m0, s63, 1024
    s_nop 0
    buffer_load_dwordx4 v19, s[8:11], s60 offen lds
    s_add_u32 m0, s63, 2048
    s_nop 0
    buffer_load_dwordx4 v20, s[8:11], s60 offen lds
    s_add_u32 m0, s63, 3072
    s_nop 0
    buffer_load_dwordx4 v21, s[8:11], s60 offen lds
    s_add_u32 m0, s64, 16384
    s_nop 0
    buffer_load_dwordx4 v22, s[12:15], s61 offen lds
    s_add_u32 m0, s64, 17408
    s_nop 0
    buffer_load_dwordx4 v23, s[12:15], s61 offen lds
    s_add_u32 m0, s64, 18432
    s_nop 0
    buffer_load_dwordx4 v24, s[12:15], s61 offen lds
    s_add_u32 m0, s64, 19456
    s_nop 0
    buffer_load_dwordx4 v25, s[12:15], s61 offen lds
    s_add_u32 m0, s64, 20480
    s_nop 0
    buffer_load_dwordx4 v26, s[12:15], s61 offen lds
    s_add_u32 m0, s63, 4096
    s_nop 0
    buffer_load_dwordx4 v18, s[8:11], s77 offen lds
    s_add_u32 m0, s63, 5120
    s_nop 0
    buffer_load_dwordx4 v19, s[8:11], s77 offen lds
    s_add_u32 m0, s63, 6144
    s_nop 0
    buffer_load_dwordx4 v20, s[8:11], s77 offen lds
    s_add_u32 m0, s63, 7168
    s_nop 0
    buffer_load_dwordx4 v21, s[8:11], s77 offen lds
    s_add_u32 m0, s64, 21504
    s_nop 0
    buffer_load_dwordx4 v22, s[12:15], s49 offen lds
    s_add_u32 m0, s64, 22528
    s_nop 0
    buffer_load_dwordx4 v23, s[12:15], s49 offen lds
    s_add_u32 m0, s64, 23552
    s_nop 0
    buffer_load_dwordx4 v24, s[12:15], s49 offen lds
    s_add_u32 m0, s64, 24576
    s_nop 0
    buffer_load_dwordx4 v25, s[12:15], s49 offen lds
    s_add_u32 m0, s64, 25600
    s_nop 0
    buffer_load_dwordx4 v26, s[12:15], s49 offen lds
    s_add_u32 s60, s60, 128
    s_cmp_ge_u32 s60, s43
    s_cselect_b32 s69, 1280, 0
    s_sub_u32 s60, s60, s69
    s_add_u32 s77, s60, 40960
    s_add_u32 s61, s61, 245760
    s_cmp_ge_u32 s61, 2457600
    s_cselect_b32 s69, 2457600, 0
    s_sub_u32 s61, s61, s69
    s_add_u32 s49, s61, 61440
    s_waitcnt vmcnt(18) lgkmcnt(0)
    s_barrier
    s_waitcnt vmcnt(0) lgkmcnt(0)
    s_barrier
    s_barrier
    buffer_load_dword v8, v46, s[20:23], 0 offen sc1
    s_waitcnt vmcnt(0)
    v_cmp_lt_u32 vcc, v8, v47
    s_mov_b32 s82, 0
    s_nop 3
    s_cbranch_vccz L_okLKV1
L_spLKV1:
    s_sleep 4
    buffer_load_dword v8, v46, s[20:23], 0 offen sc1
    s_waitcnt vmcnt(0)
    v_cmp_lt_u32 vcc, v8, v47
    s_add_u32 s82, s82, 1
    s_cmp_lt_u32 s82, 0x40000
    s_cselect_b64 s[94:95], -1, 0
    s_and_b64 vcc, vcc, s[94:95]
    s_cbranch_vccnz L_spLKV1
L_okLKV1:
    s_mul_i32 s92, s50, 40960
    s_add_u32 s92, s92, s79
    s_add_u32 m0, s57, 49152
    s_nop 0
    buffer_load_dwordx4 v5, s[20:23], s92 offen offset:0 sc1 lds
    buffer_load_dwordx4 v5, s[20:23], s92 offen offset:1024 sc1 lds
    buffer_load_dwordx4 v5, s[20:23], s92 offen offset:2048 sc1 lds
    buffer_load_dwordx4 v5, s[20:23], s92 offen offset:3072 sc1 lds
    s_add_u32 m0, s57, 53248
    s_nop 0
    buffer_load_dwordx4 v6, s[20:23], s92 offen offset:0 sc1 lds
    buffer_load_dwordx4 v6, s[20:23], s92 offen offset:1024 sc1 lds
    s_add_u32 s92, s92, 10240
    s_add_u32 m0, s57, 59392
    s_nop 0
    buffer_load_dwordx4 v5, s[20:23], s92 offen offset:0 sc1 lds
    buffer_load_dwordx4 v5, s[20:23], s92 offen offset:1024 sc1 lds
    buffer_load_dwordx4 v5, s[20:23], s92 offen offset:2048 sc1 lds
    buffer_load_dwordx4 v5, s[20:23], s92 offen offset:3072 sc1 lds
    s_add_u32 m0, s57, 63488
    s_nop 0
    buffer_load_dwordx4 v6, s[20:23], s92 offen offset:0 sc1 lds
    buffer_load_dwordx4 v6, s[20:23], s92 offen offset:1024 sc1 lds
    s_add_u32 s50, s50, 1
    s_mul_i32 s92, s50, 40960
    s_add_u32 s92, s92, s79
    s_add_u32 m0, s57, 94208
    s_nop 0
    buffer_load_dwordx4 v5, s[20:23], s92 offen offset:0 sc1 lds
    buffer_load_dwordx4 v5, s[20:23], s92 offen offset:1024 sc1 lds
    buffer_load_dwordx4 v5, s[20:23], s92 offen offset:2048 sc1 lds
    buffer_load_dwordx4 v5, s[20:23], s92 offen offset:3072 sc1 lds
    s_add_u32 m0, s57, 98304
    s_nop 0
    buffer_load_dwordx4 v6, s[20:23], s92 offen offset:0 sc1 lds
    buffer_load_dwordx4 v6, s[20:23], s92 offen offset:1024 sc1 lds
    s_add_u32 s92, s92, 10240
    s_add_u32 m0, s57, 104448
    s_nop 0
    buffer_load_dwordx4 v5, s[20:23], s92 offen offset:0 sc1 lds
    buffer_load_dwordx4 v5, s[20:23], s92 offen offset:1024 sc1 lds
    buffer_load_dwordx4 v5, s[20:23], s92 offen offset:2048 sc1 lds
    buffer_load_dwordx4 v5, s[20:23], s92 offen offset:3072 sc1 lds
    s_add_u32 m0, s57, 108544
    s_nop 0
    buffer_load_dwordx4 v6, s[20:23], s92 offen offset:0 sc1 lds
    buffer_load_dwordx4 v6, s[20:23], s92 offen offset:1024 sc1 lds
    s_add_u32 s50, s50, 1
    buffer_load_dword v8, v48, s[20:23], 0 offen sc1
    s_barrier
    s_waitcnt vmcnt(0)
    v_cmp_lt_u32 vcc, v8, v49
    s_mov_b32 s82, 0
    s_nop 3
    s_cbranch_vccz L_okLKV2
L_spLKV2:
    s_sleep 4
    buffer_load_dword v8, v48, s[20:23], 0 offen sc1
    s_waitcnt vmcnt(0)
    v_cmp_lt_u32 vcc, v8, v49
    s_add_u32 s82, s82, 1
    s_cmp_lt_u32 s82, 0x40000
    s_cselect_b64 s[94:95], -1, 0
    s_and_b64 vcc, vcc, s[94:95]
    s_cbranch_vccnz L_spLKV2
L_okLKV2:
    s_lshl_b32 s91, s47, 14
    s_add_u32 s91, s91, s76
    s_add_u32 m0, s57, 45056
    s_nop 0
    buffer_load_dwordx4 v5, s[20:23], s91 offen offset:0 sc1 lds
    buffer_load_dwordx4 v5, s[20:23], s91 offen offset:1024 sc1 lds
    buffer_load_dwordx4 v5, s[20:23], s91 offen offset:2048 sc1 lds
    buffer_load_dwordx4 v5, s[20:23], s91 offen offset:3072 sc1 lds
    s_add_u32 m0, s57, 55296
    s_nop 0
    buffer_load_dwordx4 v6, s[20:23], s91 offen offset:0 sc1 lds
    buffer_load_dwordx4 v6, s[20:23], s91 offen offset:1024 sc1 lds
    buffer_load_dwordx4 v6, s[20:23], s91 offen offset:2048 sc1 lds
    buffer_load_dwordx4 v6, s[20:23], s91 offen offset:3072 sc1 lds
    s_add_u32 s47, s47, 1
    s_lshl_b32 s91, s47, 14
    s_add_u32 s91, s91, s76
    s_add_u32 m0, s57, 90112
    s_nop 0
    buffer_load_dwordx4 v5, s[20:23], s91 offen offset:0 sc1 lds
    buffer_load_dwordx4 v5, s[20:23], s91 offen offset:1024 sc1 lds
    buffer_load_dwordx4 v5, s[20:23], s91 offen offset:2048 sc1 lds
    buffer_load_dwordx4 v5, s[20:23], s91 offen offset:3072 sc1 lds
    s_add_u32 m0, s57, 100352
    s_nop 0
    buffer_load_dwordx4 v6, s[20:23], s91 offen offset:0 sc1 lds
    buffer_load_dwordx4 v6, s[20:23], s91 offen offset:1024 sc1 lds
    buffer_load_dwordx4 v6, s[20:23], s91 offen offset:2048 sc1 lds
    buffer_load_dwordx4 v6, s[20:23], s91 offen offset:3072 sc1 lds
    s_add_u32 s47, s47, 1
    s_waitcnt vmcnt(8)
    s_barrier
    s_lshl_b32 s91, s47, 14
    s_add_u32 s91, s91, s76
    s_add_u32 m0, s57, 0
    s_nop 0
    buffer_load_dwordx4 v5, s[20:23], s91 offen offset:0 sc1 lds
    buffer_load_dwordx4 v5, s[20:23], s91 offen offset:1024 sc1 lds
    buffer_load_dwordx4 v5, s[20:23], s91 offen offset:2048 sc1 lds
    buffer_load_dwordx4 v5, s[20:23], s91 offen offset:3072 sc1 lds
    s_add_u32 m0, s57, 10240
    s_nop 0
    buffer_load_dwordx4 v6, s[20:23], s91 offen offset:0 sc1 lds
    buffer_load_dwordx4 v6, s[20:23], s91 offen offset:1024 sc1 lds
    buffer_load_dwordx4 v6, s[20:23], s91 offen offset:2048 sc1 lds
    buffer_load_dwordx4 v6, s[20:23], s91 offen offset:3072 sc1 lds
    s_add_u32 s47, s47, 1
    s_mul_i32 s92, s50, 40960
    s_add_u32 s92, s92, s79
    s_add_u32 m0, s57, 4096
    s_nop 0
    buffer_load_dwordx4 v5, s[20:23], s92 offen offset:0 sc1 lds
    buffer_load_dwordx4 v5, s[20:23], s92 offen offset:1024 sc1 lds
    buffer_load_dwordx4 v5, s[20:23], s92 offen offset:2048 sc1 lds
    buffer_load_dwordx4 v5, s[20:23], s92 offen offset:3072 sc1 lds
    s_add_u32 m0, s57, 8192
    s_nop 0
    buffer_load_dwordx4 v6, s[20:23], s92 offen offset:0 sc1 lds
    buffer_load_dwordx4 v6, s[20:23], s92 offen offset:1024 sc1 lds
    s_add_u32 s92, s92, 10240
    s_add_u32 m0, s57, 14336
    s_nop 0
    buffer_load_dwordx4 v5, s[20:23], s92 offen offset:0 sc1 lds
    buffer_load_dwordx4 v5, s[20:23], s92 offen offset:1024 sc1 lds
    buffer_load_dwordx4 v5, s[20:23], s92 offen offset:2048 sc1 lds
    buffer_load_dwordx4 v5, s[20:23], s92 offen offset:3072 sc1 lds
    s_add_u32 m0, s57, 18432
    s_nop 0
    buffer_load_dwordx4 v6, s[20:23], s92 offen offset:0 sc1 lds
    buffer_load_dwordx4 v6, s[20:23], s92 offen offset:1024 sc1 lds
    s_add_u32 s50, s50, 1
    s_waitcnt vmcnt(20)
    s_barrier
    s_lshl_b32 s91, s47, 14
    s_add_u32 s91, s91, s76
    s_add_u32 m0, s57, 45056
    s_nop 0
    buffer_load_dwordx4 v5, s[20:23], s91 offen offset:0 sc1 lds
    buffer_load_dwordx4 v5, s[20:23], s91 offen offset:1024 sc1 lds
    buffer_load_dwordx4 v5, s[20:23], s91 offen offset:2048 sc1 lds
    buffer_load_dwordx4 v5, s[20:23], s91 offen offset:3072 sc1 lds
    s_add_u32 m0, s57, 55296
    s_nop 0
    buffer_load_dwordx4 v6, s[20:23], s91 offen offset:0 sc1 lds
    buffer_load_dwordx4 v6, s[20:23], s91 offen offset:1024 sc1 lds
    buffer_load_dwordx4 v6, s[20:23], s91 offen offset:2048 sc1 lds
    buffer_load_dwordx4 v6, s[20:23], s91 offen offset:3072 sc1 lds
    s_add_u32 s47, s47, 1
    s_mul_i32 s92, s50, 40960
    s_add_u32 s92, s92, s79
    s_add_u32 m0, s57, 49152
    s_nop 0
    buffer_load_dwordx4 v5, s[20:23], s92 offen offset:0 sc1 lds
    buffer_load_dwordx4 v5, s[20:23], s92 offen offset:1024 sc1 lds
    buffer_load_dwordx4 v5, s[20:23], s92 offen offset:2048 sc1 lds
    buffer_load_dwordx4 v5, s[20:23], s92 offen offset:3072 sc1 lds
    s_add_u32 m0, s57, 53248
    s_nop 0
    buffer_load_dwordx4 v6, s[20:23], s92 offen offset:0 sc1 lds
    buffer_load_dwordx4 v6, s[20:23], s92 offen offset:1024 sc1 lds
    s_add_u32 s92, s92, 10240
    s_add_u32 m0, s57, 59392
    s_nop 0
    buffer_load_dwordx4 v5, s[20:23], s92 offen offset:0 sc1 lds
    buffer_load_dwordx4 v5, s[20:23], s92 offen offset:1024 sc1 lds
    buffer_load_dwordx4 v5, s[20:23], s92 offen offset:2048 sc1 lds
    buffer_load_dwordx4 v5, s[20:23], s92 offen offset:3072 sc1 lds
    s_add_u32 m0, s57, 63488
    s_nop 0
    buffer_load_dwordx4 v6, s[20:23], s92 offen offset:0 sc1 lds
    buffer_load_dwordx4 v6, s[20:23], s92 offen offset:1024 sc1 lds
    s_add_u32 s50, s50, 1
    s_waitcnt vmcnt(20)
    s_barrier
    s_lshl_b32 s91, s47, 14
    s_add_u32 s91, s91, s76
    s_add_u32 m0, s57, 90112
    s_nop 0
    buffer_load_dwordx4 v5, s[20:23], s91 offen offset:0 sc1 lds
    buffer_load_dwordx4 v5, s[20:23], s91 offen offset:1024 sc1 lds
    buffer_load_dwordx4 v5, s[20:23], s91 offen offset:2048 sc1 lds
    buffer_load_dwordx4 v5, s[20:23], s91 offen offset:3072 sc1 lds
    s_add_u32 m0, s57, 100352
    s_nop 0
    buffer_load_dwordx4 v6, s[20:23], s91 offen offset:0 sc1 lds
    buffer_load_dwordx4 v6, s[20:23], s91 offen offset:1024 sc1 lds
    buffer_load_dwordx4 v6, s[20:23], s91 offen offset:2048 sc1 lds
    buffer_load_dwordx4 v6, s[20:23], s91 offen offset:3072 sc1 lds
    s_add_u32 s47, s47, 1
    s_mul_i32 s92, s50, 40960
    s_add_u32 s92, s92, s79
    s_add_u32 m0, s57, 94208
    s_nop 0
    buffer_load_dwordx4 v5, s[20:23], s92 offen offset:0 sc1 lds
    buffer_load_dwordx4 v5, s[20:23], s92 offen offset:1024 sc1 lds
    buffer_load_dwordx4 v5, s[20:23], s92 offen offset:2048 sc1 lds
    buffer_load_dwordx4 v5, s[20:23], s92 offen offset:3072 sc1 lds
    s_add_u32 m0, s57, 98304
    s_nop 0
    buffer_load_dwordx4 v6, s[20:23], s92 offen offset:0 sc1 lds
    buffer_load_dwordx4 v6, s[20:23], s92 offen offset:1024 sc1 lds
    s_add_u32 s92, s92, 10240
    s_add_u32 m0, s57, 104448
    s_nop 0
    buffer_load_dwordx4 v5, s[20:23], s92 offen offset:0 sc1 lds
    buffer_load_dwordx4 v5, s[20:23], s92 offen offset:1024 sc1 lds
    buffer_load_dwordx4 v5, s[20:23], s92 offen offset:2048 sc1 lds
    buffer_load_dwordx4 v5, s[20:23], s92 offen offset:3072 sc1 lds
    s_add_u32 m0, s57, 108544
    s_nop 0
    buffer_load_dwordx4 v6, s[20:23], s92 offen offset:0 sc1 lds
    buffer_load_dwordx4 v6, s[20:23], s92 offen offset:1024 sc1 lds
    s_add_u32 s50, s50, 1
    s_waitcnt vmcnt(20)
    s_barrier
    s_lshl_b32 s91, s47, 14
    s_add_u32 s91, s91, s76
    s_add_u32 m0, s57, 0
    s_nop 0
    buffer_load_dwordx4 v5, s[20:23], s91 offen offset:0 sc1 lds
    buffer_load_dwordx4 v5, s[20:23], s91 offen offset:1024 sc1 lds
    buffer_load_dwordx4 v5, s[20:23], s91 offen offset:2048 sc1 lds
    buffer_load_dwordx4 v5, s[20:23], s91 offen offset:3072 sc1 lds
    s_add_u32 m0, s57, 10240
    s_nop 0
    buffer_load_dwordx4 v6, s[20:23], s91 offen offset:0 sc1 lds
    buffer_load_dwordx4 v6, s[20:23], s91 offen offset:1024 sc1 lds
    buffer_load_dwordx4 v6, s[20:23], s91 offen offset:2048 sc1 lds
    buffer_load_dwordx4 v6, s[20:23], s91 offen offset:3072 sc1 lds
    s_add_u32 s47, s47, 1
    s_mul_i32 s92, s50, 40960
    s_add_u32 s92, s92, s79
    s_add_u32 m0, s57, 4096
    s_nop 0
    buffer_load_dwordx4 v5, s[20:23], s92 offen offset:0 sc1 lds
    buffer_load_dwordx4 v5, s[20:23], s92 offen offset:1024 sc1 lds
    buffer_load_dwordx4 v5, s[20:23], s92 offen offset:2048 sc1 lds
    buffer_load_dwordx4 v5, s[20:23], s92 offen offset:3072 sc1 lds
    s_add_u32 m0, s57, 8192
    s_nop 0
    buffer_load_dwordx4 v6, s[20:23], s92 offen offset:0 sc1 lds
    buffer_load_dwordx4 v6, s[20:23], s92 offen offset:1024 sc1 lds
    s_add_u32 s92, s92, 10240
    s_add_u32 m0, s57, 14336
    s_nop 0
    buffer_load_dwordx4 v5, s[20:23], s92 offen offset:0 sc1 lds
    buffer_load_dwordx4 v5, s[20:23], s92 offen offset:1024 sc1 lds
    buffer_load_dwordx4 v5, s[20:23], s92 offen offset:2048 sc1 lds
    buffer_load_dwordx4 v5, s[20:23], s92 offen offset:3072 sc1 lds
    s_add_u32 m0, s57, 18432
    s_nop 0
    buffer_load_dwordx4 v6, s[20:23], s92 offen offset:0 sc1 lds
    buffer_load_dwordx4 v6, s[20:23], s92 offen offset:1024 sc1 lds
    s_add_u32 s50, s50, 1
    s_waitcnt vmcnt(20)
    s_barrier
    s_lshl_b32 s91, s47, 14
    s_add_u32 s91, s91, s76
    s_add_u32 m0, s57, 45056
    s_nop 0
    buffer_load_dwordx4 v5, s[20:23], s91 offen offset:0 sc1 lds
    buffer_load_dwordx4 v5, s[20:23], s91 offen offset:1024 sc1 lds
    buffer_load_dwordx4 v5, s[20:23], s91 offen offset:2048 sc1 lds
    buffer_load_dwordx4 v5, s[20:23], s91 offen offset:3072 sc1 lds
    s_add_u32 m0, s57, 55296
    s_nop 0
    buffer_load_dwordx4 v6, s[20:23], s91 offen offset:0 sc1 lds
    buffer_load_dwordx4 v6, s[20:23], s91 offen offset:1024 sc1 lds
    buffer_load_dwordx4 v6, s[20:23], s91 offen offset:2048 sc1 lds
    buffer_load_dwordx4 v6, s[20:23], s91 offen offset:3072 sc1 lds
    s_add_u32 s47, s47, 1
    s_mul_i32 s92, s50, 40960
    s_add_u32 s92, s92, s79
    s_add_u32 m0, s57, 49152
    s_nop 0
    buffer_load_dwordx4 v5, s[20:23], s92 offen offset:0 sc1 lds
    buffer_load_dwordx4 v5, s[20:23], s92 offen offset:1024 sc1 lds
    buffer_load_dwordx4 v5, s[20:23], s92 offen offset:2048 sc1 lds
    buffer_load_dwordx4 v5, s[20:23], s92 offen offset:3072 sc1 lds
    s_add_u32 m0, s57, 53248
    s_nop 0
    buffer_load_dwordx4 v6, s[20:23], s92 offen offset:0 sc1 lds
    buffer_load_dwordx4 v6, s[20:23], s92 offen offset:1024 sc1 lds
    s_add_u32 s92, s92, 10240
    s_add_u32 m0, s57, 59392
    s_nop 0
    buffer_load_dwordx4 v5, s[20:23], s92 offen offset:0 sc1 lds
    buffer_load_dwordx4 v5, s[20:23], s92 offen offset:1024 sc1 lds
    buffer_load_dwordx4 v5, s[20:23], s92 offen offset:2048 sc1 lds
    buffer_load_dwordx4 v5, s[20:23], s92 offen offset:3072 sc1 lds
    s_add_u32 m0, s57, 63488
    s_nop 0
    buffer_load_dwordx4 v6, s[20:23], s92 offen offset:0 sc1 lds
    buffer_load_dwordx4 v6, s[20:23], s92 offen offset:1024 sc1 lds
    s_add_u32 s50, s50, 1
    s_waitcnt vmcnt(20)
    s_barrier
    s_lshl_b32 s91, s47, 14
    s_add_u32 s91, s91, s76
    s_add_u32 m0, s57, 90112
    s_nop 0
    buffer_load_dwordx4 v5, s[20:23], s91 offen offset:0 sc1 lds
    buffer_load_dwordx4 v5, s[20:23], s91 offen offset:1024 sc1 lds
    buffer_load_dwordx4 v5, s[20:23], s91 offen offset:2048 sc1 lds
    buffer_load_dwordx4 v5, s[20:23], s91 offen offset:3072 sc1 lds
    s_add_u32 m0, s57, 100352
    s_nop 0
    buffer_load_dwordx4 v6, s[20:23], s91 offen offset:0 sc1 lds
    buffer_load_dwordx4 v6, s[20:23], s91 offen offset:1024 sc1 lds
    buffer_load_dwordx4 v6, s[20:23], s91 offen offset:2048 sc1 lds
    buffer_load_dwordx4 v6, s[20:23], s91 offen offset:3072 sc1 lds
    s_add_u32 s47, s47, 1
    s_mul_i32 s92, s50, 40960
    s_add_u32 s92, s92, s79
    s_add_u32 m0, s57, 94208
    s_nop 0
    buffer_load_dwordx4 v5, s[20:23], s92 offen offset:0 sc1 lds
    buffer_load_dwordx4 v5, s[20:23], s92 offen offset:1024 sc1 lds
    buffer_load_dwordx4 v5, s[20:23], s92 offen offset:2048 sc1 lds
    buffer_load_dwordx4 v5, s[20:23], s92 offen offset:3072 sc1 lds
    s_add_u32 m0, s57, 98304
    s_nop 0
    buffer_load_dwordx4 v6, s[20:23], s92 offen offset:0 sc1 lds
    buffer_load_dwordx4 v6, s[20:23], s92 offen offset:1024 sc1 lds
    s_add_u32 s92, s92, 10240
    s_add_u32 m0, s57, 104448
    s_nop 0
    buffer_load_dwordx4 v5, s[20:23], s92 offen offset:0 sc1 lds
    buffer_load_dwordx4 v5, s[20:23], s92 offen offset:1024 sc1 lds
    buffer_load_dwordx4 v5, s[20:23], s92 offen offset:2048 sc1 lds
    buffer_load_dwordx4 v5, s[20:23], s92 offen offset:3072 sc1 lds
    s_add_u32 m0, s57, 108544
    s_nop 0
    buffer_load_dwordx4 v6, s[20:23], s92 offen offset:0 sc1 lds
    buffer_load_dwordx4 v6, s[20:23], s92 offen offset:1024 sc1 lds
    s_add_u32 s50, s50, 1
    s_waitcnt vmcnt(20)
    s_barrier
    s_lshl_b32 s91, s47, 14
    s_add_u32 s91, s91, s76
    s_add_u32 m0, s57, 0
    s_nop 0
    buffer_load_dwordx4 v5, s[20:23], s91 offen offset:0 sc1 lds
    buffer_load_dwordx4 v5, s[20:23], s91 offen offset:1024 sc1 lds
    buffer_load_dwordx4 v5, s[20:23], s91 offen offset:2048 sc1 lds
    buffer_load_dwordx4 v5, s[20:23], s91 offen offset:3072 sc1 lds
    s_add_u32 m0, s57, 10240
    s_nop 0
    buffer_load_dwordx4 v6, s[20:23], s91 offen offset:0 sc1 lds
    buffer_load_dwordx4 v6, s[20:23], s91 offen offset:1024 sc1 lds
    buffer_load_dwordx4 v6, s[20:23], s91 offen offset:2048 sc1 lds
    buffer_load_dwordx4 v6, s[20:23], s91 offen offset:3072 sc1 lds
    s_add_u32 s47, s47, 1
    s_mul_i32 s92, s50, 40960
    s_add_u32 s92, s92, s79
    s_add_u32 m0, s57, 4096
    s_nop 0
    buffer_load_dwordx4 v5, s[20:23], s92 offen offset:0 sc1 lds
    buffer_load_dwordx4 v5, s[20:23], s92 offen offset:1024 sc1 lds
    buffer_load_dwordx4 v5, s[20:23], s92 offen offset:2048 sc1 lds
    buffer_load_dwordx4 v5, s[20:23], s92 offen offset:3072 sc1 lds
    s_add_u32 m0, s57, 8192
    s_nop 0
    buffer_load_dwordx4 v6, s[20:23], s92 offen offset:0 sc1 lds
    buffer_load_dwordx4 v6, s[20:23], s92 offen offset:1024 sc1 lds
    s_add_u32 s92, s92, 10240
    s_add_u32 m0, s57, 14336
    s_nop 0
    buffer_load_dwordx4 v5, s[20:23], s92 offen offset:0 sc1 lds
    buffer_load_dwordx4 v5, s[20:23], s92 offen offset:1024 sc1 lds
    buffer_load_dwordx4 v5, s[20:23], s92 offen offset:2048 sc1 lds
    buffer_load_dwordx4 v5, s[20:23], s92 offen offset:3072 sc1 lds
    s_add_u32 m0, s57, 18432
    s_nop 0
    buffer_load_dwordx4 v6, s[20:23], s92 offen offset:0 sc1 lds
    buffer_load_dwordx4 v6, s[20:23], s92 offen offset:1024 sc1 lds
    s_add_u32 s50, s50, 1
    s_waitcnt vmcnt(20)
    s_barrier
    s_lshl_b32 s91, s47, 14
    s_add_u32 s91, s91, s76
    s_add_u32 m0, s57, 45056
    s_nop 0
    buffer_load_dwordx4 v5, s[20:23], s91 offen offset:0 sc1 lds
    buffer_load_dwordx4 v5, s[20:23], s91 offen offset:1024 sc1 lds
    buffer_load_dwordx4 v5, s[20:23], s91 offen offset:2048 sc1 lds
    buffer_load_dwordx4 v5, s[20:23], s91 offen offset:3072 sc1 lds
    s_add_u32 m0, s57, 55296
    s_nop 0
    buffer_load_dwordx4 v6, s[20:23], s91 offen offset:0 sc1 lds
    buffer_load_dwordx4 v6, s[20:23], s91 offen offset:1024 sc1 lds
    buffer_load_dwordx4 v6, s[20:23], s91 offen offset:2048 sc1 lds
    buffer_load_dwordx4 v6, s[20:23], s91 offen offset:3072 sc1 lds
    s_add_u32 s47, s47, 1
    s_mul_i32 s92, s50, 40960
    s_add_u32 s92, s92, s79
    s_add_u32 m0, s57, 49152
    s_nop 0
    buffer_load_dwordx4 v5, s[20:23], s92 offen offset:0 sc1 lds
    buffer_load_dwordx4 v5, s[20:23], s92 offen offset:1024 sc1 lds
    buffer_load_dwordx4 v5, s[20:23], s92 offen offset:2048 sc1 lds
    buffer_load_dwordx4 v5, s[20:23], s92 offen offset:3072 sc1 lds
    s_add_u32 m0, s57, 53248
    s_nop 0
    buffer_load_dwordx4 v6, s[20:23], s92 offen offset:0 sc1 lds
    buffer_load_dwordx4 v6, s[20:23], s92 offen offset:1024 sc1 lds
    s_add_u32 s92, s92, 10240
    s_add_u32 m0, s57, 59392
    s_nop 0
    buffer_load_dwordx4 v5, s[20:23], s92 offen offset:0 sc1 lds
    buffer_load_dwordx4 v5, s[20:23], s92 offen offset:1024 sc1 lds
    buffer_load_dwordx4 v5, s[20:23], s92 offen offset:2048 sc1 lds
    buffer_load_dwordx4 v5, s[20:23], s92 offen offset:3072 sc1 lds
    s_add_u32 m0, s57, 63488
    s_nop 0
    buffer_load_dwordx4 v6, s[20:23], s92 offen offset:0 sc1 lds
    buffer_load_dwordx4 v6, s[20:23], s92 offen offset:1024 sc1 lds
    s_add_u32 s50, s50, 1
    s_waitcnt vmcnt(20)
    s_barrier
    s_lshl_b32 s91, s47, 14
    s_add_u32 s91, s91, s76
    s_add_u32 m0, s57, 90112
    s_nop 0
    buffer_load_dwordx4 v5, s[20:23], s91 offen offset:0 sc1 lds
    buffer_load_dwordx4 v5, s[20:23], s91 offen offset:1024 sc1 lds
    buffer_load_dwordx4 v5, s[20:23], s91 offen offset:2048 sc1 lds
    buffer_load_dwordx4 v5, s[20:23], s91 offen offset:3072 sc1 lds
    s_add_u32 m0, s57, 100352
    s_nop 0
    buffer_load_dwordx4 v6, s[20:23], s91 offen offset:0 sc1 lds
    buffer_load_dwordx4 v6, s[20:23], s91 offen offset:1024 sc1 lds
    buffer_load_dwordx4 v6, s[20:23], s91 offen offset:2048 sc1 lds
    buffer_load_dwordx4 v6, s[20:23], s91 offen offset:3072 sc1 lds
    s_add_u32 s47, s47, 1
    s_mul_i32 s92, s50, 40960
    s_add_u32 s92, s92, s79
    s_add_u32 m0, s57, 94208
    s_nop 0
    buffer_load_dwordx4 v5, s[20:23], s92 offen offset:0 sc1 lds
    buffer_load_dwordx4 v5, s[20:23], s92 offen offset:1024 sc1 lds
    buffer_load_dwordx4 v5, s[20:23], s92 offen offset:2048 sc1 lds
    buffer_load_dwordx4 v5, s[20:23], s92 offen offset:3072 sc1 lds
    s_add_u32 m0, s57, 98304
    s_nop 0
    buffer_load_dwordx4 v6, s[20:23], s92 offen offset:0 sc1 lds
    buffer_load_dwordx4 v6, s[20:23], s92 offen offset:1024 sc1 lds
    s_add_u32 s92, s92, 10240
    s_add_u32 m0, s57, 104448
    s_nop 0
    buffer_load_dwordx4 v5, s[20:23], s92 offen offset:0 sc1 lds
    buffer_load_dwordx4 v5, s[20:23], s92 offen offset:1024 sc1 lds
    buffer_load_dwordx4 v5, s[20:23], s92 offen offset:2048 sc1 lds
    buffer_load_dwordx4 v5, s[20:23], s92 offen offset:3072 sc1 lds
    s_add_u32 m0, s57, 108544
    s_nop 0
    buffer_load_dwordx4 v6, s[20:23], s92 offen offset:0 sc1 lds
    buffer_load_dwordx4 v6, s[20:23], s92 offen offset:1024 sc1 lds
    s_add_u32 s50, s50, 1
    s_waitcnt vmcnt(20)
    s_barrier
    s_lshl_b32 s91, s47, 14
    s_add_u32 s91, s91, s76
    s_add_u32 m0, s57, 0
    s_nop 0
    buffer_load_dwordx4 v5, s[20:23], s91 offen offset:0 sc1 lds
    buffer_load_dwordx4 v5, s[20:23], s91 offen offset:1024 sc1 lds
    buffer_load_dwordx4 v5, s[20:23], s91 offen offset:2048 sc1 lds
    buffer_load_dwordx4 v5, s[20:23], s91 offen offset:3072 sc1 lds
    s_add_u32 m0, s57, 10240
    s_nop 0
    buffer_load_dwordx4 v6, s[20:23], s91 offen offset:0 sc1 lds
    buffer_load_dwordx4 v6, s[20:23], s91 offen offset:1024 sc1 lds
    buffer_load_dwordx4 v6, s[20:23], s91 offen offset:2048 sc1 lds
    buffer_load_dwordx4 v6, s[20:23], s91 offen offset:3072 sc1 lds
    s_add_u32 s47, s47, 1
    s_mul_i32 s92, s50, 40960
    s_add_u32 s92, s92, s79
    s_add_u32 m0, s57, 4096
    s_nop 0
    buffer_load_dwordx4 v5, s[20:23], s92 offen offset:0 sc1 lds
    buffer_load_dwordx4 v5, s[20:23], s92 offen offset:1024 sc1 lds
    buffer_load_dwordx4 v5, s[20:23], s92 offen offset:2048 sc1 lds
    buffer_load_dwordx4 v5, s[20:23], s92 offen offset:3072 sc1 lds
    s_add_u32 m0, s57, 8192
    s_nop 0
    buffer_load_dwordx4 v6, s[20:23], s92 offen offset:0 sc1 lds
    buffer_load_dwordx4 v6, s[20:23], s92 offen offset:1024 sc1 lds
    s_add_u32 s92, s92, 10240
    s_add_u32 m0, s57, 14336
    s_nop 0
    buffer_load_dwordx4 v5, s[20:23], s92 offen offset:0 sc1 lds
    buffer_load_dwordx4 v5, s[20:23], s92 offen offset:1024 sc1 lds
    buffer_load_dwordx4 v5, s[20:23], s92 offen offset:2048 sc1 lds
    buffer_load_dwordx4 v5, s[20:23], s92 offen offset:3072 sc1 lds
    s_add_u32 m0, s57, 18432
    s_nop 0
    buffer_load_dwordx4 v6, s[20:23], s92 offen offset:0 sc1 lds
    buffer_load_dwordx4 v6, s[20:23], s92 offen offset:1024 sc1 lds
    s_add_u32 s50, s50, 1
    s_waitcnt vmcnt(20)
    s_barrier
    s_lshl_b32 s91, s47, 14
    s_add_u32 s91, s91, s76
    s_add_u32 m0, s57, 45056
    s_nop 0
    buffer_load_dwordx4 v5, s[20:23], s91 offen offset:0 sc1 lds
    buffer_load_dwordx4 v5, s[20:23], s91 offen offset:1024 sc1 lds
    buffer_load_dwordx4 v5, s[20:23], s91 offen offset:2048 sc1 lds
    buffer_load_dwordx4 v5, s[20:23], s91 offen offset:3072 sc1 lds
    s_add_u32 m0, s57, 55296
    s_nop 0
    buffer_load_dwordx4 v6, s[20:23], s91 offen offset:0 sc1 lds
    buffer_load_dwordx4 v6, s[20:23], s91 offen offset:1024 sc1 lds
    buffer_load_dwordx4 v6, s[20:23], s91 offen offset:2048 sc1 lds
    buffer_load_dwordx4 v6, s[20:23], s91 offen offset:3072 sc1 lds
    s_add_u32 s47, s47, 1
    s_mul_i32 s92, s50, 40960
    s_add_u32 s92, s92, s79
    s_add_u32 m0, s57, 49152
    s_nop 0
    buffer_load_dwordx4 v5, s[20:23], s92 offen offset:0 sc1 lds
    buffer_load_dwordx4 v5, s[20:23], s92 offen offset:1024 sc1 lds
    buffer_load_dwordx4 v5, s[20:23], s92 offen offset:2048 sc1 lds
    buffer_load_dwordx4 v5, s[20:23], s92 offen offset:3072 sc1 lds
    s_add_u32 m0, s57, 53248
    s_nop 0
    buffer_load_dwordx4 v6, s[20:23], s92 offen offset:0 sc1 lds
    buffer_load_dwordx4 v6, s[20:23], s92 offen offset:1024 sc1 lds
    s_add_u32 s92, s92, 10240
    s_add_u32 m0, s57, 59392
    s_nop 0
    buffer_load_dwordx4 v5, s[20:23], s92 offen offset:0 sc1 lds
    buffer_load_dwordx4 v5, s[20:23], s92 offen offset:1024 sc1 lds
    buffer_load_dwordx4 v5, s[20:23], s92 offen offset:2048 sc1 lds
    buffer_load_dwordx4 v5, s[20:23], s92 offen offset:3072 sc1 lds
    s_add_u32 m0, s57, 63488
    s_nop 0
    buffer_load_dwordx4 v6, s[20:23], s92 offen offset:0 sc1 lds
    buffer_load_dwordx4 v6, s[20:23], s92 offen offset:1024 sc1 lds
    s_add_u32 s50, s50, 1
    s_waitcnt vmcnt(20)
    s_barrier
    s_lshl_b32 s91, s47, 14
    s_add_u32 s91, s91, s76
    s_add_u32 m0, s57, 90112
    s_nop 0
    buffer_load_dwordx4 v5, s[20:23], s91 offen offset:0 sc1 lds
    buffer_load_dwordx4 v5, s[20:23], s91 offen offset:1024 sc1 lds
    buffer_load_dwordx4 v5, s[20:23], s91 offen offset:2048 sc1 lds
    buffer_load_dwordx4 v5, s[20:23], s91 offen offset:3072 sc1 lds
    s_add_u32 m0, s57, 100352
    s_nop 0
    buffer_load_dwordx4 v6, s[20:23], s91 offen offset:0 sc1 lds
    buffer_load_dwordx4 v6, s[20:23], s91 offen offset:1024 sc1 lds
    buffer_load_dwordx4 v6, s[20:23], s91 offen offset:2048 sc1 lds
    buffer_load_dwordx4 v6, s[20:23], s91 offen offset:3072 sc1 lds
    s_add_u32 s47, s47, 1
    s_mul_i32 s92, s50, 40960
    s_add_u32 s92, s92, s79
    s_add_u32 m0, s57, 94208
    s_nop 0
    buffer_load_dwordx4 v5, s[20:23], s92 offen offset:0 sc1 lds
    buffer_load_dwordx4 v5, s[20:23], s92 offen offset:1024 sc1 lds
    buffer_load_dwordx4 v5, s[20:23], s92 offen offset:2048 sc1 lds
    buffer_load_dwordx4 v5, s[20:23], s92 offen offset:3072 sc1 lds
    s_add_u32 m0, s57, 98304
    s_nop 0
    buffer_load_dwordx4 v6, s[20:23], s92 offen offset:0 sc1 lds
    buffer_load_dwordx4 v6, s[20:23], s92 offen offset:1024 sc1 lds
    s_add_u32 s92, s92, 10240
    s_add_u32 m0, s57, 104448
    s_nop 0
    buffer_load_dwordx4 v5, s[20:23], s92 offen offset:0 sc1 lds
    buffer_load_dwordx4 v5, s[20:23], s92 offen offset:1024 sc1 lds
    buffer_load_dwordx4 v5, s[20:23], s92 offen offset:2048 sc1 lds
    buffer_load_dwordx4 v5, s[20:23], s92 offen offset:3072 sc1 lds
    s_add_u32 m0, s57, 108544
    s_nop 0
    buffer_load_dwordx4 v6, s[20:23], s92 offen offset:0 sc1 lds
    buffer_load_dwordx4 v6, s[20:23], s92 offen offset:1024 sc1 lds
    s_add_u32 s50, s50, 1
    s_waitcnt vmcnt(20)
    s_barrier
    s_lshl_b32 s91, s47, 14
    s_add_u32 s91, s91, s76
    s_add_u32 m0, s57, 0
    s_nop 0
    buffer_load_dwordx4 v5, s[20:23], s91 offen offset:0 sc1 lds
    buffer_load_dwordx4 v5, s[20:23], s91 offen offset:1024 sc1 lds
    buffer_load_dwordx4 v5, s[20:23], s91 offen offset:2048 sc1 lds
    buffer_load_dwordx4 v5, s[20:23], s91 offen offset:3072 sc1 lds
    s_add_u32 m0, s57, 10240
    s_nop 0
    buffer_load_dwordx4 v6, s[20:23], s91 offen offset:0 sc1 lds
    buffer_load_dwordx4 v6, s[20:23], s91 offen offset:1024 sc1 lds
    buffer_load_dwordx4 v6, s[20:23], s91 offen offset:2048 sc1 lds
    buffer_load_dwordx4 v6, s[20:23], s91 offen offset:3072 sc1 lds
    s_add_u32 s47, s47, 1
    s_mul_i32 s92, s50, 40960
    s_add_u32 s92, s92, s79
    s_add_u32 m0, s57, 4096
    s_nop 0
    buffer_load_dwordx4 v5, s[20:23], s92 offen offset:0 sc1 lds
    buffer_load_dwordx4 v5, s[20:23], s92 offen offset:1024 sc1 lds
    buffer_load_dwordx4 v5, s[20:23], s92 offen offset:2048 sc1 lds
    buffer_load_dwordx4 v5, s[20:23], s92 offen offset:3072 sc1 lds
    s_add_u32 m0, s57, 8192
    s_nop 0
    buffer_load_dwordx4 v6, s[20:23], s92 offen offset:0 sc1 lds
    buffer_load_dwordx4 v6, s[20:23], s92 offen offset:1024 sc1 lds
    s_add_u32 s92, s92, 10240
    s_add_u32 m0, s57, 14336
    s_nop 0
    buffer_load_dwordx4 v5, s[20:23], s92 offen offset:0 sc1 lds
    buffer_load_dwordx4 v5, s[20:23], s92 offen offset:1024 sc1 lds
    buffer_load_dwordx4 v5, s[20:23], s92 offen offset:2048 sc1 lds
    buffer_load_dwordx4 v5, s[20:23], s92 offen offset:3072 sc1 lds
    s_add_u32 m0, s57, 18432
    s_nop 0
    buffer_load_dwordx4 v6, s[20:23], s92 offen offset:0 sc1 lds
    buffer_load_dwordx4 v6, s[20:23], s92 offen offset:1024 sc1 lds
    s_add_u32 s50, s50, 1
    s_waitcnt vmcnt(20)
    s_barrier
    s_lshl_b32 s91, s47, 14
    s_add_u32 s91, s91, s76
    s_add_u32 m0, s57, 45056
    s_nop 0
    buffer_load_dwordx4 v5, s[20:23], s91 offen offset:0 sc1 lds
    buffer_load_dwordx4 v5, s[20:23], s91 offen offset:1024 sc1 lds
    buffer_load_dwordx4 v5, s[20:23], s91 offen offset:2048 sc1 lds
    buffer_load_dwordx4 v5, s[20:23], s91 offen offset:3072 sc1 lds
    s_add_u32 m0, s57, 55296
    s_nop 0
    buffer_load_dwordx4 v6, s[20:23], s91 offen offset:0 sc1 lds
    buffer_load_dwordx4 v6, s[20:23], s91 offen offset:1024 sc1 lds
    buffer_load_dwordx4 v6, s[20:23], s91 offen offset:2048 sc1 lds
    buffer_load_dwordx4 v6, s[20:23], s91 offen offset:3072 sc1 lds
    s_add_u32 s47, s47, 1
    s_mul_i32 s92, s50, 40960
    s_add_u32 s92, s92, s79
    s_add_u32 m0, s57, 49152
    s_nop 0
    buffer_load_dwordx4 v5, s[20:23], s92 offen offset:0 sc1 lds
    buffer_load_dwordx4 v5, s[20:23], s92 offen offset:1024 sc1 lds
    buffer_load_dwordx4 v5, s[20:23], s92 offen offset:2048 sc1 lds
    buffer_load_dwordx4 v5, s[20:23], s92 offen offset:3072 sc1 lds
    s_add_u32 m0, s57, 53248
    s_nop 0
    buffer_load_dwordx4 v6, s[20:23], s92 offen offset:0 sc1 lds
    buffer_load_dwordx4 v6, s[20:23], s92 offen offset:1024 sc1 lds
    s_add_u32 s92, s92, 10240
    s_add_u32 m0, s57, 59392
    s_nop 0
    buffer_load_dwordx4 v5, s[20:23], s92 offen offset:0 sc1 lds
    buffer_load_dwordx4 v5, s[20:23], s92 offen offset:1024 sc1 lds
    buffer_load_dwordx4 v5, s[20:23], s92 offen offset:2048 sc1 lds
    buffer_load_dwordx4 v5, s[20:23], s92 offen offset:3072 sc1 lds
    s_add_u32 m0, s57, 63488
    s_nop 0
    buffer_load_dwordx4 v6, s[20:23], s92 offen offset:0 sc1 lds
    buffer_load_dwordx4 v6, s[20:23], s92 offen offset:1024 sc1 lds
    s_add_u32 s50, s50, 1
    s_waitcnt vmcnt(20)
    s_barrier
    s_lshl_b32 s91, s47, 14
    s_add_u32 s91, s91, s76
    s_add_u32 m0, s57, 90112
    s_nop 0
    buffer_load_dwordx4 v5, s[20:23], s91 offen offset:0 sc1 lds
    buffer_load_dwordx4 v5, s[20:23], s91 offen offset:1024 sc1 lds
    buffer_load_dwordx4 v5, s[20:23], s91 offen offset:2048 sc1 lds
    buffer_load_dwordx4 v5, s[20:23], s91 offen offset:3072 sc1 lds
    s_add_u32 m0, s57, 100352
    s_nop 0
    buffer_load_dwordx4 v6, s[20:23], s91 offen offset:0 sc1 lds
    buffer_load_dwordx4 v6, s[20:23], s91 offen offset:1024 sc1 lds
    buffer_load_dwordx4 v6, s[20:23], s91 offen offset:2048 sc1 lds
    buffer_load_dwordx4 v6, s[20:23], s91 offen offset:3072 sc1 lds
    s_add_u32 s47, s47, 1
    s_mul_i32 s92, s50, 40960
    s_add_u32 s92, s92, s79
    s_add_u32 m0, s57, 94208
    s_nop 0
    buffer_load_dwordx4 v5, s[20:23], s92 offen offset:0 sc1 lds
    buffer_load_dwordx4 v5, s[20:23], s92 offen offset:1024 sc1 lds
    buffer_load_dwordx4 v5, s[20:23], s92 offen offset:2048 sc1 lds
    buffer_load_dwordx4 v5, s[20:23], s92 offen offset:3072 sc1 lds
    s_add_u32 m0, s57, 98304
    s_nop 0
    buffer_load_dwordx4 v6, s[20:23], s92 offen offset:0 sc1 lds
    buffer_load_dwordx4 v6, s[20:23], s92 offen offset:1024 sc1 lds
    s_add_u32 s92, s92, 10240
    s_add_u32 m0, s57, 104448
    s_nop 0
    buffer_load_dwordx4 v5, s[20:23], s92 offen offset:0 sc1 lds
    buffer_load_dwordx4 v5, s[20:23], s92 offen offset:1024 sc1 lds
    buffer_load_dwordx4 v5, s[20:23], s92 offen offset:2048 sc1 lds
    buffer_load_dwordx4 v5, s[20:23], s92 offen offset:3072 sc1 lds
    s_add_u32 m0, s57, 108544
    s_nop 0
    buffer_load_dwordx4 v6, s[20:23], s92 offen offset:0 sc1 lds
    buffer_load_dwordx4 v6, s[20:23], s92 offen offset:1024 sc1 lds
    s_add_u32 s50, s50, 1
    s_waitcnt vmcnt(20)
    s_barrier
    s_waitcnt vmcnt(0)
    s_barrier
    s_endpgm
L_SKV:
    v_mov_b32 v45, 1073741824
    v_bfe_u32 v10, v1, 2, 2
    v_and_b32 v11, 3, v1
    v_lshlrev_b32 v11, 3, v11
    v_and_b32 v12, 16, v1
    v_lshl_add_u32 v11, v12, 1, v11
    v_lshl_add_u32 v12, v2, 3, v10
    v_mul_u32_u24 v58, 320, v12
    v_add_u32 v58, v58, v11
    s_mul_i32 s39, s36, 64
    s_add_u32 s39, s39, 16384
    v_add_u32 v32, s39, v58
    s_lshl_b32 s96, s36, 7
    v_add_u32 v33, 16640, v58
    s_mov_b32 s97, 512
    v_and_b32 v10, 31, v1
    v_bfe_u32 v11, v1, 1, 3
    v_xor_b32 v11, v11, v2
    s_lshl_b32 s39, s36, 12
    v_lshl_add_u32 v10, v10, 7, s39
    v_xor_b32 v12, 0, v11
    v_lshl_add_u32 v112, v12, 4, v10
    v_xor_b32 v12, 2, v11
    v_lshl_add_u32 v113, v12, 4, v10
    v_xor_b32 v12, 4, v11
    v_lshl_add_u32 v114, v12, 4, v10
    v_xor_b32 v12, 6, v11
    v_lshl_add_u32 v115, v12, 4, v10
    s_sub_u32 s69, s36, 2
    s_waitcnt lgkmcnt(0)
    s_mov_b32 s20, s58
    s_mov_b32 s21, s59
    s_mov_b32 s22, 14680064
    s_mov_b32 s23, 0x00020000
    s_mov_b32 s24, s56
    s_mov_b32 s25, s57
    s_mov_b32 s26, 256
    s_mov_b32 s27, 0x00020000
    s_lshl_b32 s40, s69, 5
    s_add_u32 s40, s40, s89
    s_sub_u32 s76, s40, 48
    s_mul_i32 s60, s76, 13108
    s_lshr_b32 s60, s60, 16
    s_mul_i32 s61, s60, 5
    s_sub_u32 s61, s76, s61
    s_lshl_b32 s79, s61, 1
    s_cmp_lt_u32 s61, 3
    s_cselect_b32 s41, 0, 1
    s_sub_u32 s79, s79, s41
    s_add_u32 s41, s79, 1
    s_cmp_eq_u32 s61, 2
    s_cselect_b32 s41, 9, s41
    s_mul_i32 s60, s60, 10
    s_add_u32 s79, s79, s60
    s_add_u32 s41, s41, s60
    s_lshr_b32 s76, s40, 2
    s_mul_i32 s76, s76, 12
    s_and_b32 s60, s40, 3
    s_lshl_b32 s60, s60, 1
    s_add_u32 s76, s76, s60
    s_add_u32 s76, s76, 4
    s_sub_u32 s60, s40, 32
    s_lshr_b32 s60, s60, 1
    s_mul_i32 s60, s60, 12
    s_and_b32 s61, s40, 1
    s_lshl_b32 s61, s61, 1
    s_add_u32 s60, s60, s61
    s_cmp_lt_u32 s40, 32
    s_cselect_b32 s76, s76, s60
    s_add_u32 s60, s76, 1
    s_cmp_lt_u32 s40, 48
    s_cselect_b32 s79, s76, s79
    s_cselect_b32 s41, s60, s41
    s_cselect_b32 s28, s54, s48
    s_cselect_b32 s29, s55, s49
    s_mov_b32 s30, 819200
    s_cselect_b32 s30, 1966080, s30
    s_mov_b32 s31, 0x00020000
    s_mul_i32 s76, s90, 320
    s_add_u32 s76, s76, 0
    s_mul_i32 s79, s79, 20480
    s_mul_i32 s41, s41, 20480
    s_sub_u32 s41, s41, 20480
    s_add_u32 s79, s79, s76
    s_add_u32 s41, s41, s76
    s_mul_i32 s77, s90, 68
    s_add_u32 s77, s77, s40
    s_mul_i32 s77, s77, 10240
    s_add_u32 s77, s77, 9437184
    s_cmp_lt_u32 s40, 68
    s_cselect_b32 s79, s79, 1073741824
    s_cselect_b32 s41, s41, 1073741824
    s_cselect_b32 s77, s77, 1073741824
    v_mov_b32 v13, s79
    v_mov_b32 v14, s41
    v_add_u32 v58, 0, v1
    v_mul_u32_u24 v11, 6554, v58
    v_lshrrev_b32 v11, 16, v11
    v_mul_u32_u24 v12, 10, v11
    v_sub_u32 v12, v58, v12
    v_cmp_lt_u32 vcc, 15, v11
    v_mul_u32_u24 v11, 1280, v11
    v_lshl_add_u32 v11, v12, 4, v11
    v_cndmask_b32 v15, v13, v14, vcc
    v_add_u32 v140, v11, v15
    v_add_u32 v58, 64, v1
    v_mul_u32_u24 v11, 6554, v58
    v_lshrrev_b32 v11, 16, v11
    v_mul_u32_u24 v12, 10, v11
    v_sub_u32 v12, v58, v12
    v_cmp_lt_u32 vcc, 15, v11
    v_mul_u32_u24 v11, 1280, v11
    v_lshl_add_u32 v11, v12, 4, v11
    v_cndmask_b32 v15, v13, v14, vcc
    v_add_u32 v141, v11, v15
    v_add_u32 v58, 128, v1
    v_mul_u32_u24 v11, 6554, v58
    v_lshrrev_b32 v11, 16, v11
    v_mul_u32_u24 v12, 10, v11
    v_sub_u32 v12, v58, v12
    v_cmp_lt_u32 vcc, 15, v11
    v_mul_u32_u24 v11, 1280, v11
    v_lshl_add_u32 v11, v12, 4, v11
    v_cndmask_b32 v15, v13, v14, vcc
    v_add_u32 v142, v11, v15
    v_add_u32 v58, 192, v1
    v_mul_u32_u24 v11, 6554, v58
    v_lshrrev_b32 v11, 16, v11
    v_mul_u32_u24 v12, 10, v11
    v_sub_u32 v12, v58, v12
    v_cmp_lt_u32 vcc, 15, v11
    v_mul_u32_u24 v11, 1280, v11
    v_lshl_add_u32 v11, v12, 4, v11
    v_cndmask_b32 v15, v13, v14, vcc
    v_add_u32 v143, v11, v15
    v_add_u32 v58, 256, v1
    v_mul_u32_u24 v11, 6554, v58
    v_lshrrev_b32 v11, 16, v11
    v_mul_u32_u24 v12, 10, v11
    v_sub_u32 v12, v58, v12
    v_cmp_lt_u32 vcc, 15, v11
    v_mul_u32_u24 v11, 1280, v11
    v_lshl_add_u32 v11, v12, 4, v11
    v_cndmask_b32 v15, v13, v14, vcc
    v_add_u32 v144, v11, v15
    s_lshl_b32 s40, s69, 5
    s_add_u32 s40, s40, s89
    s_add_u32 s40, s40, 64
    s_sub_u32 s76, s40, 48
    s_mul_i32 s60, s76, 13108
    s_lshr_b32 s60, s60, 16
    s_mul_i32 s61, s60, 5
    s_sub_u32 s61, s76, s61
    s_lshl_b32 s79, s61, 1
    s_cmp_lt_u32 s61, 3
    s_cselect_b32 s41, 0, 1
    s_sub_u32 s79, s79, s41
    s_add_u32 s41, s79, 1
    s_cmp_eq_u32 s61, 2
    s_cselect_b32 s41, 9, s41
    s_mul_i32 s60, s60, 10
    s_add_u32 s79, s79, s60
    s_add_u32 s41, s41, s60
    s_lshr_b32 s76, s40, 2
    s_mul_i32 s76, s76, 12
    s_and_b32 s60, s40, 3
    s_lshl_b32 s60, s60, 1
    s_add_u32 s76, s76, s60
    s_add_u32 s76, s76, 4
    s_sub_u32 s60, s40, 32
    s_lshr_b32 s60, s60, 1
    s_mul_i32 s60, s60, 12
    s_and_b32 s61, s40, 1
    s_lshl_b32 s61, s61, 1
    s_add_u32 s60, s60, s61
    s_cmp_lt_u32 s40, 32
    s_cselect_b32 s76, s76, s60
    s_add_u32 s60, s76, 1
    s_cmp_lt_u32 s40, 48
    s_cselect_b32 s79, s76, s79
    s_cselect_b32 s41, s60, s41
    s_cselect_b32 s12, s54, s48
    s_cselect_b32 s13, s55, s49
    s_mov_b32 s14, 819200
    s_cselect_b32 s14, 1966080, s14
    s_mov_b32 s15, 0x00020000
    s_mul_i32 s76, s90, 320
    s_add_u32 s76, s76, 0
    s_mul_i32 s79, s79, 20480
    s_mul_i32 s41, s41, 20480
    s_sub_u32 s41, s41, 20480
    s_add_u32 s79, s79, s76
    s_add_u32 s41, s41, s76
    s_mul_i32 s63, s90, 68
    s_add_u32 s63, s63, s40
    s_mul_i32 s63, s63, 10240
    s_add_u32 s63, s63, 9437184
    s_cmp_lt_u32 s40, 68
    s_cselect_b32 s79, s79, 1073741824
    s_cselect_b32 s41, s41, 1073741824
    s_cselect_b32 s63, s63, 1073741824
    v_mov_b32 v13, s79
    v_mov_b32 v14, s41
    v_add_u32 v58, 0, v1
    v_mul_u32_u24 v11, 6554, v58
    v_lshrrev_b32 v11, 16, v11
    v_mul_u32_u24 v12, 10, v11
    v_sub_u32 v12, v58, v12
    v_cmp_lt_u32 vcc, 15, v11
    v_mul_u32_u24 v11, 1280, v11
    v_lshl_add_u32 v11, v12, 4, v11
    v_cndmask_b32 v15, v13, v14, vcc
    v_add_u32 v145, v11, v15
    v_add_u32 v58, 64, v1
    v_mul_u32_u24 v11, 6554, v58
    v_lshrrev_b32 v11, 16, v11
    v_mul_u32_u24 v12, 10, v11
    v_sub_u32 v12, v58, v12
    v_cmp_lt_u32 vcc, 15, v11
    v_mul_u32_u24 v11, 1280, v11
    v_lshl_add_u32 v11, v12, 4, v11
    v_cndmask_b32 v15, v13, v14, vcc
    v_add_u32 v146, v11, v15
    v_add_u32 v58, 128, v1
    v_mul_u32_u24 v11, 6554, v58
    v_lshrrev_b32 v11, 16, v11
    v_mul_u32_u24 v12, 10, v11
    v_sub_u32 v12, v58, v12
    v_cmp_lt_u32 vcc, 15, v11
    v_mul_u32_u24 v11, 1280, v11
    v_lshl_add_u32 v11, v12, 4, v11
    v_cndmask_b32 v15, v13, v14, vcc
    v_add_u32 v147, v11, v15
    v_add_u32 v58, 192, v1
    v_mul_u32_u24 v11, 6554, v58
    v_lshrrev_b32 v11, 16, v11
    v_mul_u32_u24 v12, 10, v11
    v_sub_u32 v12, v58, v12
    v_cmp_lt_u32 vcc, 15, v11
    v_mul_u32_u24 v11, 1280, v11
    v_lshl_add_u32 v11, v12, 4, v11
    v_cndmask_b32 v15, v13, v14, vcc
    v_add_u32 v148, v11, v15
    v_add_u32 v58, 256, v1
    v_mul_u32_u24 v11, 6554, v58
    v_lshrrev_b32 v11, 16, v11
    v_mul_u32_u24 v12, 10, v11
    v_sub_u32 v12, v58, v12
    v_cmp_lt_u32 vcc, 15, v11
    v_mul_u32_u24 v11, 1280, v11
    v_lshl_add_u32 v11, v12, 4, v11
    v_cndmask_b32 v15, v13, v14, vcc
    v_add_u32 v149, v11, v15
    s_mov_b32 s49, s69
    s_mul_i32 s64, s49, 10240
    s_add_u32 s64, s64, 135168
    v_bfe_u32 v58, v1, 4, 1
    v_bfe_u32 v11, v1, 2, 2
    v_lshl_add_u32 v58, v58, 2, v11
    v_lshl_add_u32 v58, v2, 4, v58
    v_mul_u32_u24 v58, 160, v58
    v_and_b32 v11, 3, v1
    v_lshl_add_u32 v58, v11, 3, v58
    v_add_u32 v150, s64, v58
    v_subrev_u32 v56, 384, v0
    v_mov_b32 v46, 1
    v_mov_b32 v31, 3
    v_cmp_gt_u32 vcc, 2, v56
    v_lshlrev_b32 v11, 7, v1
    v_mov_b32 v13, 128
    v_cndmask_b32 v51, v45, v11, vcc
    v_cndmask_b32 v55, 0, v13, vcc
    s_lshr_b32 s39, s89, 1
    s_lshl_b32 s39, s39, 11
    s_and_b32 s40, s89, 1
    s_lshl_b32 s40, s40, 5
    s_add_u32 s39, s39, s40
    s_add_u32 s39, s39, 13697152
    v_lshrrev_b32 v10, 1, v1
    v_and_b32 v11, 1, v1
    v_lshl_add_u32 v11, v11, 4, s39
    v_lshl_add_u32 v12, v10, 8, v11
    v_cmp_gt_u32 vcc, 16, v56
    v_mov_b32 v13, 2
    s_nop 0
    v_cndmask_b32 v48, v45, v12, vcc
    v_cndmask_b32 v52, 0, v46, vcc
    v_cndmask_b32 v53, 0, v13, vcc
    v_cndmask_b32 v49, 0, v31, vcc
    v_lshlrev_b32 v11, 2, v3
    s_lshl_b32 s39, s49, 9
    v_add_u32 v11, s39, v11
    v_lshl_add_u32 v152, v2, 10, v11
    v_cmp_gt_u32 vcc, 640, v11
    v_and_b32 v12, 0x7f, v11
    s_mul_i32 s44, s37, 10240
    s_add_u32 s44, s44, 13762560
    v_cndmask_b32 v13, v12, v11, vcc
    v_lshl_add_u32 v153, v2, 11, v13
    v_lshl_add_u32 v156, v2, 11, v12
    s_mul_i32 s45, s88, 20480
    s_add_u32 s45, s45, 12845056
    v_lshlrev_b32 v155, 1, v11
    v_lshl_add_u32 v155, v2, 4, v155
    v_add_u32 v155, 159744, v155
    v_lshlrev_b32 v12, 1, v12
    v_lshl_add_u32 v12, v2, 4, v12
    v_add_u32 v157, 161792, v12
    v_lshrrev_b32 v11, 3, v11
    v_add_u32 v154, v11, v2
    s_waitcnt lgkmcnt(0)
    s_barrier
    ds_read_b128 v[120:123], v112
    ds_read_b128 v[124:127], v113
    ds_read_b128 v[128:131], v114
    ds_read_b128 v[132:135], v115
    ds_read_b64_tr_b16 v[64:65], v32 offset:0
    ds_read_b64_tr_b16 v[66:67], v32 offset:1280
    ds_read_b64_tr_b16 v[68:69], v32 offset:5120
    ds_read_b64_tr_b16 v[70:71], v32 offset:6400
    ds_read_b64_tr_b16 v[72:73], v32 offset:10240
    ds_read_b64_tr_b16 v[74:75], v32 offset:11520
    ds_read_b64_tr_b16 v[76:77], v32 offset:15360
    ds_read_b64_tr_b16 v[78:79], v32 offset:16640
    ds_read_b64_tr_b16 v[80:81], v33 offset:0
    ds_read_b64_tr_b16 v[82:83], v33 offset:1280
    ds_read_b64_tr_b16 v[84:85], v33 offset:5120
    ds_read_b64_tr_b16 v[86:87], v33 offset:6400
    ds_read_b64_tr_b16 v[88:89], v33 offset:10240
    ds_read_b64_tr_b16 v[90:91], v33 offset:11520
    ds_read_b64_tr_b16 v[92:93], v33 offset:15360
    ds_read_b64_tr_b16 v[94:95], v33 offset:16640
    s_waitcnt lgkmcnt(0)
    v_mov_b32 v116, 0
    v_mov_b32 v117, 0
    v_mov_b32 v118, 0
    v_mov_b32 v119, 0
    v_mov_b32 v36, 0
    v_mov_b32 v37, 0
    v_mov_b32 v38, 0
    v_mov_b32 v39, 0
    v_lshlrev_b32 v58, 16, v120
    v_and_b32 v59, s67, v120
    v_lshlrev_b32 v60, 16, v121
    v_and_b32 v61, s67, v121
    v_add_f32 v116, v116, v58
    v_add_f32 v117, v117, v59
    v_fmac_f32 v118, v58, v58
    v_fmac_f32 v119, v59, v59
    v_add_f32 v116, v116, v60
    v_add_f32 v117, v117, v61
    v_fmac_f32 v118, v60, v60
    v_fmac_f32 v119, v61, v61
    v_lshlrev_b32 v58, 16, v122
    v_and_b32 v59, s67, v122
    v_lshlrev_b32 v60, 16, v123
    v_and_b32 v61, s67, v123
    v_add_f32 v116, v116, v58
    v_add_f32 v117, v117, v59
    v_fmac_f32 v118, v58, v58
    v_fmac_f32 v119, v59, v59
    v_add_f32 v116, v116, v60
    v_add_f32 v117, v117, v61
    v_fmac_f32 v118, v60, v60
    v_fmac_f32 v119, v61, v61
    v_lshlrev_b32 v58, 16, v124
    v_and_b32 v59, s67, v124
    v_lshlrev_b32 v60, 16, v125
    v_and_b32 v61, s67, v125
    v_add_f32 v116, v116, v58
    v_add_f32 v117, v117, v59
    v_fmac_f32 v118, v58, v58
    v_fmac_f32 v119, v59, v59
    v_add_f32 v116, v116, v60
    v_add_f32 v117, v117, v61
    v_fmac_f32 v118, v60, v60
    v_fmac_f32 v119, v61, v61
    v_lshlrev_b32 v58, 16, v126
    v_and_b32 v59, s67, v126
    v_lshlrev_b32 v60, 16, v127
    v_and_b32 v61, s67, v127
    v_add_f32 v116, v116, v58
    v_add_f32 v117, v117, v59
    v_fmac_f32 v118, v58, v58
    v_fmac_f32 v119, v59, v59
    v_add_f32 v116, v116, v60
    v_add_f32 v117, v117, v61
    v_fmac_f32 v118, v60, v60
    v_fmac_f32 v119, v61, v61
    v_lshlrev_b32 v58, 16, v128
    v_and_b32 v59, s67, v128
    v_lshlrev_b32 v60, 16, v129
    v_and_b32 v61, s67, v129
    v_add_f32 v116, v116, v58
    v_add_f32 v117, v117, v59
    v_fmac_f32 v118, v58, v58
    v_fmac_f32 v119, v59, v59
    v_add_f32 v116, v116, v60
    v_add_f32 v117, v117, v61
    v_fmac_f32 v118, v60, v60
    v_fmac_f32 v119, v61, v61
    v_lshlrev_b32 v58, 16, v130
    v_and_b32 v59, s67, v130
    v_lshlrev_b32 v60, 16, v131
    v_and_b32 v61, s67, v131
    v_add_f32 v116, v116, v58
    v_add_f32 v117, v117, v59
    v_fmac_f32 v118, v58, v58
    v_fmac_f32 v119, v59, v59
    v_add_f32 v116, v116, v60
    v_add_f32 v117, v117, v61
    v_fmac_f32 v118, v60, v60
    v_fmac_f32 v119, v61, v61
    v_lshlrev_b32 v58, 16, v132
    v_and_b32 v59, s67, v132
    v_lshlrev_b32 v60, 16, v133
    v_and_b32 v61, s67, v133
    v_add_f32 v116, v116, v58
    v_add_f32 v117, v117, v59
    v_fmac_f32 v118, v58, v58
    v_fmac_f32 v119, v59, v59
    v_add_f32 v116, v116, v60
    v_add_f32 v117, v117, v61
    v_fmac_f32 v118, v60, v60
    v_fmac_f32 v119, v61, v61
    v_lshlrev_b32 v58, 16, v134
    v_and_b32 v59, s67, v134
    v_lshlrev_b32 v60, 16, v135
    v_and_b32 v61, s67, v135
    v_add_f32 v116, v116, v58
    v_add_f32 v117, v117, v59
    v_fmac_f32 v118, v58, v58
    v_fmac_f32 v119, v59, v59
    v_add_f32 v116, v116, v60
    v_add_f32 v117, v117, v61
    v_fmac_f32 v118, v60, v60
    v_fmac_f32 v119, v61, v61
    v_lshlrev_b32 v58, 16, v64
    v_and_b32 v59, s67, v64
    v_lshlrev_b32 v60, 16, v80
    v_and_b32 v61, s67, v80
    v_add_f32 v36, v36, v58
    v_add_f32 v37, v37, v59
    v_add_f32 v38, v38, v60
    v_add_f32 v39, v39, v61
    v_lshlrev_b32 v58, 16, v65
    v_and_b32 v59, s67, v65
    v_lshlrev_b32 v60, 16, v81
    v_and_b32 v61, s67, v81
    v_add_f32 v36, v36, v58
    v_add_f32 v37, v37, v59
    v_add_f32 v38, v38, v60
    v_add_f32 v39, v39, v61
    v_lshlrev_b32 v58, 16, v66
    v_and_b32 v59, s67, v66
    v_lshlrev_b32 v60, 16, v82
    v_and_b32 v61, s67, v82
    v_add_f32 v36, v36, v58
    v_add_f32 v37, v37, v59
    v_add_f32 v38, v38, v60
    v_add_f32 v39, v39, v61
    v_lshlrev_b32 v58, 16, v67
    v_and_b32 v59, s67, v67
    v_lshlrev_b32 v60, 16, v83
    v_and_b32 v61, s67, v83
    v_add_f32 v36, v36, v58
    v_add_f32 v37, v37, v59
    v_add_f32 v38, v38, v60
    v_add_f32 v39, v39, v61
    v_lshlrev_b32 v58, 16, v68
    v_and_b32 v59, s67, v68
    v_lshlrev_b32 v60, 16, v84
    v_and_b32 v61, s67, v84
    v_add_f32 v36, v36, v58
    v_add_f32 v37, v37, v59
    v_add_f32 v38, v38, v60
    v_add_f32 v39, v39, v61
    v_lshlrev_b32 v58, 16, v69
    v_and_b32 v59, s67, v69
    v_lshlrev_b32 v60, 16, v85
    v_and_b32 v61, s67, v85
    v_add_f32 v36, v36, v58
    v_add_f32 v37, v37, v59
    v_add_f32 v38, v38, v60
    v_add_f32 v39, v39, v61
    v_lshlrev_b32 v58, 16, v70
    v_and_b32 v59, s67, v70
    v_lshlrev_b32 v60, 16, v86
    v_and_b32 v61, s67, v86
    v_add_f32 v36, v36, v58
    v_add_f32 v37, v37, v59
    v_add_f32 v38, v38, v60
    v_add_f32 v39, v39, v61
    s_waitcnt lgkmcnt(0)
    s_barrier
    s_add_u32 m0, s64, 0
    s_nop 0
    buffer_load_dwordx4 v140, s[28:31], 0 offen lds
    s_add_u32 m0, s64, 1024
    s_nop 0
    buffer_load_dwordx4 v141, s[28:31], 0 offen lds
    s_add_u32 m0, s64, 2048
    s_nop 0
    buffer_load_dwordx4 v142, s[28:31], 0 offen lds
    s_add_u32 m0, s64, 3072
    s_nop 0
    buffer_load_dwordx4 v143, s[28:31], 0 offen lds
    s_add_u32 m0, s64, 4096
    s_nop 0
    buffer_load_dwordx4 v144, s[28:31], 0 offen lds
    s_add_u32 m0, s64, 5120
    s_nop 0
    buffer_load_dwordx4 v145, s[12:15], 0 offen lds
    s_add_u32 m0, s64, 6144
    s_nop 0
    buffer_load_dwordx4 v146, s[12:15], 0 offen lds
    s_add_u32 m0, s64, 7168
    s_nop 0
    buffer_load_dwordx4 v147, s[12:15], 0 offen lds
    s_add_u32 m0, s64, 8192
    s_nop 0
    buffer_load_dwordx4 v148, s[12:15], 0 offen lds
    s_add_u32 m0, s64, 9216
    s_nop 0
    buffer_load_dwordx4 v149, s[12:15], 0 offen lds
    buffer_load_dword v8, v51, s[24:27], 0 offen sc1
    v_lshlrev_b32 v58, 16, v71
    v_and_b32 v59, s67, v71
    v_lshlrev_b32 v60, 16, v87
    v_and_b32 v61, s67, v87
    v_add_f32 v36, v36, v58
    v_add_f32 v37, v37, v59
    v_add_f32 v38, v38, v60
    v_add_f32 v39, v39, v61
    v_lshlrev_b32 v58, 16, v72
    v_and_b32 v59, s67, v72
    v_lshlrev_b32 v60, 16, v88
    v_and_b32 v61, s67, v88
    v_add_f32 v36, v36, v58
    v_add_f32 v37, v37, v59
    v_add_f32 v38, v38, v60
    v_add_f32 v39, v39, v61
    v_lshlrev_b32 v58, 16, v73
    v_and_b32 v59, s67, v73
    v_lshlrev_b32 v60, 16, v89
    v_and_b32 v61, s67, v89
    v_add_f32 v36, v36, v58
    v_add_f32 v37, v37, v59
    v_add_f32 v38, v38, v60
    v_add_f32 v39, v39, v61
    v_lshlrev_b32 v58, 16, v74
    v_and_b32 v59, s67, v74
    v_lshlrev_b32 v60, 16, v90
    v_and_b32 v61, s67, v90
    v_add_f32 v36, v36, v58
    v_add_f32 v37, v37, v59
    v_add_f32 v38, v38, v60
    v_add_f32 v39, v39, v61
    v_lshlrev_b32 v58, 16, v75
    v_and_b32 v59, s67, v75
    v_lshlrev_b32 v60, 16, v91
    v_and_b32 v61, s67, v91
    v_add_f32 v36, v36, v58
    v_add_f32 v37, v37, v59
    v_add_f32 v38, v38, v60
    v_add_f32 v39, v39, v61
    v_lshlrev_b32 v58, 16, v76
    v_and_b32 v59, s67, v76
    v_lshlrev_b32 v60, 16, v92
    v_and_b32 v61, s67, v92
    v_add_f32 v36, v36, v58
    v_add_f32 v37, v37, v59
    v_add_f32 v38, v38, v60
    v_add_f32 v39, v39, v61
    v_lshlrev_b32 v58, 16, v77
    v_and_b32 v59, s67, v77
    v_lshlrev_b32 v60, 16, v93
    v_and_b32 v61, s67, v93
    v_add_f32 v36, v36, v58
    v_add_f32 v37, v37, v59
    v_add_f32 v38, v38, v60
    v_add_f32 v39, v39, v61
    v_lshlrev_b32 v58, 16, v78
    v_and_b32 v59, s67, v78
    v_lshlrev_b32 v60, 16, v94
    v_and_b32 v61, s67, v94
    v_add_f32 v36, v36, v58
    v_add_f32 v37, v37, v59
    v_add_f32 v38, v38, v60
    v_add_f32 v39, v39, v61
    v_lshlrev_b32 v58, 16, v79
    v_and_b32 v59, s67, v79
    v_lshlrev_b32 v60, 16, v95
    v_and_b32 v61, s67, v95
    v_add_f32 v36, v36, v58
    v_add_f32 v37, v37, v59
    v_add_f32 v38, v38, v60
    v_add_f32 v39, v39, v61
    v_add_f32 v116, v116, v117
    v_add_f32 v117, v118, v119
    v_add_f32 v36, v36, v37
    v_add_f32 v38, v38, v39
    v_mov_b32 v58, v116
    v_mov_b32 v59, v117
    v_mov_b32 v60, v36
    v_mov_b32 v61, v38
    s_nop 1
    v_permlane32_swap_b32 v116, v58
    v_permlane32_swap_b32 v117, v59
    v_permlane32_swap_b32 v36, v60
    v_permlane32_swap_b32 v38, v61
    s_nop 1
    v_add_f32 v116, v116, v58
    v_add_f32 v117, v117, v59
    v_add_f32 v36, v36, v60
    v_add_f32 v38, v38, v61
    v_max_u32 v116, 1, v116
    v_max_u32 v117, 1, v117
    v_max_u32 v36, 1, v36
    v_max_u32 v38, 1, v38
    s_mul_i32 s39, s37, 10
    s_add_u32 s39, s39, s83
    s_lshl_b32 s39, s39, 10
    s_add_u32 s39, s39, 13762560
    s_cmp_lt_u32 s88, 10
    s_cselect_b32 s39, s39, 1073741824
    s_mul_i32 s42, s88, 10
    s_add_u32 s42, s42, s83
    s_lshl_b32 s42, s42, 11
    s_add_u32 s42, s42, 12845056
    s_cmp_lt_u32 s37, 10
    s_cselect_b32 s42, s42, 1073741824
    s_lshl_b32 s40, s36, 8
    s_add_u32 s39, s39, s40
    v_lshlrev_b32 v58, 1, v3
    v_cndmask_b32 v58, v58, v45, s[70:71]
    buffer_store_dwordx2 v[116:117], v58, s[20:23], s39 offen sc1
    v_add_u32 v59, s96, v3
    v_add_u32 v60, s97, v3
    v_cndmask_b32 v59, v59, v60, s[70:71]
    v_cndmask_b32 v36, v36, v38, s[70:71]
    buffer_store_dword v36, v59, s[20:23], s42 offen sc1
    s_waitcnt lgkmcnt(0)
    s_barrier
    s_waitcnt lgkmcnt(0)
    s_barrier
    s_waitcnt vmcnt(2)
    v_cmp_lt_u32 vcc, v8, v55
    s_mov_b32 s82, 0
    s_nop 3
    s_cbranch_vccz L_okSKV1
L_spSKV1:
    s_sleep 4
    buffer_load_dword v8, v51, s[24:27], 0 offen sc1
    s_waitcnt vmcnt(0)
    v_cmp_lt_u32 vcc, v8, v55
    s_add_u32 s82, s82, 1
    s_cmp_lt_u32 s82, 0x40000
    s_cselect_b64 s[94:95], -1, 0
    s_and_b64 vcc, vcc, s[94:95]
    s_cbranch_vccnz L_spSKV1
L_okSKV1:
    ds_read_b64_tr_b16 v[176:177], v150 offset:0
    ds_read_b64_tr_b16 v[178:179], v150 offset:1280
    ds_read_b64_tr_b16 v[180:181], v150 offset:32
    ds_read_b64_tr_b16 v[182:183], v150 offset:1312
    ds_read_b64_tr_b16 v[184:185], v150 offset:64
    ds_read_b64_tr_b16 v[186:187], v150 offset:1344
    ds_read_b64_tr_b16 v[188:189], v150 offset:96
    ds_read_b64_tr_b16 v[190:191], v150 offset:1376
    ds_read_b64_tr_b16 v[192:193], v150 offset:128
    ds_read_b64_tr_b16 v[194:195], v150 offset:1408
    ds_read_b64_tr_b16 v[196:197], v150 offset:5120
    ds_read_b64_tr_b16 v[198:199], v150 offset:6400
    ds_read_b64_tr_b16 v[200:201], v150 offset:5152
    ds_read_b64_tr_b16 v[202:203], v150 offset:6432
    ds_read_b64_tr_b16 v[204:205], v150 offset:5184
    ds_read_b64_tr_b16 v[206:207], v150 offset:6464
    ds_read_b64_tr_b16 v[208:209], v150 offset:5216
    ds_read_b64_tr_b16 v[210:211], v150 offset:6496
    ds_read_b64_tr_b16 v[212:213], v150 offset:5248
    ds_read_b64_tr_b16 v[214:215], v150 offset:6528
    s_waitcnt lgkmcnt(0)
    s_barrier
    buffer_store_dwordx4 v[176:179], v5, s[20:23], s77 offen offset:0 sc1
    buffer_store_dwordx4 v[180:183], v5, s[20:23], s77 offen offset:1024 sc1
    buffer_store_dwordx4 v[184:187], v5, s[20:23], s77 offen offset:2048 sc1
    buffer_store_dwordx4 v[196:199], v5, s[20:23], s63 offen offset:0 sc1
    buffer_store_dwordx4 v[200:203], v5, s[20:23], s63 offen offset:1024 sc1
    buffer_store_dwordx4 v[204:207], v5, s[20:23], s63 offen offset:2048 sc1
    s_waitcnt lgkmcnt(0)
    s_barrier
    buffer_store_dwordx4 v[188:191], v5, s[20:23], s77 offen offset:3072 sc1
    buffer_store_dwordx4 v[192:195], v6, s[20:23], s77 offen sc1
    buffer_store_dwordx4 v[208:211], v5, s[20:23], s63 offen offset:3072 sc1
    buffer_store_dwordx4 v[212:215], v6, s[20:23], s63 offen sc1
    s_add_u32 s39, s44, 0
    buffer_load_dwordx4 v[64:67], v152, s[20:23], s39 offen sc1
    s_add_u32 s39, s45, 0
    buffer_load_dwordx4 v[84:87], v153, s[20:23], s39 offen sc1
    s_waitcnt lgkmcnt(0)
    s_barrier
    s_add_u32 s39, s44, 2048
    buffer_load_dwordx4 v[68:71], v152, s[20:23], s39 offen sc1
    s_add_u32 s39, s45, 4096
    buffer_load_dwordx4 v[88:91], v153, s[20:23], s39 offen sc1
    s_add_u32 s39, s44, 4096
    buffer_load_dwordx4 v[72:75], v152, s[20:23], s39 offen sc1
    s_add_u32 s39, s45, 8192
    buffer_load_dwordx4 v[92:95], v153, s[20:23], s39 offen sc1
    s_add_u32 s39, s44, 6144
    buffer_load_dwordx4 v[76:79], v152, s[20:23], s39 offen sc1
    s_add_u32 s39, s45, 12288
    buffer_load_dwordx4 v[96:99], v153, s[20:23], s39 offen sc1
    s_add_u32 s39, s44, 8192
    buffer_load_dwordx4 v[80:83], v152, s[20:23], s39 offen sc1
    s_add_u32 s39, s45, 16384
    buffer_load_dwordx4 v[100:103], v153, s[20:23], s39 offen sc1
    s_waitcnt lgkmcnt(0)
    s_barrier
    s_waitcnt vmcnt(10)
    s_waitcnt lgkmcnt(0)
    s_barrier
    v_mov_b32 v9, 2
    buffer_store_dword v9, v4, s[20:23], s74 offen offset:0 sc1
    s_waitcnt vmcnt(1)
    s_mov_b32 s82, 0
L_pvKV:
    v_min_u32 v58, v64, v65
    v_min_u32 v59, v66, v67
    v_min3_u32 v58, v58, v68, v69
    v_min3_u32 v59, v59, v70, v71
    v_min3_u32 v58, v58, v72, v73
    v_min3_u32 v59, v59, v74, v75
    v_min3_u32 v58, v58, v76, v77
    v_min3_u32 v59, v59, v78, v79
    v_min3_u32 v58, v58, v80, v81
    v_min3_u32 v59, v59, v82, v83
    v_min3_u32 v58, v58, v84, v85
    v_min3_u32 v59, v59, v86, v87
    v_min3_u32 v58, v58, v88, v89
    v_min3_u32 v59, v59, v90, v91
    v_min3_u32 v58, v58, v92, v93
    v_min3_u32 v59, v59, v94, v95
    v_min3_u32 v58, v58, v96, v97
    v_min3_u32 v59, v59, v98, v99
    v_min3_u32 v58, v58, v100, v101
    v_min3_u32 v59, v59, v102, v103
    v_min_u32 v58, v58, v59
    v_cmp_eq_u32 vcc, 0, v58
    s_add_u32 s82, s82, 1
    s_cmp_lt_u32 s82, 0x20000
    s_cselect_b64 s[94:95], -1, 0
    s_and_b64 vcc, vcc, s[94:95]
    s_cbranch_vccz L_pvokKV
    s_sleep 2
    s_add_u32 s39, s44, 0
    buffer_load_dwordx4 v[64:67], v152, s[20:23], s39 offen sc1
    s_add_u32 s39, s45, 0
    buffer_load_dwordx4 v[84:87], v153, s[20:23], s39 offen sc1
    s_add_u32 s39, s44, 2048
    buffer_load_dwordx4 v[68:71], v152, s[20:23], s39 offen sc1
    s_add_u32 s39, s45, 4096
    buffer_load_dwordx4 v[88:91], v153, s[20:23], s39 offen sc1
    s_add_u32 s39, s44, 4096
    buffer_load_dwordx4 v[72:75], v152, s[20:23], s39 offen sc1
    s_add_u32 s39, s45, 8192
    buffer_load_dwordx4 v[92:95], v153, s[20:23], s39 offen sc1
    s_add_u32 s39, s44, 6144
    buffer_load_dwordx4 v[76:79], v152, s[20:23], s39 offen sc1
    s_add_u32 s39, s45, 12288
    buffer_load_dwordx4 v[96:99], v153, s[20:23], s39 offen sc1
    s_add_u32 s39, s44, 8192
    buffer_load_dwordx4 v[80:83], v152, s[20:23], s39 offen sc1
    s_add_u32 s39, s45, 16384
    buffer_load_dwordx4 v[100:103], v153, s[20:23], s39 offen sc1
    s_waitcnt vmcnt(0)
    s_branch L_pvKV
L_pvokKV:
    v_add_f32 v64, v64, v68
    v_add_f32 v84, v84, v88
    v_add_f32 v65, v65, v69
    v_add_f32 v85, v85, v89
    v_add_f32 v66, v66, v70
    v_add_f32 v86, v86, v90
    v_add_f32 v67, v67, v71
    v_add_f32 v87, v87, v91
    v_add_f32 v64, v64, v72
    v_add_f32 v84, v84, v92
    v_add_f32 v65, v65, v73
    v_add_f32 v85, v85, v93
    v_add_f32 v66, v66, v74
    v_add_f32 v86, v86, v94
    v_add_f32 v67, v67, v75
    v_add_f32 v87, v87, v95
    v_add_f32 v64, v64, v76
    v_add_f32 v84, v84, v96
    v_add_f32 v65, v65, v77
    v_add_f32 v85, v85, v97
    v_add_f32 v66, v66, v78
    v_add_f32 v86, v86, v98
    v_add_f32 v67, v67, v79
    v_add_f32 v87, v87, v99
    v_add_f32 v64, v64, v80
    v_add_f32 v84, v84, v100
    v_add_f32 v65, v65, v81
    v_add_f32 v85, v85, v101
    v_add_f32 v66, v66, v82
    v_add_f32 v86, v86, v102
    v_add_f32 v67, v67, v83
    v_add_f32 v87, v87, v103
    s_nop 1
    v_permlane32_swap_b32 v64, v66
    v_permlane32_swap_b32 v65, v67
    v_permlane32_swap_b32 v84, v86
    v_permlane32_swap_b32 v85, v87
    s_nop 1
    v_add_f32 v64, v64, v66
    v_add_f32 v65, v65, v67
    s_waitcnt lgkmcnt(0)
    s_barrier
    v_add_f32 v88, v84, v86
    v_add_f32 v96, v85, v87
    v_mul_f32 v15, 0x3acccccd, v64
    v_and_b32 v92, s67, v88
    v_mul_f32 v14, 0x3acccccd, v65
    v_and_b32 v100, s67, v96
    v_fma_f32 v14, -v15, v15, v14
    v_sub_f32 v92, v88, v92
    v_max_f32 v14, 0, v14
    v_sub_f32 v100, v96, v100
    v_cvt_pk_bf16_f32 v12, v15, v14
    v_lshrrev_b32 v88, 16, v88
    v_lshlrev_b32 v13, 16, v12
    v_lshrrev_b32 v96, 16, v96
    v_and_b32 v14, s67, v12
    v_and_or_b32 v90, v92, s67, v88
    v_add_f32 v14, 0x3727c5ac, v14
    v_and_or_b32 v98, v100, s67, v96
    v_cvt_pk_bf16_f32 v14, v14, v14
    v_and_b32 v93, s67, v92
    v_and_b32 v14, s67, v14
    v_and_b32 v101, s67, v100
    v_sqrt_f32 v14, v14
    v_sub_f32 v93, v92, v93
    v_xor_b32 v12, 0x80000000, v13
    v_sub_f32 v101, v100, v101
    v_cvt_pk_bf16_f32 v14, v14, v14
    v_lshrrev_b32 v91, 16, v93
    v_and_b32 v70, s67, v14
    v_lshrrev_b32 v99, 16, v101
    v_rcp_f32 v69, v70
    v_lshrrev_b32 v14, 16, v12
    v_mul_f32 v71, 0x3fb8aa3b, v69
    v_or_b32 v68, v12, v14
    v_lshrrev_b32 v11, 5, v154
    v_mul_u32_u24 v11, 768, v11
    v_add_u32 v11, 156672, v11
    v_and_b32 v13, 31, v154
    v_lshl_add_u32 v12, v13, 2, v11
    v_lshl_add_u32 v11, v13, 4, v11
    ds_write_b128 v11, v[68:71]
    ds_write_b32 v12, v71 offset:512
    ds_write_b32 v12, v69 offset:640
    ds_write_b64 v155, v[90:91] offset:0
    ds_write_b64 v155, v[98:99] offset:8
    s_waitcnt lgkmcnt(0)
    s_barrier
    v_lshlrev_b32 v58, 2, v56
    v_add_u32 v60, 4096, v58
    v_add_u32 v61, 6656, v58
    v_cmp_gt_u32 vcc, 16, v56
    s_lshl_b32 s40, s38, 13
    s_add_u32 s40, s40, 12582912
    v_cndmask_b32 v61, v45, v61, vcc
    s_barrier
    ds_read_b32 v64, v58 offset:0
    ds_read_b32 v65, v58 offset:6784
    ds_read_b32 v66, v58 offset:13568
    ds_read_b32 v67, v58 offset:20352
    ds_read_b32 v68, v58 offset:512
    ds_read_b32 v69, v58 offset:7296
    ds_read_b32 v70, v58 offset:14080
    ds_read_b32 v71, v58 offset:20864
    ds_read_b32 v72, v58 offset:1024
    ds_read_b32 v73, v58 offset:7808
    ds_read_b32 v74, v58 offset:14592
    ds_read_b32 v75, v58 offset:21376
    ds_read_b32 v76, v58 offset:1536
    ds_read_b32 v77, v58 offset:8320
    ds_read_b32 v78, v58 offset:15104
    ds_read_b32 v79, v58 offset:21888
    ds_read_b32 v80, v58 offset:2048
    ds_read_b32 v81, v58 offset:8832
    ds_read_b32 v82, v58 offset:15616
    ds_read_b32 v83, v58 offset:22400
    ds_read_b32 v84, v58 offset:2560
    ds_read_b32 v85, v58 offset:9344
    ds_read_b32 v86, v58 offset:16128
    ds_read_b32 v87, v58 offset:22912
    ds_read_b32 v88, v58 offset:3072
    ds_read_b32 v89, v58 offset:9856
    ds_read_b32 v90, v58 offset:16640
    ds_read_b32 v91, v58 offset:23424
    ds_read_b32 v92, v58 offset:3584
    ds_read_b32 v93, v58 offset:10368
    ds_read_b32 v94, v58 offset:17152
    ds_read_b32 v95, v58 offset:23936
    ds_read_b32 v96, v58 offset:4096
    ds_read_b32 v97, v58 offset:10880
    ds_read_b32 v98, v58 offset:17664
    ds_read_b32 v99, v58 offset:24448
    ds_read_b32 v100, v58 offset:4608
    ds_read_b32 v101, v58 offset:11392
    ds_read_b32 v102, v58 offset:18176
    ds_read_b32 v103, v58 offset:24960
    ds_read_b32 v104, v58 offset:5120
    ds_read_b32 v105, v58 offset:11904
    ds_read_b32 v106, v58 offset:18688
    ds_read_b32 v107, v58 offset:25472
    ds_read_b32 v108, v58 offset:5632
    ds_read_b32 v109, v58 offset:12416
    ds_read_b32 v110, v58 offset:19200
    ds_read_b32 v111, v58 offset:25984
    ds_read_b32 v112, v58 offset:6144
    ds_read_b32 v113, v58 offset:12928
    ds_read_b32 v114, v58 offset:19712
    ds_read_b32 v115, v58 offset:26496
    ds_read_b32 v116, v58 offset:6656
    ds_read_b32 v117, v58 offset:13440
    ds_read_b32 v118, v58 offset:20224
    ds_read_b32 v119, v58 offset:27008
    s_waitcnt lgkmcnt(15)
    v_add_f32 v64, v64, v65
    v_add_f32 v66, v66, v67
    v_add_f32 v64, v64, v66
    buffer_atomic_add_f32 v64, v58, s[20:23], s40 offen offset:0
    s_waitcnt lgkmcnt(15)
    v_add_f32 v68, v68, v69
    v_add_f32 v70, v70, v71
    v_add_f32 v68, v68, v70
    buffer_atomic_add_f32 v68, v58, s[20:23], s40 offen offset:512
    s_waitcnt lgkmcnt(15)
    v_add_f32 v72, v72, v73
    v_add_f32 v74, v74, v75
    v_add_f32 v72, v72, v74
    buffer_atomic_add_f32 v72, v58, s[20:23], s40 offen offset:1024
    s_waitcnt lgkmcnt(15)
    v_add_f32 v76, v76, v77
    v_add_f32 v78, v78, v79
    v_add_f32 v76, v76, v78
    buffer_atomic_add_f32 v76, v58, s[20:23], s40 offen offset:1536
    s_waitcnt lgkmcnt(15)
    v_add_f32 v80, v80, v81
    v_add_f32 v82, v82, v83
    v_add_f32 v80, v80, v82
    buffer_atomic_add_f32 v80, v58, s[20:23], s40 offen offset:2048
    s_waitcnt lgkmcnt(15)
    v_add_f32 v84, v84, v85
    v_add_f32 v86, v86, v87
    v_add_f32 v84, v84, v86
    buffer_atomic_add_f32 v84, v58, s[20:23], s40 offen offset:2560
    s_waitcnt lgkmcnt(15)
    v_add_f32 v88, v88, v89
    v_add_f32 v90, v90, v91
    v_add_f32 v88, v88, v90
    buffer_atomic_add_f32 v88, v58, s[20:23], s40 offen offset:3072
    s_waitcnt lgkmcnt(15)
    v_add_f32 v92, v92, v93
    v_add_f32 v94, v94, v95
    v_add_f32 v92, v92, v94
    buffer_atomic_add_f32 v92, v58, s[20:23], s40 offen offset:3584
    s_waitcnt lgkmcnt(15)
    v_add_f32 v96, v96, v97
    v_add_f32 v98, v98, v99
    v_add_f32 v96, v96, v98
    buffer_atomic_add_f32 v96, v60, s[20:23], s40 offen offset:0
    s_waitcnt lgkmcnt(15)
    v_add_f32 v100, v100, v101
    v_add_f32 v102, v102, v103
    v_add_f32 v100, v100, v102
    buffer_atomic_add_f32 v100, v60, s[20:23], s40 offen offset:512
    s_waitcnt lgkmcnt(12)
    v_add_f32 v104, v104, v105
    v_add_f32 v106, v106, v107
    v_add_f32 v104, v104, v106
    buffer_atomic_add_f32 v104, v60, s[20:23], s40 offen offset:1024
    s_waitcnt lgkmcnt(8)
    v_add_f32 v108, v108, v109
    v_add_f32 v110, v110, v111
    v_add_f32 v108, v108, v110
    buffer_atomic_add_f32 v108, v60, s[20:23], s40 offen offset:1536
    s_waitcnt lgkmcnt(4)
    v_add_f32 v112, v112, v113
    v_add_f32 v114, v114, v115
    v_add_f32 v112, v112, v114
    buffer_atomic_add_f32 v112, v60, s[20:23], s40 offen offset:2048
    s_waitcnt lgkmcnt(0)
    v_add_f32 v116, v116, v117
    v_add_f32 v118, v118, v119
    v_add_f32 v116, v116, v118
    buffer_atomic_add_f32 v116, v61, s[20:23], s40 offen
    s_waitcnt vmcnt(0)
    v_mov_b32 v9, 3
    buffer_store_dword v9, v4, s[20:23], s74 offen offset:4 sc1
    s_waitcnt lgkmcnt(0)
    s_barrier
    s_waitcnt lgkmcnt(0)
    s_barrier
    s_waitcnt lgkmcnt(0)
    s_barrier
    s_waitcnt lgkmcnt(0)
    s_barrier
    s_waitcnt lgkmcnt(0)
    s_barrier
    buffer_load_dword v8, v48, s[20:23], 0 offen sc1
    s_waitcnt lgkmcnt(0)
    s_barrier
    s_waitcnt vmcnt(0)
    s_waitcnt vmcnt(0)
    v_cmp_lt_u32 vcc, v8, v53
    s_mov_b32 s82, 0
    s_nop 3
    s_cbranch_vccz L_okSKV2
L_spSKV2:
    s_sleep 4
    buffer_load_dword v8, v48, s[20:23], 0 offen sc1
    s_waitcnt vmcnt(0)
    v_cmp_lt_u32 vcc, v8, v53
    s_add_u32 s82, s82, 1
    s_cmp_lt_u32 s82, 0x40000
    s_cselect_b64 s[94:95], -1, 0
    s_and_b64 vcc, vcc, s[94:95]
    s_cbranch_vccnz L_spSKV2
L_okSKV2:
    s_waitcnt lgkmcnt(0)
    s_barrier
    s_waitcnt lgkmcnt(0)
    s_barrier
    s_waitcnt lgkmcnt(0)
    s_barrier
    buffer_load_dword v8, v48, s[20:23], 0 offen sc1
    s_waitcnt lgkmcnt(0)
    s_barrier
    s_waitcnt vmcnt(0)
    s_waitcnt vmcnt(0)
    v_cmp_lt_u32 vcc, v8, v49
    s_mov_b32 s82, 0
    s_nop 3
    s_cbranch_vccz L_okSKV3
L_spSKV3:
    s_sleep 4
    buffer_load_dword v8, v48, s[20:23], 0 offen sc1
    s_waitcnt vmcnt(0)
    v_cmp_lt_u32 vcc, v8, v49
    s_add_u32 s82, s82, 1
    s_cmp_lt_u32 s82, 0x40000
    s_cselect_b64 s[94:95], -1, 0
    s_and_b64 vcc, vcc, s[94:95]
    s_cbranch_vccnz L_spSKV3
L_okSKV3:
    s_waitcnt lgkmcnt(0)
    s_barrier
    s_waitcnt lgkmcnt(0)
    s_barrier
    s_waitcnt lgkmcnt(0)
    s_barrier
    s_waitcnt lgkmcnt(0)
    s_barrier
    s_waitcnt lgkmcnt(0)
    s_barrier
    s_waitcnt lgkmcnt(0)
    s_barrier
    s_waitcnt lgkmcnt(0)
    s_barrier
    s_endpgm
L_SKV_end:
L_CQ:
    s_getpc_b64 s[32:33]
L_CQ_pc:
    s_mov_b32 s34, L_SQ_end-L_CQ_pc
    s_mov_b32 s35, 0x00020000
    v_lshlrev_b32 v10, 7, v0
    buffer_load_dword v255, v10, s[32:35], 0 offen
    v_mov_b32 v32, 0
    v_mov_b32 v33, 0
    v_mov_b32 v34, 0
    v_mov_b32 v35, 0
    s_mul_i32 s39, s37, 10
    s_add_u32 s39, s39, s83
    s_lshl_b32 s39, s39, 10
    s_add_u32 s39, s39, 13762560
    s_cmp_lt_u32 s88, 10
    s_cselect_b32 s39, s39, 1073741824
    s_mul_i32 s40, s88, 10
    s_add_u32 s40, s40, s83
    s_lshl_b32 s40, s40, 11
    s_add_u32 s40, s40, 12845056
    s_cmp_lt_u32 s37, 10
    s_cselect_b32 s40, s40, 1073741824
    s_cmp_eq_u32 s36, 0
    s_cselect_b32 s39, s39, 1073741824
    s_cselect_b32 s40, s40, 1073741824
    s_and_b32 s41, s74, 0xffffff80
    v_mov_b32 v11, 1073741824
    v_cmp_gt_u32 vcc, 8, v0
    s_nop 1
    v_cndmask_b32 v10, v11, v5, vcc
    s_waitcnt lgkmcnt(0)
    s_mov_b32 s20, s58
    s_mov_b32 s21, s59
    s_mov_b32 s22, 14680064
    s_mov_b32 s23, 0x00020000
    buffer_store_dwordx4 v[32:35], v10, s[20:23], s41 offen sc1
    buffer_store_dwordx4 v[32:35], v5, s[20:23], s39 offen sc1
    buffer_store_dwordx4 v[32:35], v5, s[20:23], s40 offen sc1
    buffer_store_dwordx4 v[32:35], v10, s[20:23], s40 offen offset:1024 sc1
    s_mov_b32 s8, s44
    s_mov_b32 s9, s45
    s_mov_b32 s10, 2621440
    s_mov_b32 s11, 0x00020000
    s_mov_b32 s84, s50
    s_mov_b32 s85, s51
    s_mov_b32 s86, 2621440
    s_mov_b32 s87, 0x00020000
    s_mov_b32 s24, s56
    s_mov_b32 s25, s57
    s_mov_b32 s26, 256
    s_mov_b32 s27, 0x00020000
    v_and_b32 v10, 31, v1
    v_bfe_u32 v11, v1, 1, 3
    v_xor_b32 v11, v11, v2
    s_lshl_b32 s39, s36, 12
    v_lshl_add_u32 v10, v10, 7, s39
    v_xor_b32 v12, 0, v11
    v_lshl_add_u32 v18, v12, 4, v10
    v_xor_b32 v12, 2, v11
    v_lshl_add_u32 v19, v12, 4, v10
    v_xor_b32 v12, 4, v11
    v_lshl_add_u32 v20, v12, 4, v10
    v_xor_b32 v12, 6, v11
    v_lshl_add_u32 v21, v12, 4, v10
    v_bfe_u32 v10, v1, 2, 2
    v_and_b32 v11, 3, v1
    v_lshlrev_b32 v11, 3, v11
    v_and_b32 v12, 16, v1
    v_lshl_add_u32 v11, v12, 1, v11
    v_lshl_add_u32 v22, v10, 6, v11
    v_mul_u32_u24 v12, 2048, v2
    v_add_u32 v22, v22, v12
    v_add_u32 v22, 16384, v22
    v_bfe_u32 v10, v1, 2, 2
    v_and_b32 v11, 3, v1
    v_lshlrev_b32 v11, 3, v11
    v_and_b32 v12, 16, v1
    v_lshl_add_u32 v11, v12, 1, v11
    v_lshl_add_u32 v12, v2, 3, v10
    v_mul_u32_u24 v23, 192, v12
    v_add_u32 v23, v23, v11
    v_add_u32 v23, 69632, v23
    v_bfe_u32 v10, v1, 2, 2
    v_and_b32 v11, 3, v1
    v_lshlrev_b32 v11, 3, v11
    v_and_b32 v12, 16, v1
    v_lshl_add_u32 v11, v12, 1, v11
    v_lshl_add_u32 v28, v10, 6, v11
    v_mul_u32_u24 v12, 1024, v2
    v_add_u32 v28, v28, v12
    v_add_u32 v28, 61440, v28
    v_and_b32 v10, 15, v1
    v_lshlrev_b32 v10, 4, v10
    v_lshl_add_u32 v10, v2, 8, v10
    v_and_b32 v11, 16, v1
    v_lshl_add_u32 v10, v11, 6, v10
    s_and_b32 s39, s36, 1
    s_lshl_b32 s39, s39, 11
    v_add_u32 v24, s39, v10
    s_lshr_b32 s39, s36, 1
    s_lshl_b32 s40, s37, 1
    s_add_u32 s39, s39, s40
    s_mul_i32 s68, s39, 278528
    v_mov_b32 v36, 0
    v_mov_b32 v37, 0
    v_mov_b32 v38, 0
    v_mov_b32 v39, 0
    v_mov_b32 v40, 0
    v_mov_b32 v41, 0
    v_mov_b32 v42, 0
    v_mov_b32 v43, 0
    v_mov_b32 v44, 0
    v_mov_b32 v45, 0
    v_mov_b32 v46, 0
    v_mov_b32 v47, 0
    v_mov_b32 v48, 0
    v_mov_b32 v49, 0
    v_mov_b32 v50, 0
    v_mov_b32 v51, 0
    v_mov_b32 v52, 0
    v_mov_b32 v53, 0
    v_mov_b32 v54, 0
    v_mov_b32 v55, 0
    v_mov_b32 v56, 0
    v_mov_b32 v57, 0
    v_mov_b32 v58, 0
    v_mov_b32 v59, 0
    v_mov_b32 v60, 0
    v_mov_b32 v61, 0
    v_mov_b32 v62, 0
    v_mov_b32 v63, 0
    v_mov_b32 v64, 0
    v_mov_b32 v65, 0
    v_mov_b32 v66, 0
    v_mov_b32 v67, 0
    v_mov_b32 v68, 0
    v_mov_b32 v69, 0
    v_mov_b32 v70, 0
    v_mov_b32 v71, 0
    v_mov_b32 v72, 0
    v_mov_b32 v73, 0
    v_mov_b32 v74, 0
    v_mov_b32 v75, 0
    v_mov_b32 v76, 0
    v_mov_b32 v77, 0
    v_mov_b32 v78, 0
    v_mov_b32 v79, 0
    v_mov_b32 v80, 0
    v_mov_b32 v81, 0
    v_mov_b32 v82, 0
    v_mov_b32 v83, 0
    v_mov_b32 v84, 0
    v_mov_b32 v85, 0
    v_mov_b32 v86, 0
    v_mov_b32 v87, 0
    v_mov_b32 v88, 0
    v_mov_b32 v89, 0
    v_mov_b32 v90, 0
    v_mov_b32 v91, 0
    v_mov_b32 v92, 0
    v_mov_b32 v93, 0
    v_mov_b32 v94, 0
    v_mov_b32 v95, 0
    v_mov_b32 v96, 0
    v_mov_b32 v97, 0
    v_mov_b32 v98, 0
    v_mov_b32 v99, 0
    v_mov_b32 v100, 0
    v_mov_b32 v101, 0
    v_mov_b32 v102, 0
    v_mov_b32 v103, 0
    v_mov_b32 v104, 0
    v_mov_b32 v105, 0
    v_mov_b32 v106, 0
    v_mov_b32 v107, 0
    v_mov_b32 v108, 0
    v_mov_b32 v109, 0
    v_mov_b32 v110, 0
    v_mov_b32 v111, 0
    v_mov_b32 v112, 0
    v_mov_b32 v113, 0
    v_mov_b32 v114, 0
    v_mov_b32 v115, 0
    v_mov_b32 v116, 0
    v_mov_b32 v117, 0
    v_mov_b32 v118, 0
    v_mov_b32 v119, 0
    v_mov_b32 v120, 0
    v_mov_b32 v121, 0
    v_mov_b32 v122, 0
    v_mov_b32 v123, 0
    v_mov_b32 v124, 0
    v_mov_b32 v125, 0
    v_mov_b32 v126, 0
    v_mov_b32 v127, 0
    v_mov_b32 v128, 0
    v_mov_b32 v129, 0
    v_mov_b32 v130, 0
    v_mov_b32 v131, 0
    v_mov_b32 v132, 0
    v_mov_b32 v133, 0
    v_mov_b32 v134, 0
    v_mov_b32 v135, 0
    v_mov_b32 v136, 0
    v_mov_b32 v137, 0
    v_mov_b32 v138, 0
    v_mov_b32 v139, 0
    v_mov_b32 v140, 0
    v_mov_b32 v141, 0
    v_mov_b32 v142, 0
    v_mov_b32 v143, 0
    v_mov_b32 v144, 0
    v_mov_b32 v145, 0
    v_mov_b32 v146, 0
    v_mov_b32 v147, 0
    v_mov_b32 v148, 0
    v_mov_b32 v149, 0
    v_mov_b32 v150, 0
    v_mov_b32 v151, 0
    v_mov_b32 v152, 0
    v_mov_b32 v153, 0
    v_mov_b32 v154, 0
    v_mov_b32 v155, 0
    v_mov_b32 v156, 0
    v_mov_b32 v157, 0
    v_mov_b32 v158, 0
    v_mov_b32 v159, 0
    v_mov_b32 v160, 0
    v_mov_b32 v161, 0
    v_mov_b32 v162, 0
    v_mov_b32 v163, 0
    v_mov_b32 v164, 0
    v_mov_b32 v165, 0
    v_mov_b32 v166, 0
    v_mov_b32 v167, 0
    v_mov_b32 v168, 0
    v_mov_b32 v169, 0
    v_mov_b32 v170, 0
    v_mov_b32 v171, 0
    v_mov_b32 v172, 0
    v_mov_b32 v173, 0
    v_mov_b32 v174, 0
    v_mov_b32 v175, 0
    v_mov_b32 v192, 0
    v_mov_b32 v193, 0
    v_mov_b32 v194, 0
    v_mov_b32 v195, 0
    v_mov_b32 v196, 0
    v_mov_b32 v197, 0
    v_mov_b32 v198, 0
    v_mov_b32 v199, 0
    v_mov_b32 v200, 0
    v_mov_b32 v201, 0
    v_mov_b32 v202, 0
    v_mov_b32 v203, 0
    v_mov_b32 v204, 0
    v_mov_b32 v205, 0
    v_mov_b32 v206, 0
    v_mov_b32 v207, 0
    v_mov_b32 v228, 0
    v_mov_b32 v229, 0
    v_mov_b32 v230, 0
    v_mov_b32 v231, 0
    v_mov_b32 v246, 0
    v_mov_b32 v247, 0
    v_lshlrev_b32 v25, 1, v3
    v_add_u32 v25, 159744, v25
    s_mul_i32 s39, s36, 768
    s_add_u32 s39, s39, 156672
    v_lshl_add_u32 v26, v3, 2, s39
    v_lshl_add_u32 v27, v2, 4, s39
    s_and_b32 s39, s2, 1
    s_lshl_b32 s39, s39, 7
    v_mov_b32 v10, s39
    v_mov_b32 v11, 1073741824
    v_cmp_eq_u32 vcc, 0, v0
    v_mov_b32 v12, 1
    s_nop 0
    v_cndmask_b32 v10, v11, v10, vcc
    s_waitcnt vmcnt(0)
    buffer_atomic_add v12, v10, s[24:27], 0 offen
    s_mov_b32 s93, 0
    s_mov_b32 s96, 0
    .p2align 3
L_CQ_p1:
    s_waitcnt lgkmcnt(0)
    s_barrier
    v_mfma_f32_32x32x16_bf16 v[32:47], v[192:195], v[228:231], v[32:47]
    ds_read_b128 v[224:227], v18
    ds_read_b64_tr_b16 v[176:177], v22 offset:0
    ds_read_b64_tr_b16 v[178:179], v22 offset:256
    ds_read_b64_tr_b16 v[180:181], v22 offset:512
    v_mfma_f32_32x32x16_bf16 v[48:63], v[196:199], v[228:231], v[48:63]
    ds_read_b64_tr_b16 v[182:183], v22 offset:768
    ds_read_b64_tr_b16 v[184:185], v22 offset:1024
    ds_read_b64_tr_b16 v[186:187], v22 offset:1280
    ds_read_b64_tr_b16 v[188:189], v22 offset:1536
    v_mfma_f32_32x32x16_bf16 v[64:79], v[200:203], v[228:231], v[64:79]
    ds_read_b64_tr_b16 v[190:191], v22 offset:1792
    v_mfma_f32_32x32x16_bf16 v[80:95], v[204:207], v[228:231], v[80:95]
    s_waitcnt lgkmcnt(0)
    v_mfma_f32_32x32x16_bf16 v[32:47], v[176:179], v[224:227], v[32:47]
    ds_read_b128 v[228:231], v19
    ds_read_b64_tr_b16 v[192:193], v22 offset:4096
    ds_read_b64_tr_b16 v[194:195], v22 offset:4352
    ds_read_b64_tr_b16 v[196:197], v22 offset:4608
    v_mfma_f32_32x32x16_bf16 v[48:63], v[180:183], v[224:227], v[48:63]
    ds_read_b64_tr_b16 v[198:199], v22 offset:4864
    ds_read_b64_tr_b16 v[200:201], v22 offset:5120
    ds_read_b64_tr_b16 v[202:203], v22 offset:5376
    ds_read_b64_tr_b16 v[204:205], v22 offset:5632
    v_mfma_f32_32x32x16_bf16 v[64:79], v[184:187], v[224:227], v[64:79]
    ds_read_b64_tr_b16 v[206:207], v22 offset:5888
    v_mfma_f32_32x32x16_bf16 v[80:95], v[188:191], v[224:227], v[80:95]
    s_waitcnt lgkmcnt(0)
    v_mfma_f32_32x32x16_bf16 v[32:47], v[192:195], v[228:231], v[32:47]
    ds_read_b128 v[224:227], v20
    ds_read_b64_tr_b16 v[176:177], v22 offset:8192
    ds_read_b64_tr_b16 v[178:179], v22 offset:8448
    ds_read_b64_tr_b16 v[180:181], v22 offset:8704
    v_mfma_f32_32x32x16_bf16 v[48:63], v[196:199], v[228:231], v[48:63]
    ds_read_b64_tr_b16 v[182:183], v22 offset:8960
    ds_read_b64_tr_b16 v[184:185], v22 offset:9216
    ds_read_b64_tr_b16 v[186:187], v22 offset:9472
    ds_read_b64_tr_b16 v[188:189], v22 offset:9728
    v_mfma_f32_32x32x16_bf16 v[64:79], v[200:203], v[228:231], v[64:79]
    ds_read_b64_tr_b16 v[190:191], v22 offset:9984
    v_mfma_f32_32x32x16_bf16 v[80:95], v[204:207], v[228:231], v[80:95]
    s_add_u32 s96, s96, 1
    s_cmp_eq_u32 s96, 3
    s_cselect_b32 s96, 0, s96
    s_mov_b32 s97, 45056
    s_cselect_b32 s97, 0xfffea000, s97
    s_add_u32 s93, s93, 1
    s_cmp_lt_u32 s93, 10
    s_waitcnt lgkmcnt(0)
    v_mfma_f32_32x32x16_bf16 v[32:47], v[176:179], v[224:227], v[32:47]
    ds_read_b128 v[228:231], v21
    ds_read_b64_tr_b16 v[192:193], v22 offset:12288
    ds_read_b64_tr_b16 v[194:195], v22 offset:12544
    ds_read_b64_tr_b16 v[196:197], v22 offset:12800
    v_mfma_f32_32x32x16_bf16 v[48:63], v[180:183], v[224:227], v[48:63]
    ds_read_b64_tr_b16 v[198:199], v22 offset:13056
    ds_read_b64_tr_b16 v[200:201], v22 offset:13312
    ds_read_b64_tr_b16 v[202:203], v22 offset:13568
    ds_read_b64_tr_b16 v[204:205], v22 offset:13824
    v_mfma_f32_32x32x16_bf16 v[64:79], v[184:187], v[224:227], v[64:79]
    ds_read_b64_tr_b16 v[206:207], v22 offset:14080
    v_mfma_f32_32x32x16_bf16 v[80:95], v[188:191], v[224:227], v[80:95]
    v_add_u32 v18, s97, v18
    v_add_u32 v19, s97, v19
    v_add_u32 v20, s97, v20
    v_add_u32 v21, s97, v21
    v_add_u32 v22, s97, v22
    s_cbranch_scc1 L_CQ_p1
    s_waitcnt lgkmcnt(0)
    s_barrier
    ds_read_b128 v[248:251], v26
    ds_read_b64 v[176:177], v25 offset:0
    ds_read_b64 v[180:181], v25 offset:256
    ds_read_b64 v[184:185], v25 offset:512
    ds_read_b64 v[188:189], v25 offset:768
    ds_read_b64 v[208:209], v25 offset:1024
    ds_read_b64 v[212:213], v25 offset:1280
    ds_read_b64 v[216:217], v25 offset:1536
    ds_read_b64 v[220:221], v25 offset:1792
    ds_read_b64 v[232:233], v25 offset:2048
    v_mfma_f32_32x32x16_bf16 v[32:47], v[192:195], v[228:231], v[32:47]
    v_mov_b32 v178, 0
    v_mov_b32 v179, 0
    v_mov_b32 v182, 0
    v_mov_b32 v183, 0
    v_mov_b32 v186, 0
    v_mfma_f32_32x32x16_bf16 v[48:63], v[196:199], v[228:231], v[48:63]
    v_mov_b32 v187, 0
    v_mov_b32 v190, 0
    v_mov_b32 v191, 0
    v_mov_b32 v210, 0
    v_mov_b32 v211, 0
    v_mfma_f32_32x32x16_bf16 v[64:79], v[200:203], v[228:231], v[64:79]
    v_mov_b32 v214, 0
    v_mov_b32 v215, 0
    v_mov_b32 v218, 0
    v_mov_b32 v219, 0
    v_mov_b32 v222, 0
    v_mfma_f32_32x32x16_bf16 v[80:95], v[204:207], v[228:231], v[80:95]
    v_mov_b32 v223, 0
    v_mov_b32 v234, 0
    v_mov_b32 v235, 0
    s_waitcnt lgkmcnt(0)
    v_lshrrev_b32 v14, 16, v248
    v_cndmask_b32 v244, v248, 0, s[70:71]
    v_cndmask_b32 v245, v14, 0, s[70:71]
    s_nop 1
    v_mfma_f32_32x32x16_bf16 v[32:47], v[176:179], v[244:247], v[32:47]
    v_mfma_f32_32x32x16_bf16 v[48:63], v[180:183], v[244:247], v[48:63]
    v_mfma_f32_32x32x16_bf16 v[64:79], v[184:187], v[244:247], v[64:79]
    v_mfma_f32_32x32x16_bf16 v[80:95], v[188:191], v[244:247], v[80:95]
    v_mfma_f32_32x32x16_bf16 v[96:111], v[208:211], v[244:247], v[96:111]
    v_mfma_f32_32x32x16_bf16 v[112:127], v[212:215], v[244:247], v[112:127]
    v_mfma_f32_32x32x16_bf16 v[128:143], v[216:219], v[244:247], v[128:143]
    v_mfma_f32_32x32x16_bf16 v[144:159], v[220:223], v[244:247], v[144:159]
    v_mfma_f32_32x32x16_bf16 v[160:175], v[232:235], v[244:247], v[160:175]
    s_waitcnt lgkmcnt(0)
    s_barrier
    ds_read_b128 v[224:227], v18
    ds_read_b64_tr_b16 v[176:177], v28 offset:0
    ds_read_b64_tr_b16 v[178:179], v28 offset:256
    ds_read_b64_tr_b16 v[180:181], v28 offset:512
    ds_read_b64_tr_b16 v[182:183], v28 offset:768
    ds_read_b64_tr_b16 v[184:185], v23 offset:0
    ds_read_b64_tr_b16 v[186:187], v23 offset:768
    ds_read_b64_tr_b16 v[188:189], v23 offset:64
    ds_read_b64_tr_b16 v[190:191], v23 offset:832
    ds_read_b64_tr_b16 v[192:193], v23 offset:128
    ds_read_b64_tr_b16 v[194:195], v23 offset:896
    s_lshl_b32 s41, s37, 2
    s_add_u32 s41, s41, s36
    s_lshl_b32 s41, s41, 7
    s_add_u32 s41, s41, 13631488
    s_cmp_eq_u32 s38, 0
    s_cselect_b32 s41, s41, 1073741824
    buffer_store_dword v249, v3, s[20:23], s41 offen sc1
    s_lshl_b32 s91, s38, 14
    s_add_u32 s91, s91, s68
    v_max_f32 v32, 0, v32
    v_max_f32 v33, 0, v33
    v_cvt_pk_bf16_f32 v32, v32, v33
    v_max_f32 v34, 0, v34
    v_max_f32 v35, 0, v35
    v_cvt_pk_bf16_f32 v33, v34, v35
    v_max_f32 v36, 0, v36
    v_max_f32 v37, 0, v37
    v_cvt_pk_bf16_f32 v34, v36, v37
    v_max_f32 v38, 0, v38
    v_max_f32 v39, 0, v39
    v_cvt_pk_bf16_f32 v35, v38, v39
    v_max_f32 v40, 0, v40
    v_max_f32 v41, 0, v41
    v_cvt_pk_bf16_f32 v36, v40, v41
    s_waitcnt lgkmcnt(0)
    v_mfma_f32_32x32x16_bf16 v[96:111], v[176:179], v[224:227], v[96:111]
    ds_read_b128 v[228:231], v19
    ds_read_b64_tr_b16 v[196:197], v28 offset:2048
    ds_read_b64_tr_b16 v[198:199], v28 offset:2304
    ds_read_b64_tr_b16 v[200:201], v28 offset:2560
    v_max_f32 v42, 0, v42
    v_max_f32 v43, 0, v43
    v_cvt_pk_bf16_f32 v37, v42, v43
    v_max_f32 v44, 0, v44
    v_max_f32 v45, 0, v45
    v_mfma_f32_32x32x16_bf16 v[112:127], v[180:183], v[224:227], v[112:127]
    ds_read_b64_tr_b16 v[202:203], v28 offset:2816
    ds_read_b64_tr_b16 v[204:205], v23 offset:3072
    ds_read_b64_tr_b16 v[206:207], v23 offset:3840
    ds_read_b64_tr_b16 v[208:209], v23 offset:3136
    v_cvt_pk_bf16_f32 v38, v44, v45
    v_max_f32 v46, 0, v46
    v_max_f32 v47, 0, v47
    v_cvt_pk_bf16_f32 v39, v46, v47
    s_add_u32 s40, s91, 0
    v_mfma_f32_32x32x16_bf16 v[128:143], v[184:187], v[224:227], v[128:143]
    ds_read_b64_tr_b16 v[210:211], v23 offset:3904
    ds_read_b64_tr_b16 v[212:213], v23 offset:3200
    ds_read_b64_tr_b16 v[214:215], v23 offset:3968
    buffer_store_dwordx4 v[32:35], v24, s[20:23], s40 offen sc1
    buffer_store_dwordx4 v[36:39], v24, s[20:23], s40 offen offset:512 sc1
    v_max_f32 v48, 0, v48
    v_max_f32 v49, 0, v49
    v_cvt_pk_bf16_f32 v48, v48, v49
    v_mfma_f32_32x32x16_bf16 v[144:159], v[188:191], v[224:227], v[144:159]
    v_max_f32 v50, 0, v50
    v_max_f32 v51, 0, v51
    v_cvt_pk_bf16_f32 v49, v50, v51
    v_max_f32 v52, 0, v52
    v_max_f32 v53, 0, v53
    v_mfma_f32_32x32x16_bf16 v[160:175], v[192:195], v[224:227], v[160:175]
    v_cvt_pk_bf16_f32 v50, v52, v53
    v_max_f32 v54, 0, v54
    v_max_f32 v55, 0, v55
    v_cvt_pk_bf16_f32 v51, v54, v55
    v_max_f32 v56, 0, v56
    s_waitcnt lgkmcnt(0)
    v_mfma_f32_32x32x16_bf16 v[96:111], v[196:199], v[228:231], v[96:111]
    ds_read_b128 v[224:227], v20
    ds_read_b64_tr_b16 v[176:177], v28 offset:4096
    ds_read_b64_tr_b16 v[178:179], v28 offset:4352
    ds_read_b64_tr_b16 v[180:181], v28 offset:4608
    v_max_f32 v57, 0, v57
    v_cvt_pk_bf16_f32 v52, v56, v57
    v_max_f32 v58, 0, v58
    v_max_f32 v59, 0, v59
    v_cvt_pk_bf16_f32 v53, v58, v59
    v_mfma_f32_32x32x16_bf16 v[112:127], v[200:203], v[228:231], v[112:127]
    ds_read_b64_tr_b16 v[182:183], v28 offset:4864
    ds_read_b64_tr_b16 v[184:185], v23 offset:6144
    ds_read_b64_tr_b16 v[186:187], v23 offset:6912
    ds_read_b64_tr_b16 v[188:189], v23 offset:6208
    v_max_f32 v60, 0, v60
    v_max_f32 v61, 0, v61
    v_cvt_pk_bf16_f32 v54, v60, v61
    v_max_f32 v62, 0, v62
    v_max_f32 v63, 0, v63
    v_mfma_f32_32x32x16_bf16 v[128:143], v[204:207], v[228:231], v[128:143]
    ds_read_b64_tr_b16 v[190:191], v23 offset:6976
    ds_read_b64_tr_b16 v[192:193], v23 offset:6272
    ds_read_b64_tr_b16 v[194:195], v23 offset:7040
    v_cvt_pk_bf16_f32 v55, v62, v63
    s_add_u32 s40, s91, 4096
    buffer_store_dwordx4 v[48:51], v24, s[20:23], s40 offen sc1
    buffer_store_dwordx4 v[52:55], v24, s[20:23], s40 offen offset:512 sc1
    v_max_f32 v64, 0, v64
    v_mfma_f32_32x32x16_bf16 v[144:159], v[208:211], v[228:231], v[144:159]
    v_max_f32 v65, 0, v65
    v_cvt_pk_bf16_f32 v64, v64, v65
    v_max_f32 v66, 0, v66
    v_max_f32 v67, 0, v67
    v_cvt_pk_bf16_f32 v65, v66, v67
    v_mfma_f32_32x32x16_bf16 v[160:175], v[212:215], v[228:231], v[160:175]
    v_max_f32 v68, 0, v68
    v_max_f32 v69, 0, v69
    v_cvt_pk_bf16_f32 v66, v68, v69
    v_max_f32 v70, 0, v70
    v_max_f32 v71, 0, v71
    s_waitcnt lgkmcnt(0)
    v_mfma_f32_32x32x16_bf16 v[96:111], v[176:179], v[224:227], v[96:111]
    ds_read_b128 v[228:231], v21
    ds_read_b64_tr_b16 v[196:197], v28 offset:6144
    ds_read_b64_tr_b16 v[198:199], v28 offset:6400
    ds_read_b64_tr_b16 v[200:201], v28 offset:6656
    v_cvt_pk_bf16_f32 v67, v70, v71
    v_max_f32 v72, 0, v72
    v_max_f32 v73, 0, v73
    v_cvt_pk_bf16_f32 v68, v72, v73
    v_max_f32 v74, 0, v74
    v_mfma_f32_32x32x16_bf16 v[112:127], v[180:183], v[224:227], v[112:127]
    ds_read_b64_tr_b16 v[202:203], v28 offset:6912
    ds_read_b64_tr_b16 v[204:205], v23 offset:9216
    ds_read_b64_tr_b16 v[206:207], v23 offset:9984
    ds_read_b64_tr_b16 v[208:209], v23 offset:9280
    v_max_f32 v75, 0, v75
    v_cvt_pk_bf16_f32 v69, v74, v75
    v_max_f32 v76, 0, v76
    v_max_f32 v77, 0, v77
    v_cvt_pk_bf16_f32 v70, v76, v77
    v_mfma_f32_32x32x16_bf16 v[128:143], v[184:187], v[224:227], v[128:143]
    ds_read_b64_tr_b16 v[210:211], v23 offset:10048
    ds_read_b64_tr_b16 v[212:213], v23 offset:9344
    ds_read_b64_tr_b16 v[214:215], v23 offset:10112
    v_max_f32 v78, 0, v78
    v_max_f32 v79, 0, v79
    v_cvt_pk_bf16_f32 v71, v78, v79
    s_add_u32 s40, s91, 8192
    buffer_store_dwordx4 v[64:67], v24, s[20:23], s40 offen sc1
    v_mfma_f32_32x32x16_bf16 v[144:159], v[188:191], v[224:227], v[144:159]
    buffer_store_dwordx4 v[68:71], v24, s[20:23], s40 offen offset:512 sc1
    v_max_f32 v80, 0, v80
    v_max_f32 v81, 0, v81
    v_cvt_pk_bf16_f32 v80, v80, v81
    v_max_f32 v82, 0, v82
    v_mfma_f32_32x32x16_bf16 v[160:175], v[192:195], v[224:227], v[160:175]
    v_max_f32 v83, 0, v83
    v_cvt_pk_bf16_f32 v81, v82, v83
    v_max_f32 v84, 0, v84
    v_max_f32 v85, 0, v85
    v_cvt_pk_bf16_f32 v82, v84, v85
    v_add_u32 v18, 0xb000, v18
    v_add_u32 v19, 0xb000, v19
    v_add_u32 v20, 0xb000, v20
    v_add_u32 v21, 0xb000, v21
    v_add_u32 v23, 0xb000, v23
    v_add_u32 v28, 0xb000, v28
    s_waitcnt lgkmcnt(0)
    s_barrier
    v_mfma_f32_32x32x16_bf16 v[96:111], v[196:199], v[228:231], v[96:111]
    ds_read_b128 v[224:227], v18
    ds_read_b64_tr_b16 v[176:177], v28 offset:0
    ds_read_b64_tr_b16 v[178:179], v28 offset:256
    ds_read_b64_tr_b16 v[180:181], v28 offset:512
    v_max_f32 v86, 0, v86
    v_max_f32 v87, 0, v87
    v_cvt_pk_bf16_f32 v83, v86, v87
    v_max_f32 v88, 0, v88
    v_max_f32 v89, 0, v89
    v_mfma_f32_32x32x16_bf16 v[112:127], v[200:203], v[228:231], v[112:127]
    ds_read_b64_tr_b16 v[182:183], v28 offset:768
    ds_read_b64_tr_b16 v[184:185], v23 offset:0
    ds_read_b64_tr_b16 v[186:187], v23 offset:768
    ds_read_b64_tr_b16 v[188:189], v23 offset:64
    v_cvt_pk_bf16_f32 v84, v88, v89
    v_max_f32 v90, 0, v90
    v_max_f32 v91, 0, v91
    v_cvt_pk_bf16_f32 v85, v90, v91
    v_max_f32 v92, 0, v92
    v_mfma_f32_32x32x16_bf16 v[128:143], v[204:207], v[228:231], v[128:143]
    ds_read_b64_tr_b16 v[190:191], v23 offset:832
    ds_read_b64_tr_b16 v[192:193], v23 offset:128
    ds_read_b64_tr_b16 v[194:195], v23 offset:896
    v_max_f32 v93, 0, v93
    v_cvt_pk_bf16_f32 v86, v92, v93
    v_max_f32 v94, 0, v94
    v_max_f32 v95, 0, v95
    v_cvt_pk_bf16_f32 v87, v94, v95
    v_mfma_f32_32x32x16_bf16 v[144:159], v[208:211], v[228:231], v[144:159]
    s_add_u32 s40, s91, 12288
    buffer_store_dwordx4 v[80:83], v24, s[20:23], s40 offen sc1
    buffer_store_dwordx4 v[84:87], v24, s[20:23], s40 offen offset:512 sc1
    v_mfma_f32_32x32x16_bf16 v[160:175], v[212:215], v[228:231], v[160:175]
    s_waitcnt lgkmcnt(0)
    v_mfma_f32_32x32x16_bf16 v[96:111], v[176:179], v[224:227], v[96:111]
    ds_read_b128 v[228:231], v19
    ds_read_b64_tr_b16 v[196:197], v28 offset:2048
    ds_read_b64_tr_b16 v[198:199], v28 offset:2304
    ds_read_b64_tr_b16 v[200:201], v28 offset:2560
    v_mfma_f32_32x32x16_bf16 v[112:127], v[180:183], v[224:227], v[112:127]
    ds_read_b64_tr_b16 v[202:203], v28 offset:2816
    ds_read_b64_tr_b16 v[204:205], v23 offset:3072
    ds_read_b64_tr_b16 v[206:207], v23 offset:3840
    ds_read_b64_tr_b16 v[208:209], v23 offset:3136
    v_mfma_f32_32x32x16_bf16 v[128:143], v[184:187], v[224:227], v[128:143]
    ds_read_b64_tr_b16 v[210:211], v23 offset:3904
    ds_read_b64_tr_b16 v[212:213], v23 offset:3200
    ds_read_b64_tr_b16 v[214:215], v23 offset:3968
    v_mfma_f32_32x32x16_bf16 v[144:159], v[188:191], v[224:227], v[144:159]
    v_mfma_f32_32x32x16_bf16 v[160:175], v[192:195], v[224:227], v[160:175]
    s_waitcnt lgkmcnt(0)
    v_mfma_f32_32x32x16_bf16 v[96:111], v[196:199], v[228:231], v[96:111]
    ds_read_b128 v[224:227], v20
    ds_read_b64_tr_b16 v[176:177], v28 offset:4096
    ds_read_b64_tr_b16 v[178:179], v28 offset:4352
    ds_read_b64_tr_b16 v[180:181], v28 offset:4608
    v_mfma_f32_32x32x16_bf16 v[112:127], v[200:203], v[228:231], v[112:127]
    ds_read_b64_tr_b16 v[182:183], v28 offset:4864
    ds_read_b64_tr_b16 v[184:185], v23 offset:6144
    ds_read_b64_tr_b16 v[186:187], v23 offset:6912
    ds_read_b64_tr_b16 v[188:189], v23 offset:6208
    v_mfma_f32_32x32x16_bf16 v[128:143], v[204:207], v[228:231], v[128:143]
    ds_read_b64_tr_b16 v[190:191], v23 offset:6976
    ds_read_b64_tr_b16 v[192:193], v23 offset:6272
    ds_read_b64_tr_b16 v[194:195], v23 offset:7040
    v_mfma_f32_32x32x16_bf16 v[144:159], v[208:211], v[228:231], v[144:159]
    v_mfma_f32_32x32x16_bf16 v[160:175], v[212:215], v[228:231], v[160:175]
    s_waitcnt lgkmcnt(0)
    v_mfma_f32_32x32x16_bf16 v[96:111], v[176:179], v[224:227], v[96:111]
    ds_read_b128 v[228:231], v21
    ds_read_b64_tr_b16 v[196:197], v28 offset:6144
    ds_read_b64_tr_b16 v[198:199], v28 offset:6400
    ds_read_b64_tr_b16 v[200:201], v28 offset:6656
    v_mfma_f32_32x32x16_bf16 v[112:127], v[180:183], v[224:227], v[112:127]
    ds_read_b64_tr_b16 v[202:203], v28 offset:6912
    ds_read_b64_tr_b16 v[204:205], v23 offset:9216
    ds_read_b64_tr_b16 v[206:207], v23 offset:9984
    ds_read_b64_tr_b16 v[208:209], v23 offset:9280
    v_mfma_f32_32x32x16_bf16 v[128:143], v[184:187], v[224:227], v[128:143]
    ds_read_b64_tr_b16 v[210:211], v23 offset:10048
    ds_read_b64_tr_b16 v[212:213], v23 offset:9344
    ds_read_b64_tr_b16 v[214:215], v23 offset:10112
    v_mfma_f32_32x32x16_bf16 v[144:159], v[188:191], v[224:227], v[144:159]
    v_mfma_f32_32x32x16_bf16 v[160:175], v[192:195], v[224:227], v[160:175]
    v_add_u32 v18, 0xfffea000, v18
    v_add_u32 v19, 0xfffea000, v19
    v_add_u32 v20, 0xfffea000, v20
    v_add_u32 v21, 0xfffea000, v21
    v_add_u32 v23, 0xfffea000, v23
    v_add_u32 v28, 0xfffea000, v28
    s_waitcnt lgkmcnt(0)
    s_barrier
    v_mfma_f32_32x32x16_bf16 v[96:111], v[196:199], v[228:231], v[96:111]
    ds_read_b128 v[224:227], v18
    ds_read_b64_tr_b16 v[176:177], v28 offset:0
    ds_read_b64_tr_b16 v[178:179], v28 offset:256
    ds_read_b64_tr_b16 v[180:181], v28 offset:512
    v_mfma_f32_32x32x16_bf16 v[112:127], v[200:203], v[228:231], v[112:127]
    ds_read_b64_tr_b16 v[182:183], v28 offset:768
    ds_read_b64_tr_b16 v[184:185], v23 offset:0
    ds_read_b64_tr_b16 v[186:187], v23 offset:768
    ds_read_b64_tr_b16 v[188:189], v23 offset:64
    v_mfma_f32_32x32x16_bf16 v[128:143], v[204:207], v[228:231], v[128:143]
    ds_read_b64_tr_b16 v[190:191], v23 offset:832
    ds_read_b64_tr_b16 v[192:193], v23 offset:128
    ds_read_b64_tr_b16 v[194:195], v23 offset:896
    v_mfma_f32_32x32x16_bf16 v[144:159], v[208:211], v[228:231], v[144:159]
    v_mfma_f32_32x32x16_bf16 v[160:175], v[212:215], v[228:231], v[160:175]
    s_waitcnt lgkmcnt(0)
    v_mfma_f32_32x32x16_bf16 v[96:111], v[176:179], v[224:227], v[96:111]
    ds_read_b128 v[228:231], v19
    ds_read_b64_tr_b16 v[196:197], v28 offset:2048
    ds_read_b64_tr_b16 v[198:199], v28 offset:2304
    ds_read_b64_tr_b16 v[200:201], v28 offset:2560
    v_mfma_f32_32x32x16_bf16 v[112:127], v[180:183], v[224:227], v[112:127]
    ds_read_b64_tr_b16 v[202:203], v28 offset:2816
    ds_read_b64_tr_b16 v[204:205], v23 offset:3072
    ds_read_b64_tr_b16 v[206:207], v23 offset:3840
    ds_read_b64_tr_b16 v[208:209], v23 offset:3136
    v_mfma_f32_32x32x16_bf16 v[128:143], v[184:187], v[224:227], v[128:143]
    ds_read_b64_tr_b16 v[210:211], v23 offset:3904
    ds_read_b64_tr_b16 v[212:213], v23 offset:3200
    ds_read_b64_tr_b16 v[214:215], v23 offset:3968
    v_mfma_f32_32x32x16_bf16 v[144:159], v[188:191], v[224:227], v[144:159]
    v_mfma_f32_32x32x16_bf16 v[160:175], v[192:195], v[224:227], v[160:175]
    s_waitcnt lgkmcnt(0)
    v_mfma_f32_32x32x16_bf16 v[96:111], v[196:199], v[228:231], v[96:111]
    ds_read_b128 v[224:227], v20
    ds_read_b64_tr_b16 v[176:177], v28 offset:4096
    ds_read_b64_tr_b16 v[178:179], v28 offset:4352
    ds_read_b64_tr_b16 v[180:181], v28 offset:4608
    s_waitcnt vmcnt(0)
    v_mov_b32 v9, 1
    buffer_store_dword v9, v4, s[20:23], s74 offen offset:0 sc1
    v_mfma_f32_32x32x16_bf16 v[112:127], v[200:203], v[228:231], v[112:127]
    ds_read_b64_tr_b16 v[182:183], v28 offset:4864
    ds_read_b64_tr_b16 v[184:185], v23 offset:6144
    ds_read_b64_tr_b16 v[186:187], v23 offset:6912
    ds_read_b64_tr_b16 v[188:189], v23 offset:6208
    v_mfma_f32_32x32x16_bf16 v[128:143], v[204:207], v[228:231], v[128:143]
    ds_read_b64_tr_b16 v[190:191], v23 offset:6976
    ds_read_b64_tr_b16 v[192:193], v23 offset:6272
    ds_read_b64_tr_b16 v[194:195], v23 offset:7040
    v_mfma_f32_32x32x16_bf16 v[144:159], v[208:211], v[228:231], v[144:159]
    v_mfma_f32_32x32x16_bf16 v[160:175], v[212:215], v[228:231], v[160:175]
    s_waitcnt lgkmcnt(0)
    v_mfma_f32_32x32x16_bf16 v[96:111], v[176:179], v[224:227], v[96:111]
    ds_read_b128 v[228:231], v21
    ds_read_b64_tr_b16 v[196:197], v28 offset:6144
    ds_read_b64_tr_b16 v[198:199], v28 offset:6400
    ds_read_b64_tr_b16 v[200:201], v28 offset:6656
    v_mfma_f32_32x32x16_bf16 v[112:127], v[180:183], v[224:227], v[112:127]
    ds_read_b64_tr_b16 v[202:203], v28 offset:6912
    ds_read_b64_tr_b16 v[204:205], v23 offset:9216
    ds_read_b64_tr_b16 v[206:207], v23 offset:9984
    ds_read_b64_tr_b16 v[208:209], v23 offset:9280
    v_mfma_f32_32x32x16_bf16 v[128:143], v[184:187], v[224:227], v[128:143]
    ds_read_b64_tr_b16 v[210:211], v23 offset:10048
    ds_read_b64_tr_b16 v[212:213], v23 offset:9344
    ds_read_b64_tr_b16 v[214:215], v23 offset:10112
    v_mfma_f32_32x32x16_bf16 v[144:159], v[188:191], v[224:227], v[144:159]
    v_mfma_f32_32x32x16_bf16 v[160:175], v[192:195], v[224:227], v[160:175]
    v_add_u32 v18, 0xb000, v18
    v_add_u32 v19, 0xb000, v19
    v_add_u32 v20, 0xb000, v20
    v_add_u32 v21, 0xb000, v21
    v_add_u32 v23, 0xb000, v23
    v_add_u32 v28, 0xb000, v28
    s_mov_b32 s93, 0
    s_mov_b32 s96, 1
    .p2align 3
L_CQ_p2:
    s_waitcnt lgkmcnt(0)
    s_barrier
    v_mfma_f32_32x32x16_bf16 v[96:111], v[196:199], v[228:231], v[96:111]
    ds_read_b128 v[224:227], v18
    ds_read_b64_tr_b16 v[176:177], v28 offset:0
    ds_read_b64_tr_b16 v[178:179], v28 offset:256
    ds_read_b64_tr_b16 v[180:181], v28 offset:512
    v_mfma_f32_32x32x16_bf16 v[112:127], v[200:203], v[228:231], v[112:127]
    ds_read_b64_tr_b16 v[182:183], v28 offset:768
    ds_read_b64_tr_b16 v[184:185], v23 offset:0
    ds_read_b64_tr_b16 v[186:187], v23 offset:768
    ds_read_b64_tr_b16 v[188:189], v23 offset:64
    v_mfma_f32_32x32x16_bf16 v[128:143], v[204:207], v[228:231], v[128:143]
    ds_read_b64_tr_b16 v[190:191], v23 offset:832
    ds_read_b64_tr_b16 v[192:193], v23 offset:128
    ds_read_b64_tr_b16 v[194:195], v23 offset:896
    v_mfma_f32_32x32x16_bf16 v[144:159], v[208:211], v[228:231], v[144:159]
    v_mfma_f32_32x32x16_bf16 v[160:175], v[212:215], v[228:231], v[160:175]
    s_waitcnt lgkmcnt(0)
    v_mfma_f32_32x32x16_bf16 v[96:111], v[176:179], v[224:227], v[96:111]
    ds_read_b128 v[228:231], v19
    ds_read_b64_tr_b16 v[196:197], v28 offset:2048
    ds_read_b64_tr_b16 v[198:199], v28 offset:2304
    ds_read_b64_tr_b16 v[200:201], v28 offset:2560
    v_mfma_f32_32x32x16_bf16 v[112:127], v[180:183], v[224:227], v[112:127]
    ds_read_b64_tr_b16 v[202:203], v28 offset:2816
    ds_read_b64_tr_b16 v[204:205], v23 offset:3072
    ds_read_b64_tr_b16 v[206:207], v23 offset:3840
    ds_read_b64_tr_b16 v[208:209], v23 offset:3136
    v_mfma_f32_32x32x16_bf16 v[128:143], v[184:187], v[224:227], v[128:143]
    ds_read_b64_tr_b16 v[210:211], v23 offset:3904
    ds_read_b64_tr_b16 v[212:213], v23 offset:3200
    ds_read_b64_tr_b16 v[214:215], v23 offset:3968
    v_mfma_f32_32x32x16_bf16 v[144:159], v[188:191], v[224:227], v[144:159]
    v_mfma_f32_32x32x16_bf16 v[160:175], v[192:195], v[224:227], v[160:175]
    s_waitcnt lgkmcnt(0)
    v_mfma_f32_32x32x16_bf16 v[96:111], v[196:199], v[228:231], v[96:111]
    ds_read_b128 v[224:227], v20
    ds_read_b64_tr_b16 v[176:177], v28 offset:4096
    ds_read_b64_tr_b16 v[178:179], v28 offset:4352
    ds_read_b64_tr_b16 v[180:181], v28 offset:4608
    v_mfma_f32_32x32x16_bf16 v[112:127], v[200:203], v[228:231], v[112:127]
    ds_read_b64_tr_b16 v[182:183], v28 offset:4864
    ds_read_b64_tr_b16 v[184:185], v23 offset:6144
    ds_read_b64_tr_b16 v[186:187], v23 offset:6912
    ds_read_b64_tr_b16 v[188:189], v23 offset:6208
    v_mfma_f32_32x32x16_bf16 v[128:143], v[204:207], v[228:231], v[128:143]
    ds_read_b64_tr_b16 v[190:191], v23 offset:6976
    ds_read_b64_tr_b16 v[192:193], v23 offset:6272
    ds_read_b64_tr_b16 v[194:195], v23 offset:7040
    v_mfma_f32_32x32x16_bf16 v[144:159], v[208:211], v[228:231], v[144:159]
    v_mfma_f32_32x32x16_bf16 v[160:175], v[212:215], v[228:231], v[160:175]
    s_add_u32 s96, s96, 1
    s_cmp_eq_u32 s96, 3
    s_cselect_b32 s96, 0, s96
    s_mov_b32 s97, 45056
    s_cselect_b32 s97, 0xfffea000, s97
    s_add_u32 s93, s93, 1
    s_cmp_lt_u32 s93, 7
    s_waitcnt lgkmcnt(0)
    v_mfma_f32_32x32x16_bf16 v[96:111], v[176:179], v[224:227], v[96:111]
    ds_read_b128 v[228:231], v21
    ds_read_b64_tr_b16 v[196:197], v28 offset:6144
    ds_read_b64_tr_b16 v[198:199], v28 offset:6400
    ds_read_b64_tr_b16 v[200:201], v28 offset:6656
    v_mfma_f32_32x32x16_bf16 v[112:127], v[180:183], v[224:227], v[112:127]
    ds_read_b64_tr_b16 v[202:203], v28 offset:6912
    ds_read_b64_tr_b16 v[204:205], v23 offset:9216
    ds_read_b64_tr_b16 v[206:207], v23 offset:9984
    ds_read_b64_tr_b16 v[208:209], v23 offset:9280
    v_mfma_f32_32x32x16_bf16 v[128:143], v[184:187], v[224:227], v[128:143]
    ds_read_b64_tr_b16 v[210:211], v23 offset:10048
    ds_read_b64_tr_b16 v[212:213], v23 offset:9344
    ds_read_b64_tr_b16 v[214:215], v23 offset:10112
    v_mfma_f32_32x32x16_bf16 v[144:159], v[188:191], v[224:227], v[144:159]
    v_mfma_f32_32x32x16_bf16 v[160:175], v[192:195], v[224:227], v[160:175]
    v_add_u32 v18, s97, v18
    v_add_u32 v19, s97, v19
    v_add_u32 v20, s97, v20
    v_add_u32 v21, s97, v21
    v_add_u32 v23, s97, v23
    v_add_u32 v28, s97, v28
    s_cbranch_scc1 L_CQ_p2
    s_waitcnt lgkmcnt(0)
    s_barrier
    v_mfma_f32_32x32x16_bf16 v[96:111], v[196:199], v[228:231], v[96:111]
    v_mfma_f32_32x32x16_bf16 v[112:127], v[200:203], v[228:231], v[112:127]
    v_mfma_f32_32x32x16_bf16 v[128:143], v[204:207], v[228:231], v[128:143]
    v_mfma_f32_32x32x16_bf16 v[144:159], v[208:211], v[228:231], v[144:159]
    v_mfma_f32_32x32x16_bf16 v[160:175], v[212:215], v[228:231], v[160:175]
    s_lshl_b32 s91, s38, 13
    s_add_u32 s91, s91, 131072
    s_add_u32 s91, s91, s68
    s_nop 4
    v_max_f32 v96, 0, v96
    v_max_f32 v97, 0, v97
    v_cvt_pk_bf16_f32 v176, v96, v97
    v_max_f32 v98, 0, v98
    v_max_f32 v99, 0, v99
    v_cvt_pk_bf16_f32 v177, v98, v99
    v_max_f32 v100, 0, v100
    v_max_f32 v101, 0, v101
    v_cvt_pk_bf16_f32 v178, v100, v101
    v_max_f32 v102, 0, v102
    v_max_f32 v103, 0, v103
    v_cvt_pk_bf16_f32 v179, v102, v103
    v_max_f32 v104, 0, v104
    v_max_f32 v105, 0, v105
    v_cvt_pk_bf16_f32 v180, v104, v105
    v_max_f32 v106, 0, v106
    v_max_f32 v107, 0, v107
    v_cvt_pk_bf16_f32 v181, v106, v107
    v_max_f32 v108, 0, v108
    v_max_f32 v109, 0, v109
    v_cvt_pk_bf16_f32 v182, v108, v109
    v_max_f32 v110, 0, v110
    v_max_f32 v111, 0, v111
    v_cvt_pk_bf16_f32 v183, v110, v111
    s_add_u32 s40, s91, 0
    buffer_store_dwordx4 v[176:179], v24, s[20:23], s40 offen sc1
    buffer_store_dwordx4 v[180:183], v24, s[20:23], s40 offen offset:512 sc1
    v_max_f32 v112, 0, v112
    v_max_f32 v113, 0, v113
    v_cvt_pk_bf16_f32 v184, v112, v113
    v_max_f32 v114, 0, v114
    v_max_f32 v115, 0, v115
    v_cvt_pk_bf16_f32 v185, v114, v115
    v_max_f32 v116, 0, v116
    v_max_f32 v117, 0, v117
    v_cvt_pk_bf16_f32 v186, v116, v117
    v_max_f32 v118, 0, v118
    v_max_f32 v119, 0, v119
    v_cvt_pk_bf16_f32 v187, v118, v119
    v_max_f32 v120, 0, v120
    v_max_f32 v121, 0, v121
    v_cvt_pk_bf16_f32 v188, v120, v121
    v_max_f32 v122, 0, v122
    v_max_f32 v123, 0, v123
    v_cvt_pk_bf16_f32 v189, v122, v123
    v_max_f32 v124, 0, v124
    v_max_f32 v125, 0, v125
    v_cvt_pk_bf16_f32 v190, v124, v125
    v_max_f32 v126, 0, v126
    v_max_f32 v127, 0, v127
    v_cvt_pk_bf16_f32 v191, v126, v127
    s_add_u32 s40, s91, 4096
    buffer_store_dwordx4 v[184:187], v24, s[20:23], s40 offen sc1
    buffer_store_dwordx4 v[188:191], v24, s[20:23], s40 offen offset:512 sc1
    s_lshl_b32 s39, s36, 10
    s_add_u32 s39, s39, 90112
    v_add_u32 v18, s39, v5
    v_add_u32 v19, 90112, v6
    s_waitcnt lgkmcnt(0)
    s_barrier
    ds_read_b128 v[48:51], v18 offset:0
    ds_read_b128 v[52:55], v19 offset:0
    ds_read_b128 v[56:59], v19 offset:1024
    ds_read_b128 v[60:63], v19 offset:2048
    ds_read_b128 v[64:67], v19 offset:3072
    ds_read_b128 v[68:71], v18 offset:8192
    ds_read_b128 v[72:75], v19 offset:8192
    ds_read_b128 v[76:79], v19 offset:9216
    ds_read_b128 v[80:83], v19 offset:10240
    ds_read_b128 v[84:87], v19 offset:11264
    v_fma_f32 v10, v128, v251, s65
    v_fma_f32 v12, v129, v251, s65
    v_exp_f32 v11, v10 clamp
    v_exp_f32 v13, v12 clamp
    v_max_f32 v10, s65, v10
    v_max_f32 v12, s65, v12
    v_fma_f32 v10, v10, s66, v11
    v_fma_f32 v12, v12, s66, v13
    v_cvt_pk_bf16_f32 v200, v10, v12
    v_fma_f32 v10, v130, v251, s65
    v_fma_f32 v12, v131, v251, s65
    v_exp_f32 v11, v10 clamp
    v_exp_f32 v13, v12 clamp
    v_max_f32 v10, s65, v10
    v_max_f32 v12, s65, v12
    v_fma_f32 v10, v10, s66, v11
    v_fma_f32 v12, v12, s66, v13
    v_cvt_pk_bf16_f32 v201, v10, v12
    v_fma_f32 v10, v132, v251, s65
    v_fma_f32 v12, v133, v251, s65
    v_exp_f32 v11, v10 clamp
    v_exp_f32 v13, v12 clamp
    v_max_f32 v10, s65, v10
    v_max_f32 v12, s65, v12
    v_fma_f32 v10, v10, s66, v11
    v_fma_f32 v12, v12, s66, v13
    v_cvt_pk_bf16_f32 v202, v10, v12
    v_fma_f32 v10, v134, v251, s65
    v_fma_f32 v12, v135, v251, s65
    v_exp_f32 v11, v10 clamp
    s_waitcnt lgkmcnt(0)
    ds_read_b128 v[88:91], v18 offset:16384
    ds_read_b128 v[92:95], v19 offset:16384
    v_mfma_f32_16x16x32_bf16 v[32:35], v[52:55], v[48:51], 0
    ds_read_b128 v[96:99], v19 offset:17408
    v_mfma_f32_16x16x32_bf16 v[36:39], v[56:59], v[48:51], 0
    ds_read_b128 v[100:103], v19 offset:18432
    v_mfma_f32_16x16x32_bf16 v[40:43], v[60:63], v[48:51], 0
    ds_read_b128 v[104:107], v19 offset:19456
    v_mfma_f32_16x16x32_bf16 v[44:47], v[64:67], v[48:51], 0
    ds_read_b128 v[108:111], v18 offset:24576
    v_mfma_f32_16x16x32_bf16 v[32:35], v[72:75], v[68:71], v[32:35]
    ds_read_b128 v[112:115], v19 offset:24576
    v_mfma_f32_16x16x32_bf16 v[36:39], v[76:79], v[68:71], v[36:39]
    ds_read_b128 v[116:119], v19 offset:25600
    v_mfma_f32_16x16x32_bf16 v[40:43], v[80:83], v[68:71], v[40:43]
    ds_read_b128 v[120:123], v19 offset:26624
    v_mfma_f32_16x16x32_bf16 v[44:47], v[84:87], v[68:71], v[44:47]
    ds_read_b128 v[124:127], v19 offset:27648
    v_exp_f32 v13, v12 clamp
    v_max_f32 v10, s65, v10
    v_max_f32 v12, s65, v12
    v_fma_f32 v10, v10, s66, v11
    v_fma_f32 v12, v12, s66, v13
    v_cvt_pk_bf16_f32 v203, v10, v12
    v_fma_f32 v10, v136, v251, s65
    v_fma_f32 v12, v137, v251, s65
    v_exp_f32 v11, v10 clamp
    v_exp_f32 v13, v12 clamp
    v_max_f32 v10, s65, v10
    v_max_f32 v12, s65, v12
    v_fma_f32 v10, v10, s66, v11
    v_fma_f32 v12, v12, s66, v13
    v_cvt_pk_bf16_f32 v204, v10, v12
    v_fma_f32 v10, v138, v251, s65
    v_fma_f32 v12, v139, v251, s65
    v_exp_f32 v11, v10 clamp
    v_exp_f32 v13, v12 clamp
    v_max_f32 v10, s65, v10
    v_max_f32 v12, s65, v12
    v_fma_f32 v10, v10, s66, v11
    v_fma_f32 v12, v12, s66, v13
    v_cvt_pk_bf16_f32 v205, v10, v12
    v_fma_f32 v10, v140, v251, s65
    v_fma_f32 v12, v141, v251, s65
    v_exp_f32 v11, v10 clamp
    v_exp_f32 v13, v12 clamp
    v_max_f32 v10, s65, v10
    v_max_f32 v12, s65, v12
    v_add_u32 v18, 0xfffea000, v18
    v_add_u32 v19, 0xfffea000, v19
    s_waitcnt lgkmcnt(0)
    s_barrier
    ds_read_b128 v[48:51], v18 offset:0
    ds_read_b128 v[52:55], v19 offset:0
    v_mfma_f32_16x16x32_bf16 v[32:35], v[92:95], v[88:91], v[32:35]
    ds_read_b128 v[56:59], v19 offset:1024
    v_mfma_f32_16x16x32_bf16 v[36:39], v[96:99], v[88:91], v[36:39]
    ds_read_b128 v[60:63], v19 offset:2048
    v_mfma_f32_16x16x32_bf16 v[40:43], v[100:103], v[88:91], v[40:43]
    ds_read_b128 v[64:67], v19 offset:3072
    v_mfma_f32_16x16x32_bf16 v[44:47], v[104:107], v[88:91], v[44:47]
    ds_read_b128 v[68:71], v18 offset:8192
    v_mfma_f32_16x16x32_bf16 v[32:35], v[112:115], v[108:111], v[32:35]
    ds_read_b128 v[72:75], v19 offset:8192
    v_mfma_f32_16x16x32_bf16 v[36:39], v[116:119], v[108:111], v[36:39]
    ds_read_b128 v[76:79], v19 offset:9216
    v_mfma_f32_16x16x32_bf16 v[40:43], v[120:123], v[108:111], v[40:43]
    ds_read_b128 v[80:83], v19 offset:10240
    v_mfma_f32_16x16x32_bf16 v[44:47], v[124:127], v[108:111], v[44:47]
    ds_read_b128 v[84:87], v19 offset:11264
    v_fma_f32 v10, v10, s66, v11
    v_fma_f32 v12, v12, s66, v13
    v_cvt_pk_bf16_f32 v206, v10, v12
    v_fma_f32 v10, v142, v251, s65
    v_fma_f32 v12, v143, v251, s65
    v_exp_f32 v11, v10 clamp
    v_exp_f32 v13, v12 clamp
    v_max_f32 v10, s65, v10
    v_max_f32 v12, s65, v12
    v_fma_f32 v10, v10, s66, v11
    v_fma_f32 v12, v12, s66, v13
    v_cvt_pk_bf16_f32 v207, v10, v12
    v_fma_f32 v10, v144, v251, s65
    v_fma_f32 v12, v145, v251, s65
    v_exp_f32 v11, v10 clamp
    v_exp_f32 v13, v12 clamp
    v_max_f32 v10, s65, v10
    v_max_f32 v12, s65, v12
    v_fma_f32 v10, v10, s66, v11
    v_fma_f32 v12, v12, s66, v13
    v_cvt_pk_bf16_f32 v208, v10, v12
    v_fma_f32 v10, v146, v251, s65
    v_fma_f32 v12, v147, v251, s65
    v_exp_f32 v11, v10 clamp
    v_exp_f32 v13, v12 clamp
    v_max_f32 v10, s65, v10
    v_max_f32 v12, s65, v12
    v_fma_f32 v10, v10, s66, v11
    v_fma_f32 v12, v12, s66, v13
    v_cvt_pk_bf16_f32 v209, v10, v12
    s_waitcnt lgkmcnt(0)
    ds_read_b128 v[88:91], v18 offset:16384
    ds_read_b128 v[92:95], v19 offset:16384
    v_mfma_f32_16x16x32_bf16 v[32:35], v[52:55], v[48:51], v[32:35]
    ds_read_b128 v[96:99], v19 offset:17408
    v_mfma_f32_16x16x32_bf16 v[36:39], v[56:59], v[48:51], v[36:39]
    ds_read_b128 v[100:103], v19 offset:18432
    v_mfma_f32_16x16x32_bf16 v[40:43], v[60:63], v[48:51], v[40:43]
    ds_read_b128 v[104:107], v19 offset:19456
    v_mfma_f32_16x16x32_bf16 v[44:47], v[64:67], v[48:51], v[44:47]
    ds_read_b128 v[108:111], v18 offset:24576
    v_mfma_f32_16x16x32_bf16 v[32:35], v[72:75], v[68:71], v[32:35]
    ds_read_b128 v[112:115], v19 offset:24576
    v_mfma_f32_16x16x32_bf16 v[36:39], v[76:79], v[68:71], v[36:39]
    ds_read_b128 v[116:119], v19 offset:25600
    v_mfma_f32_16x16x32_bf16 v[40:43], v[80:83], v[68:71], v[40:43]
    ds_read_b128 v[120:123], v19 offset:26624
    v_mfma_f32_16x16x32_bf16 v[44:47], v[84:87], v[68:71], v[44:47]
    ds_read_b128 v[124:127], v19 offset:27648
    v_fma_f32 v10, v148, v251, s65
    v_fma_f32 v12, v149, v251, s65
    v_exp_f32 v11, v10 clamp
    v_exp_f32 v13, v12 clamp
    v_max_f32 v10, s65, v10
    v_max_f32 v12, s65, v12
    v_fma_f32 v10, v10, s66, v11
    v_fma_f32 v12, v12, s66, v13
    v_cvt_pk_bf16_f32 v210, v10, v12
    v_fma_f32 v10, v150, v251, s65
    v_fma_f32 v12, v151, v251, s65
    v_exp_f32 v11, v10 clamp
    v_exp_f32 v13, v12 clamp
    v_max_f32 v10, s65, v10
    v_max_f32 v12, s65, v12
    v_fma_f32 v10, v10, s66, v11
    v_fma_f32 v12, v12, s66, v13
    v_cvt_pk_bf16_f32 v211, v10, v12
    v_fma_f32 v10, v152, v251, s65
    v_fma_f32 v12, v153, v251, s65
    v_exp_f32 v11, v10 clamp
    v_exp_f32 v13, v12 clamp
    v_max_f32 v10, s65, v10
    v_max_f32 v12, s65, v12
    v_fma_f32 v10, v10, s66, v11
    v_fma_f32 v12, v12, s66, v13
    v_cvt_pk_bf16_f32 v212, v10, v12
    v_fma_f32 v10, v154, v251, s65
    v_fma_f32 v12, v155, v251, s65
    v_exp_f32 v11, v10 clamp
    v_add_u32 v18, 0xb000, v18
    v_add_u32 v19, 0xb000, v19
    s_waitcnt lgkmcnt(0)
    s_barrier
    ds_read_b128 v[48:51], v18 offset:0
    ds_read_b128 v[52:55], v19 offset:0
    v_mfma_f32_16x16x32_bf16 v[32:35], v[92:95], v[88:91], v[32:35]
    ds_read_b128 v[56:59], v19 offset:1024
    v_mfma_f32_16x16x32_bf16 v[36:39], v[96:99], v[88:91], v[36:39]
    ds_read_b128 v[60:63], v19 offset:2048
    v_mfma_f32_16x16x32_bf16 v[40:43], v[100:103], v[88:91], v[40:43]
    ds_read_b128 v[64:67], v19 offset:3072
    v_mfma_f32_16x16x32_bf16 v[44:47], v[104:107], v[88:91], v[44:47]
    ds_read_b128 v[68:71], v18 offset:8192
    v_mfma_f32_16x16x32_bf16 v[32:35], v[112:115], v[108:111], v[32:35]
    ds_read_b128 v[72:75], v19 offset:8192
    v_mfma_f32_16x16x32_bf16 v[36:39], v[116:119], v[108:111], v[36:39]
    ds_read_b128 v[76:79], v19 offset:9216
    v_mfma_f32_16x16x32_bf16 v[40:43], v[120:123], v[108:111], v[40:43]
    ds_read_b128 v[80:83], v19 offset:10240
    v_mfma_f32_16x16x32_bf16 v[44:47], v[124:127], v[108:111], v[44:47]
    ds_read_b128 v[84:87], v19 offset:11264
    v_exp_f32 v13, v12 clamp
    v_max_f32 v10, s65, v10
    v_max_f32 v12, s65, v12
    v_fma_f32 v10, v10, s66, v11
    v_fma_f32 v12, v12, s66, v13
    v_cvt_pk_bf16_f32 v213, v10, v12
    v_fma_f32 v10, v156, v251, s65
    v_fma_f32 v12, v157, v251, s65
    v_exp_f32 v11, v10 clamp
    v_exp_f32 v13, v12 clamp
    v_max_f32 v10, s65, v10
    v_max_f32 v12, s65, v12
    v_fma_f32 v10, v10, s66, v11
    v_fma_f32 v12, v12, s66, v13
    v_cvt_pk_bf16_f32 v214, v10, v12
    v_fma_f32 v10, v158, v251, s65
    v_fma_f32 v12, v159, v251, s65
    v_exp_f32 v11, v10 clamp
    v_exp_f32 v13, v12 clamp
    v_max_f32 v10, s65, v10
    v_max_f32 v12, s65, v12
    v_fma_f32 v10, v10, s66, v11
    v_fma_f32 v12, v12, s66, v13
    v_cvt_pk_bf16_f32 v215, v10, v12
    s_waitcnt vmcnt(0)
    v_mov_b32 v9, 2
    buffer_store_dword v9, v4, s[20:23], s74 offen offset:0 sc1
    v_fma_f32 v10, v160, v251, s65
    v_fma_f32 v12, v161, v251, s65
    v_exp_f32 v11, v10 clamp
    v_exp_f32 v13, v12 clamp
    v_max_f32 v10, s65, v10
    v_max_f32 v12, s65, v12
    s_waitcnt lgkmcnt(0)
    ds_read_b128 v[88:91], v18 offset:16384
    ds_read_b128 v[92:95], v19 offset:16384
    v_mfma_f32_16x16x32_bf16 v[32:35], v[52:55], v[48:51], v[32:35]
    ds_read_b128 v[96:99], v19 offset:17408
    v_mfma_f32_16x16x32_bf16 v[36:39], v[56:59], v[48:51], v[36:39]
    ds_read_b128 v[100:103], v19 offset:18432
    v_mfma_f32_16x16x32_bf16 v[40:43], v[60:63], v[48:51], v[40:43]
    ds_read_b128 v[104:107], v19 offset:19456
    v_mfma_f32_16x16x32_bf16 v[44:47], v[64:67], v[48:51], v[44:47]
    ds_read_b128 v[108:111], v18 offset:24576
    v_mfma_f32_16x16x32_bf16 v[32:35], v[72:75], v[68:71], v[32:35]
    ds_read_b128 v[112:115], v19 offset:24576
    v_mfma_f32_16x16x32_bf16 v[36:39], v[76:79], v[68:71], v[36:39]
    ds_read_b128 v[116:119], v19 offset:25600
    v_mfma_f32_16x16x32_bf16 v[40:43], v[80:83], v[68:71], v[40:43]
    ds_read_b128 v[120:123], v19 offset:26624
    v_mfma_f32_16x16x32_bf16 v[44:47], v[84:87], v[68:71], v[44:47]
    ds_read_b128 v[124:127], v19 offset:27648
    v_fma_f32 v10, v10, s66, v11
    v_fma_f32 v12, v12, s66, v13
    v_cvt_pk_bf16_f32 v216, v10, v12
    v_fma_f32 v10, v162, v251, s65
    v_fma_f32 v12, v163, v251, s65
    v_exp_f32 v11, v10 clamp
    v_exp_f32 v13, v12 clamp
    v_max_f32 v10, s65, v10
    v_max_f32 v12, s65, v12
    v_fma_f32 v10, v10, s66, v11
    v_fma_f32 v12, v12, s66, v13
    v_cvt_pk_bf16_f32 v217, v10, v12
    v_fma_f32 v10, v164, v251, s65
    v_fma_f32 v12, v165, v251, s65
    v_exp_f32 v11, v10 clamp
    v_exp_f32 v13, v12 clamp
    v_max_f32 v10, s65, v10
    v_max_f32 v12, s65, v12
    v_fma_f32 v10, v10, s66, v11
    v_fma_f32 v12, v12, s66, v13
    v_cvt_pk_bf16_f32 v218, v10, v12
    v_fma_f32 v10, v166, v251, s65
    v_fma_f32 v12, v167, v251, s65
    v_exp_f32 v11, v10 clamp
    v_exp_f32 v13, v12 clamp
    v_max_f32 v10, s65, v10
    v_max_f32 v12, s65, v12
    v_fma_f32 v10, v10, s66, v11
    v_fma_f32 v12, v12, s66, v13
    v_cvt_pk_bf16_f32 v219, v10, v12
    v_add_u32 v18, 0xb000, v18
    v_add_u32 v19, 0xb000, v19
    v_and_b32 v20, 31, v1
    v_mul_u32_u24 v20, 176, v20
    v_lshl_add_u32 v20, v2, 4, v20
    v_add_u32 v20, 135168, v20
    v_mov_b32 v21, 152960
    ds_read_b64 v[22:23], v21
    s_lshr_b32 s39, s38, 1
    s_mul_i32 s39, s39, 20480
    s_add_u32 s39, s39, 196608
    s_add_u32 s39, s39, s68
    s_and_b32 s40, s38, 1
    s_mul_i32 s41, s40, 12288
    s_add_u32 s41, s41, s39
    s_add_u32 s42, s41, 4096
    s_lshl_b32 s40, s40, 9
    s_add_u32 s39, s39, s40
    s_add_u32 s39, s39, 8192
    s_mov_b32 s93, 3
    s_mov_b32 s96, 0
    s_mov_b32 s69, 0
    s_waitcnt lgkmcnt(0)
    s_branch L_CQ_chk
    .p2align 3
L_CQ_dyn:
    s_waitcnt lgkmcnt(0)
    s_barrier
    ds_read_b64 v[22:23], v21
    ds_read_b128 v[48:51], v18 offset:0
    ds_read_b128 v[52:55], v19 offset:0
    v_mfma_f32_16x16x32_bf16 v[32:35], v[92:95], v[88:91], v[32:35]
    ds_read_b128 v[56:59], v19 offset:1024
    v_mfma_f32_16x16x32_bf16 v[36:39], v[96:99], v[88:91], v[36:39]
    ds_read_b128 v[60:63], v19 offset:2048
    v_mfma_f32_16x16x32_bf16 v[40:43], v[100:103], v[88:91], v[40:43]
    ds_read_b128 v[64:67], v19 offset:3072
    v_mfma_f32_16x16x32_bf16 v[44:47], v[104:107], v[88:91], v[44:47]
    ds_read_b128 v[68:71], v18 offset:8192
    v_mfma_f32_16x16x32_bf16 v[32:35], v[112:115], v[108:111], v[32:35]
    ds_read_b128 v[72:75], v19 offset:8192
    v_mfma_f32_16x16x32_bf16 v[36:39], v[116:119], v[108:111], v[36:39]
    ds_read_b128 v[76:79], v19 offset:9216
    v_mfma_f32_16x16x32_bf16 v[40:43], v[120:123], v[108:111], v[40:43]
    ds_read_b128 v[80:83], v19 offset:10240
    v_mfma_f32_16x16x32_bf16 v[44:47], v[124:127], v[108:111], v[44:47]
    ds_read_b128 v[84:87], v19 offset:11264
    s_waitcnt lgkmcnt(5)
    ds_read_b128 v[88:91], v18 offset:16384
    ds_read_b128 v[92:95], v19 offset:16384
    v_mfma_f32_16x16x32_bf16 v[32:35], v[52:55], v[48:51], v[32:35]
    ds_read_b128 v[96:99], v19 offset:17408
    v_mfma_f32_16x16x32_bf16 v[36:39], v[56:59], v[48:51], v[36:39]
    ds_read_b128 v[100:103], v19 offset:18432
    v_mfma_f32_16x16x32_bf16 v[40:43], v[60:63], v[48:51], v[40:43]
    ds_read_b128 v[104:107], v19 offset:19456
    v_mfma_f32_16x16x32_bf16 v[44:47], v[64:67], v[48:51], v[44:47]
    ds_read_b128 v[108:111], v18 offset:24576
    s_waitcnt lgkmcnt(6)
    v_mfma_f32_16x16x32_bf16 v[32:35], v[72:75], v[68:71], v[32:35]
    ds_read_b128 v[112:115], v19 offset:24576
    v_mfma_f32_16x16x32_bf16 v[36:39], v[76:79], v[68:71], v[36:39]
    ds_read_b128 v[116:119], v19 offset:25600
    v_mfma_f32_16x16x32_bf16 v[40:43], v[80:83], v[68:71], v[40:43]
    ds_read_b128 v[120:123], v19 offset:26624
    v_mfma_f32_16x16x32_bf16 v[44:47], v[84:87], v[68:71], v[44:47]
    ds_read_b128 v[124:127], v19 offset:27648
    s_mov_b32 s97, 0xfffea000
    s_cmp_eq_u32 s96, 1
    s_cselect_b32 s97, 0xb000, s97
    s_cmp_eq_u32 s96, 2
    s_cselect_b32 s97, 0xb000, s97
    s_cselect_b32 s96, -1, s96
    s_add_u32 s96, s96, 1
    v_add_u32 v18, s97, v18
    v_add_u32 v19, s97, v19
    s_add_u32 s93, s93, 1
    s_cmp_lt_u32 s93, 10
    s_cselect_b32 s69, 0, 1
L_CQ_chk:
    v_min_u32 v22, v22, v23
    s_nop 0
    v_readfirstlane_b32 s92, v22
    s_nop 3
    s_or_b32 s69, s69, s92
    s_cbranch_scc0 L_CQ_dyn
    ds_read_b128 v[48:51], v20 offset:11264
    ds_read_b128 v[52:55], v20 offset:0
    ds_read_b128 v[56:59], v20 offset:11296
    ds_read_b128 v[60:63], v20 offset:32
    ds_read_b128 v[64:67], v20 offset:5664
    ds_read_b128 v[68:71], v20 offset:11328
    ds_read_b128 v[72:75], v20 offset:64
    ds_read_b128 v[76:79], v20 offset:5696
    ds_read_b128 v[80:83], v20 offset:11360
    ds_read_b128 v[84:87], v20 offset:5728
    ds_read_b128 v[176:179], v20 offset:11392
    ds_read_b128 v[180:183], v20 offset:5760
    s_waitcnt lgkmcnt(11)
    v_mfma_f32_32x32x16_bf16 v[160:175], v[48:51], v[200:203], 0
    s_waitcnt lgkmcnt(10)
    v_mfma_f32_32x32x16_bf16 v[128:143], v[52:55], v[200:203], 0
    s_waitcnt lgkmcnt(9)
    v_mfma_f32_32x32x16_bf16 v[160:175], v[56:59], v[204:207], v[160:175]
    s_waitcnt lgkmcnt(8)
    v_mfma_f32_32x32x16_bf16 v[128:143], v[60:63], v[204:207], v[128:143]
    s_waitcnt lgkmcnt(7)
    v_mfma_f32_32x32x16_bf16 v[144:159], v[64:67], v[204:207], 0
    s_waitcnt lgkmcnt(6)
    v_mfma_f32_32x32x16_bf16 v[160:175], v[68:71], v[208:211], v[160:175]
    s_waitcnt lgkmcnt(5)
    v_mfma_f32_32x32x16_bf16 v[128:143], v[72:75], v[208:211], v[128:143]
    s_waitcnt lgkmcnt(4)
    v_mfma_f32_32x32x16_bf16 v[144:159], v[76:79], v[208:211], v[144:159]
    s_waitcnt lgkmcnt(3)
    v_mfma_f32_32x32x16_bf16 v[160:175], v[80:83], v[212:215], v[160:175]
    s_waitcnt lgkmcnt(2)
    v_mfma_f32_32x32x16_bf16 v[144:159], v[84:87], v[212:215], v[144:159]
    s_waitcnt lgkmcnt(1)
    v_mfma_f32_32x32x16_bf16 v[160:175], v[176:179], v[216:219], v[160:175]
    s_waitcnt lgkmcnt(0)
    v_mfma_f32_32x32x16_bf16 v[144:159], v[180:183], v[216:219], v[144:159]
    s_nop 9
    v_add_f32 v10, 0x358637bd, v160
    v_add_f32 v11, 0x358637bd, v161
    v_add_f32 v12, 0x358637bd, v162
    v_add_f32 v13, 0x358637bd, v163
    v_rcp_f32 v10, v10
    v_rcp_f32 v11, v11
    v_rcp_f32 v12, v12
    v_rcp_f32 v13, v13
    s_nop 0
    v_mul_f32 v10, v10, v250
    v_mul_f32 v11, v11, v250
    v_mul_f32 v12, v12, v250
    v_mul_f32 v13, v13, v250
    v_cndmask_b32 v14, v10, v11, s[70:71]
    v_cndmask_b32 v15, v12, v13, s[70:71]
    v_mul_f32 v128, v128, v10
    v_mul_f32 v129, v129, v10
    v_mul_f32 v130, v130, v10
    v_mul_f32 v131, v131, v10
    v_cvt_pk_bf16_f32 v176, v128, v129
    v_cvt_pk_bf16_f32 v177, v130, v131
    v_mul_f32 v132, v132, v10
    v_mul_f32 v133, v133, v10
    v_mul_f32 v134, v134, v10
    v_mul_f32 v135, v135, v10
    v_cvt_pk_bf16_f32 v178, v132, v133
    v_cvt_pk_bf16_f32 v179, v134, v135
    buffer_store_dwordx4 v[176:179], v24, s[20:23], s41 offen offset:0 sc1
    v_mul_f32 v136, v136, v14
    v_mul_f32 v137, v137, v14
    v_mul_f32 v138, v138, v14
    v_mul_f32 v139, v139, v14
    v_cvt_pk_bf16_f32 v180, v136, v137
    v_cvt_pk_bf16_f32 v181, v138, v139
    v_mul_f32 v140, v140, v11
    v_mul_f32 v141, v141, v11
    v_mul_f32 v142, v142, v11
    v_mul_f32 v143, v143, v11
    v_cvt_pk_bf16_f32 v182, v140, v141
    v_cvt_pk_bf16_f32 v183, v142, v143
    buffer_store_dwordx4 v[180:183], v24, s[20:23], s41 offen offset:512 sc1
    v_mul_f32 v144, v144, v11
    v_mul_f32 v145, v145, v11
    v_mul_f32 v146, v146, v11
    v_mul_f32 v147, v147, v11
    v_cvt_pk_bf16_f32 v184, v144, v145
    v_cvt_pk_bf16_f32 v185, v146, v147
    v_mul_f32 v148, v148, v12
    v_mul_f32 v149, v149, v12
    v_mul_f32 v150, v150, v12
    v_mul_f32 v151, v151, v12
    v_cvt_pk_bf16_f32 v186, v148, v149
    v_cvt_pk_bf16_f32 v187, v150, v151
    buffer_store_dwordx4 v[184:187], v24, s[20:23], s42 offen offset:0 sc1
    v_mul_f32 v152, v152, v12
    v_mul_f32 v153, v153, v12
    v_mul_f32 v154, v154, v12
    v_mul_f32 v155, v155, v12
    v_cvt_pk_bf16_f32 v188, v152, v153
    v_cvt_pk_bf16_f32 v189, v154, v155
    v_mul_f32 v156, v156, v15
    v_mul_f32 v157, v157, v15
    v_mul_f32 v158, v158, v15
    v_mul_f32 v159, v159, v15
    v_cvt_pk_bf16_f32 v190, v156, v157
    v_cvt_pk_bf16_f32 v191, v158, v159
    buffer_store_dwordx4 v[188:191], v24, s[20:23], s42 offen offset:512 sc1
    v_mul_f32 v168, v168, v13
    v_mul_f32 v169, v169, v13
    v_mul_f32 v170, v170, v13
    v_mul_f32 v171, v171, v13
    v_cvt_pk_bf16_f32 v192, v168, v169
    v_cvt_pk_bf16_f32 v193, v170, v171
    v_mul_f32 v172, v172, v13
    v_mul_f32 v173, v173, v13
    v_mul_f32 v174, v174, v13
    v_mul_f32 v175, v175, v13
    v_cvt_pk_bf16_f32 v194, v172, v173
    v_cvt_pk_bf16_f32 v195, v174, v175
    buffer_store_dwordx4 v[192:195], v24, s[20:23], s39 offen offset:0 sc1
    s_lshl_b32 s39, s89, 6
    s_lshl_b32 s40, s36, 4
    s_add_u32 s39, s39, s40
    s_mul_i32 s41, s39, 1280
    s_mul_i32 s42, s90, 320
    s_add_u32 s41, s41, s42
    s_add_u32 s41, s41, 192
    s_lshl_b32 s76, s39, 2
    s_add_u32 s76, s76, 13631488
    s_mul_i32 s40, s36, 4352
    s_add_u32 s40, s40, 90112
    v_add_u32 v10, 0, v1
    v_mul_u32_u24 v11, 8192, v10
    v_lshrrev_b32 v11, 16, v11
    v_mul_u32_u24 v12, 8, v11
    v_sub_u32 v12, v10, v12
    v_mul_u32_u24 v13, 1280, v11
    v_lshl_add_u32 v13, v12, 4, v13
    v_add_u32 v220, s41, v13
    v_mul_u32_u24 v13, 272, v11
    v_lshl_add_u32 v13, v12, 5, v13
    v_add_u32 v224, s40, v13
    v_lshlrev_b32 v228, 2, v11
    v_add_u32 v10, 64, v1
    v_mul_u32_u24 v11, 8192, v10
    v_lshrrev_b32 v11, 16, v11
    v_mul_u32_u24 v12, 8, v11
    v_sub_u32 v12, v10, v12
    v_mul_u32_u24 v13, 1280, v11
    v_lshl_add_u32 v13, v12, 4, v13
    v_add_u32 v221, s41, v13
    v_mul_u32_u24 v13, 272, v11
    v_lshl_add_u32 v13, v12, 5, v13
    v_add_u32 v225, s40, v13
    v_lshlrev_b32 v229, 2, v11
    v_and_b32 v10, 15, v1
    v_mul_u32_u24 v10, 272, v10
    v_lshrrev_b32 v11, 4, v1
    v_lshl_add_u32 v10, v11, 4, v10
    v_add_u32 v236, s40, v10
    s_cmp_ge_u32 s93, 9
    s_cbranch_scc1 L_CQ_of
    s_waitcnt lgkmcnt(0)
    s_barrier
    ds_read_b128 v[48:51], v18 offset:0
    ds_read_b128 v[52:55], v19 offset:0
    v_mfma_f32_16x16x32_bf16 v[32:35], v[92:95], v[88:91], v[32:35]
    ds_read_b128 v[56:59], v19 offset:1024
    v_mfma_f32_16x16x32_bf16 v[36:39], v[96:99], v[88:91], v[36:39]
    ds_read_b128 v[60:63], v19 offset:2048
    v_mfma_f32_16x16x32_bf16 v[40:43], v[100:103], v[88:91], v[40:43]
    ds_read_b128 v[64:67], v19 offset:3072
    v_mfma_f32_16x16x32_bf16 v[44:47], v[104:107], v[88:91], v[44:47]
    ds_read_b128 v[68:71], v18 offset:8192
    v_mfma_f32_16x16x32_bf16 v[32:35], v[112:115], v[108:111], v[32:35]
    ds_read_b128 v[72:75], v19 offset:8192
    v_mfma_f32_16x16x32_bf16 v[36:39], v[116:119], v[108:111], v[36:39]
    ds_read_b128 v[76:79], v19 offset:9216
    v_mfma_f32_16x16x32_bf16 v[40:43], v[120:123], v[108:111], v[40:43]
    ds_read_b128 v[80:83], v19 offset:10240
    v_mfma_f32_16x16x32_bf16 v[44:47], v[124:127], v[108:111], v[44:47]
    ds_read_b128 v[84:87], v19 offset:11264
    s_waitcnt lgkmcnt(5)
    ds_read_b128 v[88:91], v18 offset:16384
    ds_read_b128 v[92:95], v19 offset:16384
    v_mfma_f32_16x16x32_bf16 v[32:35], v[52:55], v[48:51], v[32:35]
    ds_read_b128 v[96:99], v19 offset:17408
    v_mfma_f32_16x16x32_bf16 v[36:39], v[56:59], v[48:51], v[36:39]
    ds_read_b128 v[100:103], v19 offset:18432
    v_mfma_f32_16x16x32_bf16 v[40:43], v[60:63], v[48:51], v[40:43]
    ds_read_b128 v[104:107], v19 offset:19456
    v_mfma_f32_16x16x32_bf16 v[44:47], v[64:67], v[48:51], v[44:47]
    ds_read_b128 v[108:111], v18 offset:24576
    s_waitcnt lgkmcnt(6)
    v_mfma_f32_16x16x32_bf16 v[32:35], v[72:75], v[68:71], v[32:35]
    ds_read_b128 v[112:115], v19 offset:24576
    v_mfma_f32_16x16x32_bf16 v[36:39], v[76:79], v[68:71], v[36:39]
    ds_read_b128 v[116:119], v19 offset:25600
    v_mfma_f32_16x16x32_bf16 v[40:43], v[80:83], v[68:71], v[40:43]
    ds_read_b128 v[120:123], v19 offset:26624
    v_mfma_f32_16x16x32_bf16 v[44:47], v[84:87], v[68:71], v[44:47]
    ds_read_b128 v[124:127], v19 offset:27648
    s_mov_b32 s97, 0xfffea000
    s_cmp_eq_u32 s96, 1
    s_cselect_b32 s97, 0xb000, s97
    s_cmp_eq_u32 s96, 2
    s_cselect_b32 s97, 0xb000, s97
    s_cselect_b32 s96, -1, s96
    s_add_u32 s96, s96, 1
    v_add_u32 v18, s97, v18
    v_add_u32 v19, s97, v19
    s_add_u32 s93, s93, 1
    s_cmp_lt_u32 s93, 99
L_CQ_of:
    s_waitcnt vmcnt(0)
    v_mov_b32 v9, 3
    buffer_store_dword v9, v4, s[20:23], s74 offen offset:0 sc1
    .p2align 3
L_CQ_g2c:
    s_waitcnt lgkmcnt(0)
    s_barrier
    ds_read_b128 v[48:51], v18 offset:0
    ds_read_b128 v[52:55], v19 offset:0
    v_mfma_f32_16x16x32_bf16 v[32:35], v[92:95], v[88:91], v[32:35]
    ds_read_b128 v[56:59], v19 offset:1024
    v_mfma_f32_16x16x32_bf16 v[36:39], v[96:99], v[88:91], v[36:39]
    ds_read_b128 v[60:63], v19 offset:2048
    v_mfma_f32_16x16x32_bf16 v[40:43], v[100:103], v[88:91], v[40:43]
    ds_read_b128 v[64:67], v19 offset:3072
    v_mfma_f32_16x16x32_bf16 v[44:47], v[104:107], v[88:91], v[44:47]
    ds_read_b128 v[68:71], v18 offset:8192
    v_mfma_f32_16x16x32_bf16 v[32:35], v[112:115], v[108:111], v[32:35]
    ds_read_b128 v[72:75], v19 offset:8192
    v_mfma_f32_16x16x32_bf16 v[36:39], v[116:119], v[108:111], v[36:39]
    ds_read_b128 v[76:79], v19 offset:9216
    v_mfma_f32_16x16x32_bf16 v[40:43], v[120:123], v[108:111], v[40:43]
    ds_read_b128 v[80:83], v19 offset:10240
    v_mfma_f32_16x16x32_bf16 v[44:47], v[124:127], v[108:111], v[44:47]
    ds_read_b128 v[84:87], v19 offset:11264
    s_waitcnt lgkmcnt(5)
    ds_read_b128 v[88:91], v18 offset:16384
    ds_read_b128 v[92:95], v19 offset:16384
    v_mfma_f32_16x16x32_bf16 v[32:35], v[52:55], v[48:51], v[32:35]
    ds_read_b128 v[96:99], v19 offset:17408
    v_mfma_f32_16x16x32_bf16 v[36:39], v[56:59], v[48:51], v[36:39]
    ds_read_b128 v[100:103], v19 offset:18432
    v_mfma_f32_16x16x32_bf16 v[40:43], v[60:63], v[48:51], v[40:43]
    ds_read_b128 v[104:107], v19 offset:19456
    v_mfma_f32_16x16x32_bf16 v[44:47], v[64:67], v[48:51], v[44:47]
    ds_read_b128 v[108:111], v18 offset:24576
    s_waitcnt lgkmcnt(6)
    v_mfma_f32_16x16x32_bf16 v[32:35], v[72:75], v[68:71], v[32:35]
    ds_read_b128 v[112:115], v19 offset:24576
    v_mfma_f32_16x16x32_bf16 v[36:39], v[76:79], v[68:71], v[36:39]
    ds_read_b128 v[116:119], v19 offset:25600
    v_mfma_f32_16x16x32_bf16 v[40:43], v[80:83], v[68:71], v[40:43]
    ds_read_b128 v[120:123], v19 offset:26624
    v_mfma_f32_16x16x32_bf16 v[44:47], v[84:87], v[68:71], v[44:47]
    ds_read_b128 v[124:127], v19 offset:27648
    s_mov_b32 s97, 0xfffea000
    s_cmp_eq_u32 s96, 1
    s_cselect_b32 s97, 0xb000, s97
    s_cmp_eq_u32 s96, 2
    s_cselect_b32 s97, 0xb000, s97
    s_cselect_b32 s96, -1, s96
    s_add_u32 s96, s96, 1
    v_add_u32 v18, s97, v18
    v_add_u32 v19, s97, v19
    s_add_u32 s93, s93, 1
    s_cmp_lt_u32 s93, 15
    s_cbranch_scc1 L_CQ_g2c
    buffer_load_dwordx4 v[128:131], v220, s[8:11], 0 offen
    buffer_load_dword v232, v228, s[20:23], s76 offen sc1
    buffer_load_dwordx4 v[132:135], v221, s[8:11], 0 offen
    buffer_load_dword v233, v229, s[20:23], s76 offen sc1
    .p2align 3
L_CQ_g2e:
    s_waitcnt lgkmcnt(0)
    s_barrier
    ds_read_b128 v[48:51], v18 offset:0
    ds_read_b128 v[52:55], v19 offset:0
    v_mfma_f32_16x16x32_bf16 v[32:35], v[92:95], v[88:91], v[32:35]
    ds_read_b128 v[56:59], v19 offset:1024
    v_mfma_f32_16x16x32_bf16 v[36:39], v[96:99], v[88:91], v[36:39]
    ds_read_b128 v[60:63], v19 offset:2048
    v_mfma_f32_16x16x32_bf16 v[40:43], v[100:103], v[88:91], v[40:43]
    ds_read_b128 v[64:67], v19 offset:3072
    v_mfma_f32_16x16x32_bf16 v[44:47], v[104:107], v[88:91], v[44:47]
    ds_read_b128 v[68:71], v18 offset:8192
    v_mfma_f32_16x16x32_bf16 v[32:35], v[112:115], v[108:111], v[32:35]
    ds_read_b128 v[72:75], v19 offset:8192
    v_mfma_f32_16x16x32_bf16 v[36:39], v[116:119], v[108:111], v[36:39]
    ds_read_b128 v[76:79], v19 offset:9216
    v_mfma_f32_16x16x32_bf16 v[40:43], v[120:123], v[108:111], v[40:43]
    ds_read_b128 v[80:83], v19 offset:10240
    v_mfma_f32_16x16x32_bf16 v[44:47], v[124:127], v[108:111], v[44:47]
    ds_read_b128 v[84:87], v19 offset:11264
    s_waitcnt lgkmcnt(5)
    ds_read_b128 v[88:91], v18 offset:16384
    ds_read_b128 v[92:95], v19 offset:16384
    v_mfma_f32_16x16x32_bf16 v[32:35], v[52:55], v[48:51], v[32:35]
    ds_read_b128 v[96:99], v19 offset:17408
    v_mfma_f32_16x16x32_bf16 v[36:39], v[56:59], v[48:51], v[36:39]
    ds_read_b128 v[100:103], v19 offset:18432
    v_mfma_f32_16x16x32_bf16 v[40:43], v[60:63], v[48:51], v[40:43]
    ds_read_b128 v[104:107], v19 offset:19456
    v_mfma_f32_16x16x32_bf16 v[44:47], v[64:67], v[48:51], v[44:47]
    ds_read_b128 v[108:111], v18 offset:24576
    s_waitcnt lgkmcnt(6)
    v_mfma_f32_16x16x32_bf16 v[32:35], v[72:75], v[68:71], v[32:35]
    ds_read_b128 v[112:115], v19 offset:24576
    v_mfma_f32_16x16x32_bf16 v[36:39], v[76:79], v[68:71], v[36:39]
    ds_read_b128 v[116:119], v19 offset:25600
    v_mfma_f32_16x16x32_bf16 v[40:43], v[80:83], v[68:71], v[40:43]
    ds_read_b128 v[120:123], v19 offset:26624
    v_mfma_f32_16x16x32_bf16 v[44:47], v[84:87], v[68:71], v[44:47]
    ds_read_b128 v[124:127], v19 offset:27648
    s_mov_b32 s97, 0xfffea000
    s_cmp_eq_u32 s96, 1
    s_cselect_b32 s97, 0xb000, s97
    s_cmp_eq_u32 s96, 2
    s_cselect_b32 s97, 0xb000, s97
    s_cselect_b32 s96, -1, s96
    s_add_u32 s96, s96, 1
    v_add_u32 v18, s97, v18
    v_add_u32 v19, s97, v19
    s_add_u32 s93, s93, 1
    s_cmp_lt_u32 s93, 17
    s_cbranch_scc1 L_CQ_g2e
    s_waitcnt lgkmcnt(0)
    v_mfma_f32_16x16x32_bf16 v[32:35], v[92:95], v[88:91], v[32:35]
    v_mfma_f32_16x16x32_bf16 v[36:39], v[96:99], v[88:91], v[36:39]
    v_mfma_f32_16x16x32_bf16 v[40:43], v[100:103], v[88:91], v[40:43]
    v_mfma_f32_16x16x32_bf16 v[44:47], v[104:107], v[88:91], v[44:47]
    v_mfma_f32_16x16x32_bf16 v[32:35], v[112:115], v[108:111], v[32:35]
    v_mfma_f32_16x16x32_bf16 v[36:39], v[116:119], v[108:111], v[36:39]
    v_mfma_f32_16x16x32_bf16 v[40:43], v[120:123], v[108:111], v[40:43]
    v_mfma_f32_16x16x32_bf16 v[44:47], v[124:127], v[108:111], v[44:47]
    s_nop 7
    ds_write_b128 v236, v[32:35] offset:0
    ds_write_b128 v236, v[36:39] offset:64
    ds_write_b128 v236, v[40:43] offset:128
    ds_write_b128 v236, v[44:47] offset:192
    s_waitcnt lgkmcnt(0)
    ds_read_b128 v[48:51], v224 offset:0
    ds_read_b128 v[52:55], v224 offset:16
    ds_read_b128 v[56:59], v225 offset:0
    ds_read_b128 v[60:63], v225 offset:16
    s_waitcnt vmcnt(0)
    s_waitcnt lgkmcnt(2)
    v_lshlrev_b32 v10, 16, v128
    v_and_b32 v11, s67, v128
    v_fma_f32 v10, v48, v232, v10
    v_fma_f32 v11, v49, v232, v11
    v_cvt_pk_bf16_f32 v144, v10, v11
    v_lshlrev_b32 v10, 16, v129
    v_and_b32 v11, s67, v129
    v_fma_f32 v10, v50, v232, v10
    v_fma_f32 v11, v51, v232, v11
    v_cvt_pk_bf16_f32 v145, v10, v11
    v_lshlrev_b32 v10, 16, v130
    v_and_b32 v11, s67, v130
    v_fma_f32 v10, v52, v232, v10
    v_fma_f32 v11, v53, v232, v11
    v_cvt_pk_bf16_f32 v146, v10, v11
    v_lshlrev_b32 v10, 16, v131
    v_and_b32 v11, s67, v131
    v_fma_f32 v10, v54, v232, v10
    v_fma_f32 v11, v55, v232, v11
    v_cvt_pk_bf16_f32 v147, v10, v11
    buffer_store_dwordx4 v[144:147], v220, s[84:87], 0 offen
    s_waitcnt lgkmcnt(0)
    v_lshlrev_b32 v10, 16, v132
    v_and_b32 v11, s67, v132
    v_fma_f32 v10, v56, v233, v10
    v_fma_f32 v11, v57, v233, v11
    v_cvt_pk_bf16_f32 v148, v10, v11
    v_lshlrev_b32 v10, 16, v133
    v_and_b32 v11, s67, v133
    v_fma_f32 v10, v58, v233, v10
    v_fma_f32 v11, v59, v233, v11
    v_cvt_pk_bf16_f32 v149, v10, v11
    v_lshlrev_b32 v10, 16, v134
    v_and_b32 v11, s67, v134
    v_fma_f32 v10, v60, v233, v10
    v_fma_f32 v11, v61, v233, v11
    v_cvt_pk_bf16_f32 v150, v10, v11
    v_lshlrev_b32 v10, 16, v135
    v_and_b32 v11, s67, v135
    v_fma_f32 v10, v62, v233, v10
    v_fma_f32 v11, v63, v233, v11
    v_cvt_pk_bf16_f32 v151, v10, v11
    buffer_store_dwordx4 v[148:151], v221, s[84:87], 0 offen
    s_endpgm
L_LQ:
    v_lshrrev_b32 v10, 3, v1
    v_and_b32 v11, 7, v1
    v_lshrrev_b32 v12, 1, v10
    v_xor_b32 v11, v11, v12
    v_xor_b32 v12, 4, v11
    v_mul_u32_u24 v10, 1280, v10
    v_lshl_add_u32 v18, v11, 4, v10
    v_lshl_add_u32 v19, v12, 4, v10
    v_add_u32 v19, 10240, v19
    v_add_u32 v20, 20480, v18
    v_add_u32 v21, 20480, v19
    s_lshl_b32 s42, s36, 1
    s_lshl_b32 s39, s37, 2
    s_add_u32 s39, s39, s42
    s_mul_i32 s60, s39, 40960
    s_add_u32 s43, s60, 1280
    s_lshl_b32 s39, s83, 7
    s_add_u32 s60, s60, s39
    s_lshl_b32 s63, s42, 12
    s_lshl_b32 s40, s83, 2
    s_add_u32 s40, s40, s42
    s_mul_i32 s61, s40, 49152
    s_mul_i32 s62, s40, 61440
    s_mul_i32 s64, s42, 4096
    s_mul_i32 s75, s42, 3072
    s_add_u32 s77, s60, 40960
    v_mov_b32 v45, 1073741824
    s_mul_i32 s39, s38, 160
    v_add_u32 v10, 0, v1
    v_mul_u32_u24 v11, 5462, v10
    v_lshrrev_b32 v11, 16, v11
    v_mul_u32_u24 v12, 12, v11
    v_sub_u32 v12, v10, v12
    v_cmp_lt_u32 vcc, 9, v12
    v_mul_u32_u24 v11, 3840, v11
    v_lshl_add_u32 v11, v12, 4, v11
    v_add_u32 v11, s39, v11
    v_cndmask_b32 v28, v11, v45, vcc
    v_add_u32 v10, 64, v1
    v_mul_u32_u24 v11, 5462, v10
    v_lshrrev_b32 v11, 16, v11
    v_mul_u32_u24 v12, 12, v11
    v_sub_u32 v12, v10, v12
    v_cmp_lt_u32 vcc, 9, v12
    v_mul_u32_u24 v11, 3840, v11
    v_lshl_add_u32 v11, v12, 4, v11
    v_add_u32 v11, s39, v11
    v_cndmask_b32 v29, v11, v45, vcc
    v_add_u32 v10, 128, v1
    v_mul_u32_u24 v11, 5462, v10
    v_lshrrev_b32 v11, 16, v11
    v_mul_u32_u24 v12, 12, v11
    v_sub_u32 v12, v10, v12
    v_cmp_lt_u32 vcc, 9, v12
    v_mul_u32_u24 v11, 3840, v11
    v_lshl_add_u32 v11, v12, 4, v11
    v_add_u32 v11, s39, v11
    v_cndmask_b32 v30, v11, v45, vcc
    v_bfe_u32 v10, v1, 2, 3
    v_mul_u32_u24 v10, 3072, v10
    v_and_b32 v11, 3, v1
    v_lshl_add_u32 v10, v11, 4, v10
    v_lshl_add_u32 v10, v2, 6, v10
    s_mul_i32 s39, s38, 384
    v_add_u32 v26, s39, v10
    v_add_u32 v27, 24576, v26
    v_add_u32 v22, 128, v26
    v_add_u32 v23, 256, v26
    v_add_u32 v24, 24704, v26
    v_add_u32 v25, 24832, v26
    s_waitcnt lgkmcnt(0)
    s_mov_b32 s8, s44
    s_mov_b32 s9, s45
    s_mov_b32 s10, 2621440
    s_mov_b32 s11, 0x00020000
    s_mov_b32 s12, s46
    s_mov_b32 s13, s47
    s_mov_b32 s14, 2457600
    s_mov_b32 s15, 0x00020000
    s_mov_b32 s16, s52
    s_mov_b32 s17, s53
    s_mov_b32 s18, 1966080
    s_mov_b32 s19, 0x00020000
    s_mov_b32 s20, s58
    s_mov_b32 s21, s59
    s_mov_b32 s22, 14680064
    s_mov_b32 s23, 0x00020000
    s_add_u32 s49, s61, 49152
    s_add_u32 s48, s62, 61440
    s_lshl_b32 s56, s36, 12
    s_add_u32 m0, s63, 0
    s_nop 0
    buffer_load_dwordx4 v18, s[8:11], s60 offen lds
    s_add_u32 m0, s63, 1024
    s_nop 0
    buffer_load_dwordx4 v19, s[8:11], s60 offen lds
    s_add_u32 m0, s63, 2048
    s_nop 0
    buffer_load_dwordx4 v20, s[8:11], s60 offen lds
    s_add_u32 m0, s63, 3072
    s_nop 0
    buffer_load_dwordx4 v21, s[8:11], s60 offen lds
    s_add_u32 m0, s64, 16384
    s_nop 0
    buffer_load_dwordx4 v22, s[16:19], s61 offen lds
    s_add_u32 m0, s64, 17408
    s_nop 0
    buffer_load_dwordx4 v23, s[16:19], s61 offen lds
    s_add_u32 m0, s64, 18432
    s_nop 0
    buffer_load_dwordx4 v24, s[16:19], s61 offen lds
    s_add_u32 m0, s64, 19456
    s_nop 0
    buffer_load_dwordx4 v25, s[16:19], s61 offen lds
    s_add_u32 m0, s56, 32768
    s_nop 0
    buffer_load_dwordx4 v26, s[16:19], s61 offen lds
    s_add_u32 m0, s56, 33792
    s_nop 0
    buffer_load_dwordx4 v27, s[16:19], s61 offen lds
    s_add_u32 m0, s75, 135168
    s_nop 0
    buffer_load_dwordx4 v28, s[12:15], s62 offen lds
    v_bfe_u32 v10, v1, 2, 2
    v_and_b32 v11, 3, v1
    v_lshlrev_b32 v11, 3, v11
    v_and_b32 v12, 16, v1
    v_lshl_add_u32 v11, v12, 1, v11
    v_lshl_add_u32 v58, v10, 6, v11
    v_mul_u32_u24 v12, 2048, v2
    v_add_u32 v58, v58, v12
    s_mul_i32 s39, s36, 512
    s_add_u32 s39, s39, 16384
    v_add_u32 v32, s39, v58
    s_lshl_b32 s96, s36, 7
    s_add_u32 m0, s75, 136192
    s_nop 0
    buffer_load_dwordx4 v29, s[12:15], s62 offen lds
    v_bfe_u32 v10, v1, 2, 2
    v_and_b32 v11, 3, v1
    v_lshlrev_b32 v11, 3, v11
    v_and_b32 v12, 16, v1
    v_lshl_add_u32 v11, v12, 1, v11
    v_lshl_add_u32 v58, v10, 6, v11
    v_mul_u32_u24 v12, 1024, v2
    v_add_u32 v58, v58, v12
    s_and_b32 s97, s36, 1
    s_lshl_b32 s39, s97, 9
    s_add_u32 s39, s39, 32768
    v_add_u32 v33, s39, v58
    s_add_u32 s97, s97, 4
    s_lshl_b32 s97, s97, 7
    s_add_u32 m0, s75, 137216
    s_nop 0
    buffer_load_dwordx4 v30, s[12:15], s62 offen lds
    v_bfe_u32 v10, v1, 2, 2
    v_and_b32 v11, 3, v1
    v_lshlrev_b32 v11, 3, v11
    v_and_b32 v12, 16, v1
    v_lshl_add_u32 v11, v12, 1, v11
    v_lshl_add_u32 v12, v2, 3, v10
    v_mul_u32_u24 v58, 192, v12
    v_add_u32 v58, v58, v11
    s_min_u32 s78, s36, 2
    s_lshl_b32 s39, s78, 6
    s_add_u32 s39, s39, 135168
    v_add_u32 v34, s39, v58
    s_add_u32 s78, s78, 6
    s_lshl_b32 s78, s78, 7
    s_add_u32 m0, s63, 4096
    s_nop 0
    buffer_load_dwordx4 v18, s[8:11], s77 offen lds
    v_and_b32 v10, 31, v1
    v_bfe_u32 v11, v1, 1, 3
    v_xor_b32 v11, v11, v2
    s_lshl_b32 s39, s36, 12
    v_lshl_add_u32 v10, v10, 7, s39
    v_xor_b32 v12, 0, v11
    v_lshl_add_u32 v112, v12, 4, v10
    v_xor_b32 v12, 2, v11
    v_lshl_add_u32 v113, v12, 4, v10
    v_xor_b32 v12, 4, v11
    v_lshl_add_u32 v114, v12, 4, v10
    v_xor_b32 v12, 6, v11
    v_lshl_add_u32 v115, v12, 4, v10
    s_add_u32 m0, s63, 5120
    s_nop 0
    buffer_load_dwordx4 v19, s[8:11], s77 offen lds
    s_lshl_b32 s42, s36, 1
    s_mul_i32 s76, s89, 68
    s_add_u32 s76, s76, s42
    s_lshl_b32 s76, s76, 12
    s_mul_i32 s79, s90, 68
    s_add_u32 s79, s79, s42
    s_mul_i32 s79, s79, 10240
    s_add_u32 s79, s79, 9443328
    s_mul_i32 s57, s42, 8192
    s_add_u32 m0, s63, 6144
    s_nop 0
    buffer_load_dwordx4 v20, s[8:11], s77 offen lds
    s_mov_b32 s47, 0
    s_mov_b32 s50, 0
    s_add_u32 m0, s63, 7168
    s_nop 0
    buffer_load_dwordx4 v21, s[8:11], s77 offen lds
    s_add_u32 m0, s64, 20480
    s_nop 0
    buffer_load_dwordx4 v22, s[16:19], s49 offen lds
    s_add_u32 m0, s64, 21504
    s_nop 0
    buffer_load_dwordx4 v23, s[16:19], s49 offen lds
    s_add_u32 m0, s64, 22528
    s_nop 0
    buffer_load_dwordx4 v24, s[16:19], s49 offen lds
    s_add_u32 m0, s64, 23552
    s_nop 0
    buffer_load_dwordx4 v25, s[16:19], s49 offen lds
    s_add_u32 m0, s56, 34816
    s_nop 0
    buffer_load_dwordx4 v26, s[16:19], s49 offen lds
    s_add_u32 m0, s56, 35840
    s_nop 0
    buffer_load_dwordx4 v27, s[16:19], s49 offen lds
    s_add_u32 m0, s75, 138240
    s_nop 0
    buffer_load_dwordx4 v28, s[12:15], s48 offen lds
    s_add_u32 m0, s75, 139264
    s_nop 0
    buffer_load_dwordx4 v29, s[12:15], s48 offen lds
    s_add_u32 m0, s75, 140288
    s_nop 0
    buffer_load_dwordx4 v30, s[12:15], s48 offen lds
    s_add_u32 s60, s60, 128
    s_cmp_ge_u32 s60, s43
    s_cselect_b32 s69, 1280, 0
    s_sub_u32 s60, s60, s69
    s_add_u32 s77, s60, 40960
    s_add_u32 s61, s61, 196608
    s_cmp_ge_u32 s61, 1966080
    s_cselect_b32 s69, 1966080, 0
    s_sub_u32 s61, s61, s69
    s_add_u32 s49, s61, 49152
    s_add_u32 m0, s63, 45056
    s_nop 0
    buffer_load_dwordx4 v18, s[8:11], s60 offen lds
    s_add_u32 m0, s63, 46080
    s_nop 0
    buffer_load_dwordx4 v19, s[8:11], s60 offen lds
    s_add_u32 m0, s63, 47104
    s_nop 0
    buffer_load_dwordx4 v20, s[8:11], s60 offen lds
    s_add_u32 m0, s63, 48128
    s_nop 0
    buffer_load_dwordx4 v21, s[8:11], s60 offen lds
    s_add_u32 m0, s64, 61440
    s_nop 0
    buffer_load_dwordx4 v22, s[16:19], s61 offen lds
    s_add_u32 m0, s64, 62464
    s_nop 0
    buffer_load_dwordx4 v23, s[16:19], s61 offen lds
    s_add_u32 m0, s64, 63488
    s_nop 0
    buffer_load_dwordx4 v24, s[16:19], s61 offen lds
    s_add_u32 m0, s64, 64512
    s_nop 0
    buffer_load_dwordx4 v25, s[16:19], s61 offen lds
    s_add_u32 m0, s63, 49152
    s_nop 0
    buffer_load_dwordx4 v18, s[8:11], s77 offen lds
    s_add_u32 m0, s63, 50176
    s_nop 0
    buffer_load_dwordx4 v19, s[8:11], s77 offen lds
    s_add_u32 m0, s63, 51200
    s_nop 0
    buffer_load_dwordx4 v20, s[8:11], s77 offen lds
    s_add_u32 m0, s63, 52224
    s_nop 0
    buffer_load_dwordx4 v21, s[8:11], s77 offen lds
    s_add_u32 m0, s64, 65536
    s_nop 0
    buffer_load_dwordx4 v22, s[16:19], s49 offen lds
    s_add_u32 m0, s64, 66560
    s_nop 0
    buffer_load_dwordx4 v23, s[16:19], s49 offen lds
    s_add_u32 m0, s64, 67584
    s_nop 0
    buffer_load_dwordx4 v24, s[16:19], s49 offen lds
    s_add_u32 m0, s64, 68608
    s_nop 0
    buffer_load_dwordx4 v25, s[16:19], s49 offen lds
    s_add_u32 s60, s60, 128
    s_cmp_ge_u32 s60, s43
    s_cselect_b32 s69, 1280, 0
    s_sub_u32 s60, s60, s69
    s_add_u32 s77, s60, 40960
    s_add_u32 s61, s61, 196608
    s_cmp_ge_u32 s61, 1966080
    s_cselect_b32 s69, 1966080, 0
    s_sub_u32 s61, s61, s69
    s_add_u32 s49, s61, 49152
    s_waitcnt vmcnt(16) lgkmcnt(0)
    s_barrier
    ds_read_b128 v[120:123], v112
    ds_read_b128 v[124:127], v113
    ds_read_b128 v[128:131], v114
    ds_read_b128 v[132:135], v115
    ds_read_b64_tr_b16 v[64:65], v32 offset:0
    ds_read_b64_tr_b16 v[66:67], v32 offset:256
    ds_read_b64_tr_b16 v[68:69], v32 offset:4096
    ds_read_b64_tr_b16 v[70:71], v32 offset:4352
    ds_read_b64_tr_b16 v[72:73], v32 offset:8192
    ds_read_b64_tr_b16 v[74:75], v32 offset:8448
    ds_read_b64_tr_b16 v[76:77], v32 offset:12288
    ds_read_b64_tr_b16 v[78:79], v32 offset:12544
    ds_read_b64_tr_b16 v[80:81], v33 offset:0
    ds_read_b64_tr_b16 v[82:83], v33 offset:256
    ds_read_b64_tr_b16 v[84:85], v33 offset:2048
    ds_read_b64_tr_b16 v[86:87], v33 offset:2304
    ds_read_b64_tr_b16 v[88:89], v33 offset:4096
    ds_read_b64_tr_b16 v[90:91], v33 offset:4352
    ds_read_b64_tr_b16 v[92:93], v33 offset:6144
    ds_read_b64_tr_b16 v[94:95], v33 offset:6400
    ds_read_b64_tr_b16 v[96:97], v34 offset:0
    ds_read_b64_tr_b16 v[98:99], v34 offset:768
    ds_read_b64_tr_b16 v[100:101], v34 offset:3072
    ds_read_b64_tr_b16 v[102:103], v34 offset:3840
    ds_read_b64_tr_b16 v[104:105], v34 offset:6144
    ds_read_b64_tr_b16 v[106:107], v34 offset:6912
    ds_read_b64_tr_b16 v[108:109], v34 offset:9216
    ds_read_b64_tr_b16 v[110:111], v34 offset:9984
    s_add_u32 m0, s63, 90112
    s_nop 0
    buffer_load_dwordx4 v18, s[8:11], s60 offen lds
    s_add_u32 m0, s63, 91136
    s_nop 0
    buffer_load_dwordx4 v19, s[8:11], s60 offen lds
    s_waitcnt lgkmcnt(0)
    s_add_u32 m0, s63, 92160
    s_nop 0
    buffer_load_dwordx4 v20, s[8:11], s60 offen lds
    v_mov_b32 v116, 0
    v_mov_b32 v117, 0
    v_mov_b32 v118, 0
    v_mov_b32 v119, 0
    v_mov_b32 v36, 0
    v_mov_b32 v37, 0
    v_mov_b32 v38, 0
    v_mov_b32 v39, 0
    v_mov_b32 v40, 0
    v_mov_b32 v41, 0
    s_add_u32 m0, s63, 93184
    s_nop 0
    buffer_load_dwordx4 v21, s[8:11], s60 offen lds
    v_lshlrev_b32 v58, 16, v120
    v_and_b32 v59, s67, v120
    v_lshlrev_b32 v60, 16, v121
    v_and_b32 v61, s67, v121
    v_add_f32 v116, v116, v58
    v_add_f32 v117, v117, v59
    v_fmac_f32 v118, v58, v58
    v_fmac_f32 v119, v59, v59
    v_add_f32 v116, v116, v60
    v_add_f32 v117, v117, v61
    v_fmac_f32 v118, v60, v60
    v_fmac_f32 v119, v61, v61
    s_add_u32 m0, s64, 106496
    s_nop 0
    buffer_load_dwordx4 v22, s[16:19], s61 offen lds
    v_lshlrev_b32 v58, 16, v122
    v_and_b32 v59, s67, v122
    v_lshlrev_b32 v60, 16, v123
    v_and_b32 v61, s67, v123
    v_add_f32 v116, v116, v58
    v_add_f32 v117, v117, v59
    v_fmac_f32 v118, v58, v58
    v_fmac_f32 v119, v59, v59
    v_add_f32 v116, v116, v60
    v_add_f32 v117, v117, v61
    v_fmac_f32 v118, v60, v60
    v_fmac_f32 v119, v61, v61
    s_add_u32 m0, s64, 107520
    s_nop 0
    buffer_load_dwordx4 v23, s[16:19], s61 offen lds
    v_lshlrev_b32 v58, 16, v124
    v_and_b32 v59, s67, v124
    v_lshlrev_b32 v60, 16, v125
    v_and_b32 v61, s67, v125
    v_add_f32 v116, v116, v58
    v_add_f32 v117, v117, v59
    v_fmac_f32 v118, v58, v58
    v_fmac_f32 v119, v59, v59
    v_add_f32 v116, v116, v60
    v_add_f32 v117, v117, v61
    v_fmac_f32 v118, v60, v60
    v_fmac_f32 v119, v61, v61
    s_add_u32 m0, s64, 108544
    s_nop 0
    buffer_load_dwordx4 v24, s[16:19], s61 offen lds
    v_lshlrev_b32 v58, 16, v126
    v_and_b32 v59, s67, v126
    v_lshlrev_b32 v60, 16, v127
    v_and_b32 v61, s67, v127
    v_add_f32 v116, v116, v58
    v_add_f32 v117, v117, v59
    v_fmac_f32 v118, v58, v58
    v_fmac_f32 v119, v59, v59
    v_add_f32 v116, v116, v60
    v_add_f32 v117, v117, v61
    v_fmac_f32 v118, v60, v60
    v_fmac_f32 v119, v61, v61
    s_add_u32 m0, s64, 109568
    s_nop 0
    buffer_load_dwordx4 v25, s[16:19], s61 offen lds
    v_lshlrev_b32 v58, 16, v128
    v_and_b32 v59, s67, v128
    v_lshlrev_b32 v60, 16, v129
    v_and_b32 v61, s67, v129
    v_add_f32 v116, v116, v58
    v_add_f32 v117, v117, v59
    v_fmac_f32 v118, v58, v58
    v_fmac_f32 v119, v59, v59
    v_add_f32 v116, v116, v60
    v_add_f32 v117, v117, v61
    v_fmac_f32 v118, v60, v60
    v_fmac_f32 v119, v61, v61
    s_add_u32 m0, s63, 94208
    s_nop 0
    buffer_load_dwordx4 v18, s[8:11], s77 offen lds
    v_lshlrev_b32 v58, 16, v130
    v_and_b32 v59, s67, v130
    v_lshlrev_b32 v60, 16, v131
    v_and_b32 v61, s67, v131
    v_add_f32 v116, v116, v58
    v_add_f32 v117, v117, v59
    v_fmac_f32 v118, v58, v58
    v_fmac_f32 v119, v59, v59
    v_add_f32 v116, v116, v60
    v_add_f32 v117, v117, v61
    v_fmac_f32 v118, v60, v60
    v_fmac_f32 v119, v61, v61
    s_add_u32 m0, s63, 95232
    s_nop 0
    buffer_load_dwordx4 v19, s[8:11], s77 offen lds
    v_lshlrev_b32 v58, 16, v132
    v_and_b32 v59, s67, v132
    v_lshlrev_b32 v60, 16, v133
    v_and_b32 v61, s67, v133
    v_add_f32 v116, v116, v58
    v_add_f32 v117, v117, v59
    v_fmac_f32 v118, v58, v58
    v_fmac_f32 v119, v59, v59
    v_add_f32 v116, v116, v60
    v_add_f32 v117, v117, v61
    v_fmac_f32 v118, v60, v60
    v_fmac_f32 v119, v61, v61
    s_add_u32 m0, s63, 96256
    s_nop 0
    buffer_load_dwordx4 v20, s[8:11], s77 offen lds
    v_lshlrev_b32 v58, 16, v134
    v_and_b32 v59, s67, v134
    v_lshlrev_b32 v60, 16, v135
    v_and_b32 v61, s67, v135
    v_add_f32 v116, v116, v58
    v_add_f32 v117, v117, v59
    v_fmac_f32 v118, v58, v58
    v_fmac_f32 v119, v59, v59
    v_add_f32 v116, v116, v60
    v_add_f32 v117, v117, v61
    v_fmac_f32 v118, v60, v60
    v_fmac_f32 v119, v61, v61
    s_add_u32 m0, s63, 97280
    s_nop 0
    buffer_load_dwordx4 v21, s[8:11], s77 offen lds
    v_lshlrev_b32 v58, 16, v64
    v_and_b32 v59, s67, v64
    v_lshlrev_b32 v60, 16, v80
    v_and_b32 v61, s67, v80
    v_lshlrev_b32 v62, 16, v96
    v_and_b32 v63, s67, v96
    v_add_f32 v36, v36, v58
    v_add_f32 v37, v37, v59
    v_add_f32 v38, v38, v60
    v_add_f32 v39, v39, v61
    v_add_f32 v40, v40, v62
    v_add_f32 v41, v41, v63
    s_add_u32 m0, s64, 110592
    s_nop 0
    buffer_load_dwordx4 v22, s[16:19], s49 offen lds
    v_lshlrev_b32 v58, 16, v65
    v_and_b32 v59, s67, v65
    v_lshlrev_b32 v60, 16, v81
    v_and_b32 v61, s67, v81
    v_lshlrev_b32 v62, 16, v97
    v_and_b32 v63, s67, v97
    v_add_f32 v36, v36, v58
    v_add_f32 v37, v37, v59
    v_add_f32 v38, v38, v60
    v_add_f32 v39, v39, v61
    v_add_f32 v40, v40, v62
    v_add_f32 v41, v41, v63
    s_add_u32 m0, s64, 111616
    s_nop 0
    buffer_load_dwordx4 v23, s[16:19], s49 offen lds
    v_lshlrev_b32 v58, 16, v66
    v_and_b32 v59, s67, v66
    v_lshlrev_b32 v60, 16, v82
    v_and_b32 v61, s67, v82
    v_lshlrev_b32 v62, 16, v98
    v_and_b32 v63, s67, v98
    v_add_f32 v36, v36, v58
    v_add_f32 v37, v37, v59
    v_add_f32 v38, v38, v60
    v_add_f32 v39, v39, v61
    v_add_f32 v40, v40, v62
    v_add_f32 v41, v41, v63
    s_add_u32 m0, s64, 112640
    s_nop 0
    buffer_load_dwordx4 v24, s[16:19], s49 offen lds
    v_lshlrev_b32 v58, 16, v67
    v_and_b32 v59, s67, v67
    v_lshlrev_b32 v60, 16, v83
    v_and_b32 v61, s67, v83
    v_lshlrev_b32 v62, 16, v99
    v_and_b32 v63, s67, v99
    v_add_f32 v36, v36, v58
    v_add_f32 v37, v37, v59
    v_add_f32 v38, v38, v60
    v_add_f32 v39, v39, v61
    v_add_f32 v40, v40, v62
    v_add_f32 v41, v41, v63
    s_add_u32 m0, s64, 113664
    s_nop 0
    buffer_load_dwordx4 v25, s[16:19], s49 offen lds
    s_add_u32 s60, s60, 128
    s_cmp_ge_u32 s60, s43
    s_cselect_b32 s69, 1280, 0
    s_sub_u32 s60, s60, s69
    s_add_u32 s77, s60, 40960
    s_add_u32 s61, s61, 196608
    s_cmp_ge_u32 s61, 1966080
    s_cselect_b32 s69, 1966080, 0
    s_sub_u32 s61, s61, s69
    s_add_u32 s49, s61, 49152
    s_waitcnt vmcnt(16) lgkmcnt(0)
    s_barrier
    s_add_u32 m0, s63, 0
    s_nop 0
    buffer_load_dwordx4 v18, s[8:11], s60 offen lds
    v_lshlrev_b32 v58, 16, v68
    v_and_b32 v59, s67, v68
    v_lshlrev_b32 v60, 16, v84
    v_and_b32 v61, s67, v84
    v_lshlrev_b32 v62, 16, v100
    v_and_b32 v63, s67, v100
    v_add_f32 v36, v36, v58
    v_add_f32 v37, v37, v59
    v_add_f32 v38, v38, v60
    v_add_f32 v39, v39, v61
    v_add_f32 v40, v40, v62
    v_add_f32 v41, v41, v63
    s_add_u32 m0, s63, 1024
    s_nop 0
    buffer_load_dwordx4 v19, s[8:11], s60 offen lds
    v_lshlrev_b32 v58, 16, v69
    v_and_b32 v59, s67, v69
    v_lshlrev_b32 v60, 16, v85
    v_and_b32 v61, s67, v85
    v_lshlrev_b32 v62, 16, v101
    v_and_b32 v63, s67, v101
    v_add_f32 v36, v36, v58
    v_add_f32 v37, v37, v59
    v_add_f32 v38, v38, v60
    v_add_f32 v39, v39, v61
    v_add_f32 v40, v40, v62
    v_add_f32 v41, v41, v63
    s_add_u32 m0, s63, 2048
    s_nop 0
    buffer_load_dwordx4 v20, s[8:11], s60 offen lds
    v_lshlrev_b32 v58, 16, v70
    v_and_b32 v59, s67, v70
    v_lshlrev_b32 v60, 16, v86
    v_and_b32 v61, s67, v86
    v_lshlrev_b32 v62, 16, v102
    v_and_b32 v63, s67, v102
    v_add_f32 v36, v36, v58
    v_add_f32 v37, v37, v59
    v_add_f32 v38, v38, v60
    v_add_f32 v39, v39, v61
    v_add_f32 v40, v40, v62
    v_add_f32 v41, v41, v63
    s_add_u32 m0, s63, 3072
    s_nop 0
    buffer_load_dwordx4 v21, s[8:11], s60 offen lds
    v_lshlrev_b32 v58, 16, v71
    v_and_b32 v59, s67, v71
    v_lshlrev_b32 v60, 16, v87
    v_and_b32 v61, s67, v87
    v_lshlrev_b32 v62, 16, v103
    v_and_b32 v63, s67, v103
    v_add_f32 v36, v36, v58
    v_add_f32 v37, v37, v59
    v_add_f32 v38, v38, v60
    v_add_f32 v39, v39, v61
    v_add_f32 v40, v40, v62
    v_add_f32 v41, v41, v63
    s_add_u32 m0, s64, 16384
    s_nop 0
    buffer_load_dwordx4 v22, s[16:19], s61 offen lds
    v_lshlrev_b32 v58, 16, v72
    v_and_b32 v59, s67, v72
    v_lshlrev_b32 v60, 16, v88
    v_and_b32 v61, s67, v88
    v_lshlrev_b32 v62, 16, v104
    v_and_b32 v63, s67, v104
    v_add_f32 v36, v36, v58
    v_add_f32 v37, v37, v59
    v_add_f32 v38, v38, v60
    v_add_f32 v39, v39, v61
    v_add_f32 v40, v40, v62
    v_add_f32 v41, v41, v63
    s_add_u32 m0, s64, 17408
    s_nop 0
    buffer_load_dwordx4 v23, s[16:19], s61 offen lds
    v_lshlrev_b32 v58, 16, v73
    v_and_b32 v59, s67, v73
    v_lshlrev_b32 v60, 16, v89
    v_and_b32 v61, s67, v89
    v_lshlrev_b32 v62, 16, v105
    v_and_b32 v63, s67, v105
    v_add_f32 v36, v36, v58
    v_add_f32 v37, v37, v59
    v_add_f32 v38, v38, v60
    v_add_f32 v39, v39, v61
    v_add_f32 v40, v40, v62
    v_add_f32 v41, v41, v63
    s_add_u32 m0, s64, 18432
    s_nop 0
    buffer_load_dwordx4 v24, s[16:19], s61 offen lds
    v_lshlrev_b32 v58, 16, v74
    v_and_b32 v59, s67, v74
    v_lshlrev_b32 v60, 16, v90
    v_and_b32 v61, s67, v90
    v_lshlrev_b32 v62, 16, v106
    v_and_b32 v63, s67, v106
    v_add_f32 v36, v36, v58
    v_add_f32 v37, v37, v59
    v_add_f32 v38, v38, v60
    v_add_f32 v39, v39, v61
    v_add_f32 v40, v40, v62
    v_add_f32 v41, v41, v63
    s_add_u32 m0, s64, 19456
    s_nop 0
    buffer_load_dwordx4 v25, s[16:19], s61 offen lds
    v_lshlrev_b32 v58, 16, v75
    v_and_b32 v59, s67, v75
    v_lshlrev_b32 v60, 16, v91
    v_and_b32 v61, s67, v91
    v_lshlrev_b32 v62, 16, v107
    v_and_b32 v63, s67, v107
    v_add_f32 v36, v36, v58
    v_add_f32 v37, v37, v59
    v_add_f32 v38, v38, v60
    v_add_f32 v39, v39, v61
    v_add_f32 v40, v40, v62
    v_add_f32 v41, v41, v63
    s_add_u32 m0, s63, 4096
    s_nop 0
    buffer_load_dwordx4 v18, s[8:11], s77 offen lds
    v_lshlrev_b32 v58, 16, v76
    v_and_b32 v59, s67, v76
    v_lshlrev_b32 v60, 16, v92
    v_and_b32 v61, s67, v92
    v_lshlrev_b32 v62, 16, v108
    v_and_b32 v63, s67, v108
    v_add_f32 v36, v36, v58
    v_add_f32 v37, v37, v59
    v_add_f32 v38, v38, v60
    v_add_f32 v39, v39, v61
    v_add_f32 v40, v40, v62
    v_add_f32 v41, v41, v63
    s_add_u32 m0, s63, 5120
    s_nop 0
    buffer_load_dwordx4 v19, s[8:11], s77 offen lds
    v_lshlrev_b32 v58, 16, v77
    v_and_b32 v59, s67, v77
    v_lshlrev_b32 v60, 16, v93
    v_and_b32 v61, s67, v93
    v_lshlrev_b32 v62, 16, v109
    v_and_b32 v63, s67, v109
    v_add_f32 v36, v36, v58
    v_add_f32 v37, v37, v59
    v_add_f32 v38, v38, v60
    v_add_f32 v39, v39, v61
    v_add_f32 v40, v40, v62
    v_add_f32 v41, v41, v63
    s_add_u32 m0, s63, 6144
    s_nop 0
    buffer_load_dwordx4 v20, s[8:11], s77 offen lds
    v_lshlrev_b32 v58, 16, v78
    v_and_b32 v59, s67, v78
    v_lshlrev_b32 v60, 16, v94
    v_and_b32 v61, s67, v94
    v_lshlrev_b32 v62, 16, v110
    v_and_b32 v63, s67, v110
    v_add_f32 v36, v36, v58
    v_add_f32 v37, v37, v59
    v_add_f32 v38, v38, v60
    v_add_f32 v39, v39, v61
    v_add_f32 v40, v40, v62
    v_add_f32 v41, v41, v63
    s_add_u32 m0, s63, 7168
    s_nop 0
    buffer_load_dwordx4 v21, s[8:11], s77 offen lds
    v_lshlrev_b32 v58, 16, v79
    v_and_b32 v59, s67, v79
    v_lshlrev_b32 v60, 16, v95
    v_and_b32 v61, s67, v95
    v_lshlrev_b32 v62, 16, v111
    v_and_b32 v63, s67, v111
    v_add_f32 v36, v36, v58
    v_add_f32 v37, v37, v59
    v_add_f32 v38, v38, v60
    v_add_f32 v39, v39, v61
    v_add_f32 v40, v40, v62
    v_add_f32 v41, v41, v63
    s_add_u32 m0, s64, 20480
    s_nop 0
    buffer_load_dwordx4 v22, s[16:19], s49 offen lds
    v_add_f32 v116, v116, v117
    v_add_f32 v117, v118, v119
    v_add_f32 v36, v36, v37
    v_add_f32 v38, v38, v39
    v_add_f32 v40, v40, v41
    v_mov_b32 v58, v116
    v_mov_b32 v59, v117
    v_mov_b32 v60, v36
    v_mov_b32 v61, v38
    v_mov_b32 v62, v40
    s_nop 1
    v_permlane32_swap_b32 v116, v58
    v_permlane32_swap_b32 v117, v59
    v_permlane32_swap_b32 v36, v60
    v_permlane32_swap_b32 v38, v61
    v_permlane32_swap_b32 v40, v62
    s_nop 1
    v_add_f32 v116, v116, v58
    v_add_f32 v117, v117, v59
    v_add_f32 v36, v36, v60
    v_add_f32 v38, v38, v61
    v_add_f32 v40, v40, v62
    v_max_u32 v116, 1, v116
    v_max_u32 v117, 1, v117
    v_max_u32 v36, 1, v36
    v_max_u32 v38, 1, v38
    v_max_u32 v40, 1, v40
    s_add_u32 m0, s64, 21504
    s_nop 0
    buffer_load_dwordx4 v23, s[16:19], s49 offen lds
    s_add_u32 m0, s64, 22528
    s_nop 0
    buffer_load_dwordx4 v24, s[16:19], s49 offen lds
    s_add_u32 m0, s64, 23552
    s_nop 0
    buffer_load_dwordx4 v25, s[16:19], s49 offen lds
    s_add_u32 s60, s60, 128
    s_cmp_ge_u32 s60, s43
    s_cselect_b32 s69, 1280, 0
    s_sub_u32 s60, s60, s69
    s_add_u32 s77, s60, 40960
    s_add_u32 s61, s61, 196608
    s_cmp_ge_u32 s61, 1966080
    s_cselect_b32 s69, 1966080, 0
    s_sub_u32 s61, s61, s69
    s_add_u32 s49, s61, 49152
    s_mul_i32 s39, s37, 10
    s_add_u32 s39, s39, s83
    s_lshl_b32 s39, s39, 10
    s_add_u32 s39, s39, 13762560
    s_cmp_lt_u32 s88, 10
    s_cselect_b32 s39, s39, 1073741824
    s_mul_i32 s42, s88, 10
    s_add_u32 s42, s42, s83
    s_lshl_b32 s42, s42, 11
    s_add_u32 s42, s42, 12845056
    s_cmp_lt_u32 s37, 10
    s_cselect_b32 s42, s42, 1073741824
    s_lshl_b32 s40, s36, 8
    s_add_u32 s39, s39, s40
    v_lshlrev_b32 v58, 1, v3
    v_cndmask_b32 v58, v58, v45, s[70:71]
    buffer_store_dwordx2 v[116:117], v58, s[20:23], s39 offen sc1
    v_add_u32 v59, s96, v3
    v_add_u32 v60, s97, v3
    v_cndmask_b32 v59, v59, v60, s[70:71]
    v_cndmask_b32 v36, v36, v38, s[70:71]
    buffer_store_dword v36, v59, s[20:23], s42 offen sc1
    v_add_u32 v61, s78, v3
    v_cndmask_b32 v61, v61, v45, s[70:71]
    buffer_store_dword v40, v61, s[20:23], s42 offen sc1
    s_waitcnt vmcnt(19) lgkmcnt(0)
    s_barrier
    s_add_u32 m0, s63, 45056
    s_nop 0
    buffer_load_dwordx4 v18, s[8:11], s60 offen lds
    s_add_u32 m0, s63, 46080
    s_nop 0
    buffer_load_dwordx4 v19, s[8:11], s60 offen lds
    s_add_u32 m0, s63, 47104
    s_nop 0
    buffer_load_dwordx4 v20, s[8:11], s60 offen lds
    s_add_u32 m0, s63, 48128
    s_nop 0
    buffer_load_dwordx4 v21, s[8:11], s60 offen lds
    s_add_u32 m0, s64, 61440
    s_nop 0
    buffer_load_dwordx4 v22, s[16:19], s61 offen lds
    s_add_u32 m0, s64, 62464
    s_nop 0
    buffer_load_dwordx4 v23, s[16:19], s61 offen lds
    s_add_u32 m0, s64, 63488
    s_nop 0
    buffer_load_dwordx4 v24, s[16:19], s61 offen lds
    s_add_u32 m0, s64, 64512
    s_nop 0
    buffer_load_dwordx4 v25, s[16:19], s61 offen lds
    s_add_u32 m0, s63, 49152
    s_nop 0
    buffer_load_dwordx4 v18, s[8:11], s77 offen lds
    s_add_u32 m0, s63, 50176
    s_nop 0
    buffer_load_dwordx4 v19, s[8:11], s77 offen lds
    s_add_u32 m0, s63, 51200
    s_nop 0
    buffer_load_dwordx4 v20, s[8:11], s77 offen lds
    s_add_u32 m0, s63, 52224
    s_nop 0
    buffer_load_dwordx4 v21, s[8:11], s77 offen lds
    s_add_u32 m0, s64, 65536
    s_nop 0
    buffer_load_dwordx4 v22, s[16:19], s49 offen lds
    s_add_u32 m0, s64, 66560
    s_nop 0
    buffer_load_dwordx4 v23, s[16:19], s49 offen lds
    s_add_u32 m0, s64, 67584
    s_nop 0
    buffer_load_dwordx4 v24, s[16:19], s49 offen lds
    s_add_u32 m0, s64, 68608
    s_nop 0
    buffer_load_dwordx4 v25, s[16:19], s49 offen lds
    s_add_u32 s60, s60, 128
    s_cmp_ge_u32 s60, s43
    s_cselect_b32 s69, 1280, 0
    s_sub_u32 s60, s60, s69
    s_add_u32 s77, s60, 40960
    s_add_u32 s61, s61, 196608
    s_cmp_ge_u32 s61, 1966080
    s_cselect_b32 s69, 1966080, 0
    s_sub_u32 s61, s61, s69
    s_add_u32 s49, s61, 49152
    s_waitcnt vmcnt(19) lgkmcnt(0)
    s_barrier
    s_add_u32 m0, s63, 90112
    s_nop 0
    buffer_load_dwordx4 v18, s[8:11], s60 offen lds
    s_add_u32 m0, s63, 91136
    s_nop 0
    buffer_load_dwordx4 v19, s[8:11], s60 offen lds
    s_add_u32 m0, s63, 92160
    s_nop 0
    buffer_load_dwordx4 v20, s[8:11], s60 offen lds
    s_add_u32 m0, s63, 93184
    s_nop 0
    buffer_load_dwordx4 v21, s[8:11], s60 offen lds
    s_add_u32 m0, s64, 106496
    s_nop 0
    buffer_load_dwordx4 v22, s[16:19], s61 offen lds
    s_add_u32 m0, s64, 107520
    s_nop 0
    buffer_load_dwordx4 v23, s[16:19], s61 offen lds
    s_add_u32 m0, s64, 108544
    s_nop 0
    buffer_load_dwordx4 v24, s[16:19], s61 offen lds
    s_add_u32 m0, s64, 109568
    s_nop 0
    buffer_load_dwordx4 v25, s[16:19], s61 offen lds
    s_add_u32 m0, s63, 94208
    s_nop 0
    buffer_load_dwordx4 v18, s[8:11], s77 offen lds
    s_add_u32 m0, s63, 95232
    s_nop 0
    buffer_load_dwordx4 v19, s[8:11], s77 offen lds
    s_add_u32 m0, s63, 96256
    s_nop 0
    buffer_load_dwordx4 v20, s[8:11], s77 offen lds
    s_add_u32 m0, s63, 97280
    s_nop 0
    buffer_load_dwordx4 v21, s[8:11], s77 offen lds
    s_add_u32 m0, s64, 110592
    s_nop 0
    buffer_load_dwordx4 v22, s[16:19], s49 offen lds
    s_add_u32 m0, s64, 111616
    s_nop 0
    buffer_load_dwordx4 v23, s[16:19], s49 offen lds
    s_add_u32 m0, s64, 112640
    s_nop 0
    buffer_load_dwordx4 v24, s[16:19], s49 offen lds
    s_add_u32 m0, s64, 113664
    s_nop 0
    buffer_load_dwordx4 v25, s[16:19], s49 offen lds
    s_add_u32 s60, s60, 128
    s_cmp_ge_u32 s60, s43
    s_cselect_b32 s69, 1280, 0
    s_sub_u32 s60, s60, s69
    s_add_u32 s77, s60, 40960
    s_add_u32 s61, s61, 196608
    s_cmp_ge_u32 s61, 1966080
    s_cselect_b32 s69, 1966080, 0
    s_sub_u32 s61, s61, s69
    s_add_u32 s49, s61, 49152
    s_waitcnt vmcnt(16) lgkmcnt(0)
    s_barrier
    s_add_u32 m0, s63, 0
    s_nop 0
    buffer_load_dwordx4 v18, s[8:11], s60 offen lds
    s_add_u32 m0, s63, 1024
    s_nop 0
    buffer_load_dwordx4 v19, s[8:11], s60 offen lds
    s_add_u32 m0, s63, 2048
    s_nop 0
    buffer_load_dwordx4 v20, s[8:11], s60 offen lds
    s_add_u32 m0, s63, 3072
    s_nop 0
    buffer_load_dwordx4 v21, s[8:11], s60 offen lds
    s_add_u32 m0, s64, 16384
    s_nop 0
    buffer_load_dwordx4 v22, s[16:19], s61 offen lds
    s_add_u32 m0, s64, 17408
    s_nop 0
    buffer_load_dwordx4 v23, s[16:19], s61 offen lds
    s_add_u32 m0, s64, 18432
    s_nop 0
    buffer_load_dwordx4 v24, s[16:19], s61 offen lds
    s_add_u32 m0, s64, 19456
    s_nop 0
    buffer_load_dwordx4 v25, s[16:19], s61 offen lds
    s_add_u32 m0, s63, 4096
    s_nop 0
    buffer_load_dwordx4 v18, s[8:11], s77 offen lds
    s_add_u32 m0, s63, 5120
    s_nop 0
    buffer_load_dwordx4 v19, s[8:11], s77 offen lds
    s_add_u32 m0, s63, 6144
    s_nop 0
    buffer_load_dwordx4 v20, s[8:11], s77 offen lds
    s_add_u32 m0, s63, 7168
    s_nop 0
    buffer_load_dwordx4 v21, s[8:11], s77 offen lds
    s_add_u32 m0, s64, 20480
    s_nop 0
    buffer_load_dwordx4 v22, s[16:19], s49 offen lds
    s_add_u32 m0, s64, 21504
    s_nop 0
    buffer_load_dwordx4 v23, s[16:19], s49 offen lds
    s_add_u32 m0, s64, 22528
    s_nop 0
    buffer_load_dwordx4 v24, s[16:19], s49 offen lds
    s_add_u32 m0, s64, 23552
    s_nop 0
    buffer_load_dwordx4 v25, s[16:19], s49 offen lds
    s_add_u32 s60, s60, 128
    s_cmp_ge_u32 s60, s43
    s_cselect_b32 s69, 1280, 0
    s_sub_u32 s60, s60, s69
    s_add_u32 s77, s60, 40960
    s_add_u32 s61, s61, 196608
    s_cmp_ge_u32 s61, 1966080
    s_cselect_b32 s69, 1966080, 0
    s_sub_u32 s61, s61, s69
    s_add_u32 s49, s61, 49152
    s_waitcnt vmcnt(16) lgkmcnt(0)
    s_barrier
    s_add_u32 m0, s63, 45056
    s_nop 0
    buffer_load_dwordx4 v18, s[8:11], s60 offen lds
    s_add_u32 m0, s63, 46080
    s_nop 0
    buffer_load_dwordx4 v19, s[8:11], s60 offen lds
    s_add_u32 m0, s63, 47104
    s_nop 0
    buffer_load_dwordx4 v20, s[8:11], s60 offen lds
    s_add_u32 m0, s63, 48128
    s_nop 0
    buffer_load_dwordx4 v21, s[8:11], s60 offen lds
    s_add_u32 m0, s64, 61440
    s_nop 0
    buffer_load_dwordx4 v22, s[16:19], s61 offen lds
    s_add_u32 m0, s64, 62464
    s_nop 0
    buffer_load_dwordx4 v23, s[16:19], s61 offen lds
    s_add_u32 m0, s64, 63488
    s_nop 0
    buffer_load_dwordx4 v24, s[16:19], s61 offen lds
    s_add_u32 m0, s64, 64512
    s_nop 0
    buffer_load_dwordx4 v25, s[16:19], s61 offen lds
    s_add_u32 m0, s63, 49152
    s_nop 0
    buffer_load_dwordx4 v18, s[8:11], s77 offen lds
    s_add_u32 m0, s63, 50176
    s_nop 0
    buffer_load_dwordx4 v19, s[8:11], s77 offen lds
    s_add_u32 m0, s63, 51200
    s_nop 0
    buffer_load_dwordx4 v20, s[8:11], s77 offen lds
    s_add_u32 m0, s63, 52224
    s_nop 0
    buffer_load_dwordx4 v21, s[8:11], s77 offen lds
    s_add_u32 m0, s64, 65536
    s_nop 0
    buffer_load_dwordx4 v22, s[16:19], s49 offen lds
    s_add_u32 m0, s64, 66560
    s_nop 0
    buffer_load_dwordx4 v23, s[16:19], s49 offen lds
    s_add_u32 m0, s64, 67584
    s_nop 0
    buffer_load_dwordx4 v24, s[16:19], s49 offen lds
    s_add_u32 m0, s64, 68608
    s_nop 0
    buffer_load_dwordx4 v25, s[16:19], s49 offen lds
    s_add_u32 s60, s60, 128
    s_cmp_ge_u32 s60, s43
    s_cselect_b32 s69, 1280, 0
    s_sub_u32 s60, s60, s69
    s_add_u32 s77, s60, 40960
    s_add_u32 s61, s61, 196608
    s_cmp_ge_u32 s61, 1966080
    s_cselect_b32 s69, 1966080, 0
    s_sub_u32 s61, s61, s69
    s_add_u32 s49, s61, 49152
    s_waitcnt vmcnt(16) lgkmcnt(0)
    s_barrier
    s_add_u32 m0, s63, 90112
    s_nop 0
    buffer_load_dwordx4 v18, s[8:11], s60 offen lds
    s_add_u32 m0, s63, 91136
    s_nop 0
    buffer_load_dwordx4 v19, s[8:11], s60 offen lds
    s_add_u32 m0, s63, 92160
    s_nop 0
    buffer_load_dwordx4 v20, s[8:11], s60 offen lds
    s_add_u32 m0, s63, 93184
    s_nop 0
    buffer_load_dwordx4 v21, s[8:11], s60 offen lds
    s_add_u32 m0, s64, 106496
    s_nop 0
    buffer_load_dwordx4 v22, s[16:19], s61 offen lds
    s_add_u32 m0, s64, 107520
    s_nop 0
    buffer_load_dwordx4 v23, s[16:19], s61 offen lds
    s_add_u32 m0, s64, 108544
    s_nop 0
    buffer_load_dwordx4 v24, s[16:19], s61 offen lds
    s_add_u32 m0, s64, 109568
    s_nop 0
    buffer_load_dwordx4 v25, s[16:19], s61 offen lds
    s_add_u32 m0, s63, 94208
    s_nop 0
    buffer_load_dwordx4 v18, s[8:11], s77 offen lds
    s_add_u32 m0, s63, 95232
    s_nop 0
    buffer_load_dwordx4 v19, s[8:11], s77 offen lds
    s_add_u32 m0, s63, 96256
    s_nop 0
    buffer_load_dwordx4 v20, s[8:11], s77 offen lds
    s_add_u32 m0, s63, 97280
    s_nop 0
    buffer_load_dwordx4 v21, s[8:11], s77 offen lds
    s_add_u32 m0, s64, 110592
    s_nop 0
    buffer_load_dwordx4 v22, s[16:19], s49 offen lds
    s_add_u32 m0, s64, 111616
    s_nop 0
    buffer_load_dwordx4 v23, s[16:19], s49 offen lds
    s_add_u32 m0, s64, 112640
    s_nop 0
    buffer_load_dwordx4 v24, s[16:19], s49 offen lds
    s_add_u32 m0, s64, 113664
    s_nop 0
    buffer_load_dwordx4 v25, s[16:19], s49 offen lds
    s_add_u32 s60, s60, 128
    s_cmp_ge_u32 s60, s43
    s_cselect_b32 s69, 1280, 0
    s_sub_u32 s60, s60, s69
    s_add_u32 s77, s60, 40960
    s_add_u32 s61, s61, 196608
    s_cmp_ge_u32 s61, 1966080
    s_cselect_b32 s69, 1966080, 0
    s_sub_u32 s61, s61, s69
    s_add_u32 s49, s61, 49152
    s_waitcnt vmcnt(16) lgkmcnt(0)
    s_barrier
    s_add_u32 m0, s63, 0
    s_nop 0
    buffer_load_dwordx4 v18, s[8:11], s60 offen lds
    s_add_u32 m0, s63, 1024
    s_nop 0
    buffer_load_dwordx4 v19, s[8:11], s60 offen lds
    s_add_u32 m0, s63, 2048
    s_nop 0
    buffer_load_dwordx4 v20, s[8:11], s60 offen lds
    s_add_u32 m0, s63, 3072
    s_nop 0
    buffer_load_dwordx4 v21, s[8:11], s60 offen lds
    s_add_u32 m0, s64, 16384
    s_nop 0
    buffer_load_dwordx4 v22, s[16:19], s61 offen lds
    s_add_u32 m0, s64, 17408
    s_nop 0
    buffer_load_dwordx4 v23, s[16:19], s61 offen lds
    s_add_u32 m0, s64, 18432
    s_nop 0
    buffer_load_dwordx4 v24, s[16:19], s61 offen lds
    s_add_u32 m0, s64, 19456
    s_nop 0
    buffer_load_dwordx4 v25, s[16:19], s61 offen lds
    s_add_u32 m0, s63, 4096
    s_nop 0
    buffer_load_dwordx4 v18, s[8:11], s77 offen lds
    s_add_u32 m0, s63, 5120
    s_nop 0
    buffer_load_dwordx4 v19, s[8:11], s77 offen lds
    s_add_u32 m0, s63, 6144
    s_nop 0
    buffer_load_dwordx4 v20, s[8:11], s77 offen lds
    s_add_u32 m0, s63, 7168
    s_nop 0
    buffer_load_dwordx4 v21, s[8:11], s77 offen lds
    s_add_u32 m0, s64, 20480
    s_nop 0
    buffer_load_dwordx4 v22, s[16:19], s49 offen lds
    s_add_u32 m0, s64, 21504
    s_nop 0
    buffer_load_dwordx4 v23, s[16:19], s49 offen lds
    s_add_u32 m0, s64, 22528
    s_nop 0
    buffer_load_dwordx4 v24, s[16:19], s49 offen lds
    s_add_u32 m0, s64, 23552
    s_nop 0
    buffer_load_dwordx4 v25, s[16:19], s49 offen lds
    s_add_u32 s60, s60, 128
    s_cmp_ge_u32 s60, s43
    s_cselect_b32 s69, 1280, 0
    s_sub_u32 s60, s60, s69
    s_add_u32 s77, s60, 40960
    s_add_u32 s61, s61, 196608
    s_cmp_ge_u32 s61, 1966080
    s_cselect_b32 s69, 1966080, 0
    s_sub_u32 s61, s61, s69
    s_add_u32 s49, s61, 49152
    s_waitcnt vmcnt(16) lgkmcnt(0)
    s_barrier
    s_add_u32 m0, s63, 45056
    s_nop 0
    buffer_load_dwordx4 v18, s[8:11], s60 offen lds
    s_add_u32 m0, s63, 46080
    s_nop 0
    buffer_load_dwordx4 v19, s[8:11], s60 offen lds
    s_add_u32 m0, s63, 47104
    s_nop 0
    buffer_load_dwordx4 v20, s[8:11], s60 offen lds
    s_add_u32 m0, s63, 48128
    s_nop 0
    buffer_load_dwordx4 v21, s[8:11], s60 offen lds
    s_add_u32 m0, s56, 61440
    s_nop 0
    buffer_load_dwordx4 v26, s[16:19], s61 offen lds
    s_add_u32 m0, s56, 62464
    s_nop 0
    buffer_load_dwordx4 v27, s[16:19], s61 offen lds
    s_add_u32 m0, s75, 69632
    s_nop 0
    buffer_load_dwordx4 v28, s[12:15], s62 offen lds
    s_add_u32 m0, s75, 70656
    s_nop 0
    buffer_load_dwordx4 v29, s[12:15], s62 offen lds
    s_add_u32 m0, s75, 71680
    s_nop 0
    buffer_load_dwordx4 v30, s[12:15], s62 offen lds
    s_add_u32 m0, s63, 49152
    s_nop 0
    buffer_load_dwordx4 v18, s[8:11], s77 offen lds
    s_add_u32 m0, s63, 50176
    s_nop 0
    buffer_load_dwordx4 v19, s[8:11], s77 offen lds
    s_add_u32 m0, s63, 51200
    s_nop 0
    buffer_load_dwordx4 v20, s[8:11], s77 offen lds
    s_add_u32 m0, s63, 52224
    s_nop 0
    buffer_load_dwordx4 v21, s[8:11], s77 offen lds
    s_add_u32 m0, s56, 63488
    s_nop 0
    buffer_load_dwordx4 v26, s[16:19], s49 offen lds
    s_add_u32 m0, s56, 64512
    s_nop 0
    buffer_load_dwordx4 v27, s[16:19], s49 offen lds
    s_add_u32 m0, s75, 72704
    s_nop 0
    buffer_load_dwordx4 v28, s[12:15], s48 offen lds
    s_add_u32 m0, s75, 73728
    s_nop 0
    buffer_load_dwordx4 v29, s[12:15], s48 offen lds
    s_add_u32 m0, s75, 74752
    s_nop 0
    buffer_load_dwordx4 v30, s[12:15], s48 offen lds
    s_add_u32 s60, s60, 128
    s_cmp_ge_u32 s60, s43
    s_cselect_b32 s69, 1280, 0
    s_sub_u32 s60, s60, s69
    s_add_u32 s77, s60, 40960
    s_add_u32 s61, s61, 196608
    s_cmp_ge_u32 s61, 1966080
    s_cselect_b32 s69, 1966080, 0
    s_sub_u32 s61, s61, s69
    s_add_u32 s49, s61, 49152
    s_add_u32 s62, s62, 245760
    s_cmp_ge_u32 s62, 2457600
    s_cselect_b32 s69, 2457600, 0
    s_sub_u32 s62, s62, s69
    s_add_u32 s48, s62, 61440
    s_waitcnt vmcnt(18) lgkmcnt(0)
    s_barrier
    s_add_u32 m0, s63, 90112
    s_nop 0
    buffer_load_dwordx4 v18, s[8:11], s60 offen lds
    s_add_u32 m0, s63, 91136
    s_nop 0
    buffer_load_dwordx4 v19, s[8:11], s60 offen lds
    s_add_u32 m0, s63, 92160
    s_nop 0
    buffer_load_dwordx4 v20, s[8:11], s60 offen lds
    s_add_u32 m0, s63, 93184
    s_nop 0
    buffer_load_dwordx4 v21, s[8:11], s60 offen lds
    s_add_u32 m0, s56, 106496
    s_nop 0
    buffer_load_dwordx4 v26, s[16:19], s61 offen lds
    s_add_u32 m0, s56, 107520
    s_nop 0
    buffer_load_dwordx4 v27, s[16:19], s61 offen lds
    s_add_u32 m0, s75, 114688
    s_nop 0
    buffer_load_dwordx4 v28, s[12:15], s62 offen lds
    s_add_u32 m0, s75, 115712
    s_nop 0
    buffer_load_dwordx4 v29, s[12:15], s62 offen lds
    s_add_u32 m0, s75, 116736
    s_nop 0
    buffer_load_dwordx4 v30, s[12:15], s62 offen lds
    s_add_u32 m0, s63, 94208
    s_nop 0
    buffer_load_dwordx4 v18, s[8:11], s77 offen lds
    s_add_u32 m0, s63, 95232
    s_nop 0
    buffer_load_dwordx4 v19, s[8:11], s77 offen lds
    s_add_u32 m0, s63, 96256
    s_nop 0
    buffer_load_dwordx4 v20, s[8:11], s77 offen lds
    s_add_u32 m0, s63, 97280
    s_nop 0
    buffer_load_dwordx4 v21, s[8:11], s77 offen lds
    s_add_u32 m0, s56, 108544
    s_nop 0
    buffer_load_dwordx4 v26, s[16:19], s49 offen lds
    s_add_u32 m0, s56, 109568
    s_nop 0
    buffer_load_dwordx4 v27, s[16:19], s49 offen lds
    s_add_u32 m0, s75, 117760
    s_nop 0
    buffer_load_dwordx4 v28, s[12:15], s48 offen lds
    s_add_u32 m0, s75, 118784
    s_nop 0
    buffer_load_dwordx4 v29, s[12:15], s48 offen lds
    s_add_u32 m0, s75, 119808
    s_nop 0
    buffer_load_dwordx4 v30, s[12:15], s48 offen lds
    s_add_u32 s60, s60, 128
    s_cmp_ge_u32 s60, s43
    s_cselect_b32 s69, 1280, 0
    s_sub_u32 s60, s60, s69
    s_add_u32 s77, s60, 40960
    s_add_u32 s61, s61, 196608
    s_cmp_ge_u32 s61, 1966080
    s_cselect_b32 s69, 1966080, 0
    s_sub_u32 s61, s61, s69
    s_add_u32 s49, s61, 49152
    s_add_u32 s62, s62, 245760
    s_cmp_ge_u32 s62, 2457600
    s_cselect_b32 s69, 2457600, 0
    s_sub_u32 s62, s62, s69
    s_add_u32 s48, s62, 61440
    s_barrier
    s_add_u32 m0, s63, 0
    s_nop 0
    buffer_load_dwordx4 v18, s[8:11], s60 offen lds
    s_add_u32 m0, s63, 1024
    s_nop 0
    buffer_load_dwordx4 v19, s[8:11], s60 offen lds
    s_add_u32 m0, s63, 2048
    s_nop 0
    buffer_load_dwordx4 v20, s[8:11], s60 offen lds
    s_add_u32 m0, s63, 3072
    s_nop 0
    buffer_load_dwordx4 v21, s[8:11], s60 offen lds
    s_add_u32 m0, s56, 16384
    s_nop 0
    buffer_load_dwordx4 v26, s[16:19], s61 offen lds
    s_add_u32 m0, s56, 17408
    s_nop 0
    buffer_load_dwordx4 v27, s[16:19], s61 offen lds
    s_add_u32 m0, s75, 24576
    s_nop 0
    buffer_load_dwordx4 v28, s[12:15], s62 offen lds
    s_add_u32 m0, s75, 25600
    s_nop 0
    buffer_load_dwordx4 v29, s[12:15], s62 offen lds
    s_add_u32 m0, s75, 26624
    s_nop 0
    buffer_load_dwordx4 v30, s[12:15], s62 offen lds
    s_add_u32 m0, s63, 4096
    s_nop 0
    buffer_load_dwordx4 v18, s[8:11], s77 offen lds
    s_add_u32 m0, s63, 5120
    s_nop 0
    buffer_load_dwordx4 v19, s[8:11], s77 offen lds
    s_add_u32 m0, s63, 6144
    s_nop 0
    buffer_load_dwordx4 v20, s[8:11], s77 offen lds
    s_add_u32 m0, s63, 7168
    s_nop 0
    buffer_load_dwordx4 v21, s[8:11], s77 offen lds
    s_add_u32 m0, s56, 18432
    s_nop 0
    buffer_load_dwordx4 v26, s[16:19], s49 offen lds
    s_add_u32 m0, s56, 19456
    s_nop 0
    buffer_load_dwordx4 v27, s[16:19], s49 offen lds
    s_add_u32 m0, s75, 27648
    s_nop 0
    buffer_load_dwordx4 v28, s[12:15], s48 offen lds
    s_add_u32 m0, s75, 28672
    s_nop 0
    buffer_load_dwordx4 v29, s[12:15], s48 offen lds
    s_add_u32 m0, s75, 29696
    s_nop 0
    buffer_load_dwordx4 v30, s[12:15], s48 offen lds
    s_add_u32 s60, s60, 128
    s_cmp_ge_u32 s60, s43
    s_cselect_b32 s69, 1280, 0
    s_sub_u32 s60, s60, s69
    s_add_u32 s77, s60, 40960
    s_add_u32 s61, s61, 196608
    s_cmp_ge_u32 s61, 1966080
    s_cselect_b32 s69, 1966080, 0
    s_sub_u32 s61, s61, s69
    s_add_u32 s49, s61, 49152
    s_add_u32 s62, s62, 245760
    s_cmp_ge_u32 s62, 2457600
    s_cselect_b32 s69, 2457600, 0
    s_sub_u32 s62, s62, s69
    s_add_u32 s48, s62, 61440
    s_waitcnt vmcnt(36) lgkmcnt(0)
    s_barrier
    s_waitcnt vmcnt(18) lgkmcnt(0)
    s_barrier
    s_add_u32 m0, s63, 45056
    s_nop 0
    buffer_load_dwordx4 v18, s[8:11], s60 offen lds
    s_add_u32 m0, s63, 46080
    s_nop 0
    buffer_load_dwordx4 v19, s[8:11], s60 offen lds
    s_add_u32 m0, s63, 47104
    s_nop 0
    buffer_load_dwordx4 v20, s[8:11], s60 offen lds
    s_add_u32 m0, s63, 48128
    s_nop 0
    buffer_load_dwordx4 v21, s[8:11], s60 offen lds
    s_add_u32 m0, s56, 61440
    s_nop 0
    buffer_load_dwordx4 v26, s[16:19], s61 offen lds
    s_add_u32 m0, s56, 62464
    s_nop 0
    buffer_load_dwordx4 v27, s[16:19], s61 offen lds
    s_add_u32 m0, s75, 69632
    s_nop 0
    buffer_load_dwordx4 v28, s[12:15], s62 offen lds
    s_add_u32 m0, s75, 70656
    s_nop 0
    buffer_load_dwordx4 v29, s[12:15], s62 offen lds
    s_add_u32 m0, s75, 71680
    s_nop 0
    buffer_load_dwordx4 v30, s[12:15], s62 offen lds
    s_add_u32 m0, s63, 49152
    s_nop 0
    buffer_load_dwordx4 v18, s[8:11], s77 offen lds
    s_add_u32 m0, s63, 50176
    s_nop 0
    buffer_load_dwordx4 v19, s[8:11], s77 offen lds
    s_add_u32 m0, s63, 51200
    s_nop 0
    buffer_load_dwordx4 v20, s[8:11], s77 offen lds
    s_add_u32 m0, s63, 52224
    s_nop 0
    buffer_load_dwordx4 v21, s[8:11], s77 offen lds
    s_add_u32 m0, s56, 63488
    s_nop 0
    buffer_load_dwordx4 v26, s[16:19], s49 offen lds
    s_add_u32 m0, s56, 64512
    s_nop 0
    buffer_load_dwordx4 v27, s[16:19], s49 offen lds
    s_add_u32 m0, s75, 72704
    s_nop 0
    buffer_load_dwordx4 v28, s[12:15], s48 offen lds
    s_add_u32 m0, s75, 73728
    s_nop 0
    buffer_load_dwordx4 v29, s[12:15], s48 offen lds
    s_add_u32 m0, s75, 74752
    s_nop 0
    buffer_load_dwordx4 v30, s[12:15], s48 offen lds
    s_add_u32 s60, s60, 128
    s_cmp_ge_u32 s60, s43
    s_cselect_b32 s69, 1280, 0
    s_sub_u32 s60, s60, s69
    s_add_u32 s77, s60, 40960
    s_add_u32 s61, s61, 196608
    s_cmp_ge_u32 s61, 1966080
    s_cselect_b32 s69, 1966080, 0
    s_sub_u32 s61, s61, s69
    s_add_u32 s49, s61, 49152
    s_add_u32 s62, s62, 245760
    s_cmp_ge_u32 s62, 2457600
    s_cselect_b32 s69, 2457600, 0
    s_sub_u32 s62, s62, s69
    s_add_u32 s48, s62, 61440
    s_waitcnt vmcnt(18) lgkmcnt(0)
    s_barrier
    s_add_u32 m0, s63, 90112
    s_nop 0
    buffer_load_dwordx4 v18, s[8:11], s60 offen lds
    s_add_u32 m0, s63, 91136
    s_nop 0
    buffer_load_dwordx4 v19, s[8:11], s60 offen lds
    s_add_u32 m0, s63, 92160
    s_nop 0
    buffer_load_dwordx4 v20, s[8:11], s60 offen lds
    s_add_u32 m0, s63, 93184
    s_nop 0
    buffer_load_dwordx4 v21, s[8:11], s60 offen lds
    s_add_u32 m0, s56, 106496
    s_nop 0
    buffer_load_dwordx4 v26, s[16:19], s61 offen lds
    s_add_u32 m0, s56, 107520
    s_nop 0
    buffer_load_dwordx4 v27, s[16:19], s61 offen lds
    s_add_u32 m0, s75, 114688
    s_nop 0
    buffer_load_dwordx4 v28, s[12:15], s62 offen lds
    s_add_u32 m0, s75, 115712
    s_nop 0
    buffer_load_dwordx4 v29, s[12:15], s62 offen lds
    s_add_u32 m0, s75, 116736
    s_nop 0
    buffer_load_dwordx4 v30, s[12:15], s62 offen lds
    s_add_u32 m0, s63, 94208
    s_nop 0
    buffer_load_dwordx4 v18, s[8:11], s77 offen lds
    s_add_u32 m0, s63, 95232
    s_nop 0
    buffer_load_dwordx4 v19, s[8:11], s77 offen lds
    s_add_u32 m0, s63, 96256
    s_nop 0
    buffer_load_dwordx4 v20, s[8:11], s77 offen lds
    s_add_u32 m0, s63, 97280
    s_nop 0
    buffer_load_dwordx4 v21, s[8:11], s77 offen lds
    s_add_u32 m0, s56, 108544
    s_nop 0
    buffer_load_dwordx4 v26, s[16:19], s49 offen lds
    s_add_u32 m0, s56, 109568
    s_nop 0
    buffer_load_dwordx4 v27, s[16:19], s49 offen lds
    s_add_u32 m0, s75, 117760
    s_nop 0
    buffer_load_dwordx4 v28, s[12:15], s48 offen lds
    s_add_u32 m0, s75, 118784
    s_nop 0
    buffer_load_dwordx4 v29, s[12:15], s48 offen lds
    s_add_u32 m0, s75, 119808
    s_nop 0
    buffer_load_dwordx4 v30, s[12:15], s48 offen lds
    s_add_u32 s60, s60, 128
    s_cmp_ge_u32 s60, s43
    s_cselect_b32 s69, 1280, 0
    s_sub_u32 s60, s60, s69
    s_add_u32 s77, s60, 40960
    s_add_u32 s61, s61, 196608
    s_cmp_ge_u32 s61, 1966080
    s_cselect_b32 s69, 1966080, 0
    s_sub_u32 s61, s61, s69
    s_add_u32 s49, s61, 49152
    s_add_u32 s62, s62, 245760
    s_cmp_ge_u32 s62, 2457600
    s_cselect_b32 s69, 2457600, 0
    s_sub_u32 s62, s62, s69
    s_add_u32 s48, s62, 61440
    s_waitcnt vmcnt(18) lgkmcnt(0)
    s_barrier
    s_add_u32 m0, s63, 0
    s_nop 0
    buffer_load_dwordx4 v18, s[8:11], s60 offen lds
    s_add_u32 m0, s63, 1024
    s_nop 0
    buffer_load_dwordx4 v19, s[8:11], s60 offen lds
    s_add_u32 m0, s63, 2048
    s_nop 0
    buffer_load_dwordx4 v20, s[8:11], s60 offen lds
    s_add_u32 m0, s63, 3072
    s_nop 0
    buffer_load_dwordx4 v21, s[8:11], s60 offen lds
    s_add_u32 m0, s56, 16384
    s_nop 0
    buffer_load_dwordx4 v26, s[16:19], s61 offen lds
    s_add_u32 m0, s56, 17408
    s_nop 0
    buffer_load_dwordx4 v27, s[16:19], s61 offen lds
    s_add_u32 m0, s75, 24576
    s_nop 0
    buffer_load_dwordx4 v28, s[12:15], s62 offen lds
    s_add_u32 m0, s75, 25600
    s_nop 0
    buffer_load_dwordx4 v29, s[12:15], s62 offen lds
    s_add_u32 m0, s75, 26624
    s_nop 0
    buffer_load_dwordx4 v30, s[12:15], s62 offen lds
    s_add_u32 m0, s63, 4096
    s_nop 0
    buffer_load_dwordx4 v18, s[8:11], s77 offen lds
    s_add_u32 m0, s63, 5120
    s_nop 0
    buffer_load_dwordx4 v19, s[8:11], s77 offen lds
    s_add_u32 m0, s63, 6144
    s_nop 0
    buffer_load_dwordx4 v20, s[8:11], s77 offen lds
    s_add_u32 m0, s63, 7168
    s_nop 0
    buffer_load_dwordx4 v21, s[8:11], s77 offen lds
    s_add_u32 m0, s56, 18432
    s_nop 0
    buffer_load_dwordx4 v26, s[16:19], s49 offen lds
    s_add_u32 m0, s56, 19456
    s_nop 0
    buffer_load_dwordx4 v27, s[16:19], s49 offen lds
    s_add_u32 m0, s75, 27648
    s_nop 0
    buffer_load_dwordx4 v28, s[12:15], s48 offen lds
    s_add_u32 m0, s75, 28672
    s_nop 0
    buffer_load_dwordx4 v29, s[12:15], s48 offen lds
    s_add_u32 m0, s75, 29696
    s_nop 0
    buffer_load_dwordx4 v30, s[12:15], s48 offen lds
    s_add_u32 s60, s60, 128
    s_cmp_ge_u32 s60, s43
    s_cselect_b32 s69, 1280, 0
    s_sub_u32 s60, s60, s69
    s_add_u32 s77, s60, 40960
    s_add_u32 s61, s61, 196608
    s_cmp_ge_u32 s61, 1966080
    s_cselect_b32 s69, 1966080, 0
    s_sub_u32 s61, s61, s69
    s_add_u32 s49, s61, 49152
    s_add_u32 s62, s62, 245760
    s_cmp_ge_u32 s62, 2457600
    s_cselect_b32 s69, 2457600, 0
    s_sub_u32 s62, s62, s69
    s_add_u32 s48, s62, 61440
    s_waitcnt vmcnt(18) lgkmcnt(0)
    s_barrier
    s_add_u32 m0, s63, 45056
    s_nop 0
    buffer_load_dwordx4 v18, s[8:11], s60 offen lds
    s_add_u32 m0, s63, 46080
    s_nop 0
    buffer_load_dwordx4 v19, s[8:11], s60 offen lds
    s_add_u32 m0, s63, 47104
    s_nop 0
    buffer_load_dwordx4 v20, s[8:11], s60 offen lds
    s_add_u32 m0, s63, 48128
    s_nop 0
    buffer_load_dwordx4 v21, s[8:11], s60 offen lds
    s_add_u32 m0, s56, 61440
    s_nop 0
    buffer_load_dwordx4 v26, s[16:19], s61 offen lds
    s_add_u32 m0, s56, 62464
    s_nop 0
    buffer_load_dwordx4 v27, s[16:19], s61 offen lds
    s_add_u32 m0, s75, 69632
    s_nop 0
    buffer_load_dwordx4 v28, s[12:15], s62 offen lds
    s_add_u32 m0, s75, 70656
    s_nop 0
    buffer_load_dwordx4 v29, s[12:15], s62 offen lds
    s_add_u32 m0, s75, 71680
    s_nop 0
    buffer_load_dwordx4 v30, s[12:15], s62 offen lds
    s_add_u32 m0, s63, 49152
    s_nop 0
    buffer_load_dwordx4 v18, s[8:11], s77 offen lds
    s_add_u32 m0, s63, 50176
    s_nop 0
    buffer_load_dwordx4 v19, s[8:11], s77 offen lds
    s_add_u32 m0, s63, 51200
    s_nop 0
    buffer_load_dwordx4 v20, s[8:11], s77 offen lds
    s_add_u32 m0, s63, 52224
    s_nop 0
    buffer_load_dwordx4 v21, s[8:11], s77 offen lds
    s_add_u32 m0, s56, 63488
    s_nop 0
    buffer_load_dwordx4 v26, s[16:19], s49 offen lds
    s_add_u32 m0, s56, 64512
    s_nop 0
    buffer_load_dwordx4 v27, s[16:19], s49 offen lds
    s_add_u32 m0, s75, 72704
    s_nop 0
    buffer_load_dwordx4 v28, s[12:15], s48 offen lds
    s_add_u32 m0, s75, 73728
    s_nop 0
    buffer_load_dwordx4 v29, s[12:15], s48 offen lds
    s_add_u32 m0, s75, 74752
    s_nop 0
    buffer_load_dwordx4 v30, s[12:15], s48 offen lds
    s_add_u32 s60, s60, 128
    s_cmp_ge_u32 s60, s43
    s_cselect_b32 s69, 1280, 0
    s_sub_u32 s60, s60, s69
    s_add_u32 s77, s60, 40960
    s_add_u32 s61, s61, 196608
    s_cmp_ge_u32 s61, 1966080
    s_cselect_b32 s69, 1966080, 0
    s_sub_u32 s61, s61, s69
    s_add_u32 s49, s61, 49152
    s_add_u32 s62, s62, 245760
    s_cmp_ge_u32 s62, 2457600
    s_cselect_b32 s69, 2457600, 0
    s_sub_u32 s62, s62, s69
    s_add_u32 s48, s62, 61440
    s_waitcnt vmcnt(18) lgkmcnt(0)
    s_barrier
    s_add_u32 m0, s63, 90112
    s_nop 0
    buffer_load_dwordx4 v18, s[8:11], s60 offen lds
    s_add_u32 m0, s63, 91136
    s_nop 0
    buffer_load_dwordx4 v19, s[8:11], s60 offen lds
    s_add_u32 m0, s63, 92160
    s_nop 0
    buffer_load_dwordx4 v20, s[8:11], s60 offen lds
    s_add_u32 m0, s63, 93184
    s_nop 0
    buffer_load_dwordx4 v21, s[8:11], s60 offen lds
    s_add_u32 m0, s56, 106496
    s_nop 0
    buffer_load_dwordx4 v26, s[16:19], s61 offen lds
    s_add_u32 m0, s56, 107520
    s_nop 0
    buffer_load_dwordx4 v27, s[16:19], s61 offen lds
    s_add_u32 m0, s75, 114688
    s_nop 0
    buffer_load_dwordx4 v28, s[12:15], s62 offen lds
    s_add_u32 m0, s75, 115712
    s_nop 0
    buffer_load_dwordx4 v29, s[12:15], s62 offen lds
    s_add_u32 m0, s75, 116736
    s_nop 0
    buffer_load_dwordx4 v30, s[12:15], s62 offen lds
    s_add_u32 m0, s63, 94208
    s_nop 0
    buffer_load_dwordx4 v18, s[8:11], s77 offen lds
    s_add_u32 m0, s63, 95232
    s_nop 0
    buffer_load_dwordx4 v19, s[8:11], s77 offen lds
    s_add_u32 m0, s63, 96256
    s_nop 0
    buffer_load_dwordx4 v20, s[8:11], s77 offen lds
    s_add_u32 m0, s63, 97280
    s_nop 0
    buffer_load_dwordx4 v21, s[8:11], s77 offen lds
    s_add_u32 m0, s56, 108544
    s_nop 0
    buffer_load_dwordx4 v26, s[16:19], s49 offen lds
    s_add_u32 m0, s56, 109568
    s_nop 0
    buffer_load_dwordx4 v27, s[16:19], s49 offen lds
    s_add_u32 m0, s75, 117760
    s_nop 0
    buffer_load_dwordx4 v28, s[12:15], s48 offen lds
    s_add_u32 m0, s75, 118784
    s_nop 0
    buffer_load_dwordx4 v29, s[12:15], s48 offen lds
    s_add_u32 m0, s75, 119808
    s_nop 0
    buffer_load_dwordx4 v30, s[12:15], s48 offen lds
    s_add_u32 s60, s60, 128
    s_cmp_ge_u32 s60, s43
    s_cselect_b32 s69, 1280, 0
    s_sub_u32 s60, s60, s69
    s_add_u32 s77, s60, 40960
    s_add_u32 s61, s61, 196608
    s_cmp_ge_u32 s61, 1966080
    s_cselect_b32 s69, 1966080, 0
    s_sub_u32 s61, s61, s69
    s_add_u32 s49, s61, 49152
    s_add_u32 s62, s62, 245760
    s_cmp_ge_u32 s62, 2457600
    s_cselect_b32 s69, 2457600, 0
    s_sub_u32 s62, s62, s69
    s_add_u32 s48, s62, 61440
    s_waitcnt vmcnt(18) lgkmcnt(0)
    s_barrier
    s_add_u32 m0, s63, 0
    s_nop 0
    buffer_load_dwordx4 v18, s[8:11], s60 offen lds
    s_add_u32 m0, s63, 1024
    s_nop 0
    buffer_load_dwordx4 v19, s[8:11], s60 offen lds
    s_add_u32 m0, s63, 2048
    s_nop 0
    buffer_load_dwordx4 v20, s[8:11], s60 offen lds
    s_add_u32 m0, s63, 3072
    s_nop 0
    buffer_load_dwordx4 v21, s[8:11], s60 offen lds
    s_add_u32 m0, s56, 16384
    s_nop 0
    buffer_load_dwordx4 v26, s[16:19], s61 offen lds
    s_add_u32 m0, s56, 17408
    s_nop 0
    buffer_load_dwordx4 v27, s[16:19], s61 offen lds
    s_add_u32 m0, s75, 24576
    s_nop 0
    buffer_load_dwordx4 v28, s[12:15], s62 offen lds
    s_add_u32 m0, s75, 25600
    s_nop 0
    buffer_load_dwordx4 v29, s[12:15], s62 offen lds
    s_add_u32 m0, s75, 26624
    s_nop 0
    buffer_load_dwordx4 v30, s[12:15], s62 offen lds
    s_add_u32 m0, s63, 4096
    s_nop 0
    buffer_load_dwordx4 v18, s[8:11], s77 offen lds
    s_add_u32 m0, s63, 5120
    s_nop 0
    buffer_load_dwordx4 v19, s[8:11], s77 offen lds
    s_add_u32 m0, s63, 6144
    s_nop 0
    buffer_load_dwordx4 v20, s[8:11], s77 offen lds
    s_add_u32 m0, s63, 7168
    s_nop 0
    buffer_load_dwordx4 v21, s[8:11], s77 offen lds
    s_add_u32 m0, s56, 18432
    s_nop 0
    buffer_load_dwordx4 v26, s[16:19], s49 offen lds
    s_add_u32 m0, s56, 19456
    s_nop 0
    buffer_load_dwordx4 v27, s[16:19], s49 offen lds
    s_add_u32 m0, s75, 27648
    s_nop 0
    buffer_load_dwordx4 v28, s[12:15], s48 offen lds
    s_add_u32 m0, s75, 28672
    s_nop 0
    buffer_load_dwordx4 v29, s[12:15], s48 offen lds
    s_add_u32 m0, s75, 29696
    s_nop 0
    buffer_load_dwordx4 v30, s[12:15], s48 offen lds
    s_add_u32 s60, s60, 128
    s_cmp_ge_u32 s60, s43
    s_cselect_b32 s69, 1280, 0
    s_sub_u32 s60, s60, s69
    s_add_u32 s77, s60, 40960
    s_add_u32 s61, s61, 196608
    s_cmp_ge_u32 s61, 1966080
    s_cselect_b32 s69, 1966080, 0
    s_sub_u32 s61, s61, s69
    s_add_u32 s49, s61, 49152
    s_add_u32 s62, s62, 245760
    s_cmp_ge_u32 s62, 2457600
    s_cselect_b32 s69, 2457600, 0
    s_sub_u32 s62, s62, s69
    s_add_u32 s48, s62, 61440
    s_waitcnt vmcnt(18) lgkmcnt(0)
    s_barrier
    s_add_u32 m0, s63, 45056
    s_nop 0
    buffer_load_dwordx4 v18, s[8:11], s60 offen lds
    s_add_u32 m0, s63, 46080
    s_nop 0
    buffer_load_dwordx4 v19, s[8:11], s60 offen lds
    s_add_u32 m0, s63, 47104
    s_nop 0
    buffer_load_dwordx4 v20, s[8:11], s60 offen lds
    s_add_u32 m0, s63, 48128
    s_nop 0
    buffer_load_dwordx4 v21, s[8:11], s60 offen lds
    s_add_u32 m0, s56, 61440
    s_nop 0
    buffer_load_dwordx4 v26, s[16:19], s61 offen lds
    s_add_u32 m0, s56, 62464
    s_nop 0
    buffer_load_dwordx4 v27, s[16:19], s61 offen lds
    s_add_u32 m0, s75, 69632
    s_nop 0
    buffer_load_dwordx4 v28, s[12:15], s62 offen lds
    s_add_u32 m0, s75, 70656
    s_nop 0
    buffer_load_dwordx4 v29, s[12:15], s62 offen lds
    s_add_u32 m0, s75, 71680
    s_nop 0
    buffer_load_dwordx4 v30, s[12:15], s62 offen lds
    s_add_u32 m0, s63, 49152
    s_nop 0
    buffer_load_dwordx4 v18, s[8:11], s77 offen lds
    s_add_u32 m0, s63, 50176
    s_nop 0
    buffer_load_dwordx4 v19, s[8:11], s77 offen lds
    s_add_u32 m0, s63, 51200
    s_nop 0
    buffer_load_dwordx4 v20, s[8:11], s77 offen lds
    s_add_u32 m0, s63, 52224
    s_nop 0
    buffer_load_dwordx4 v21, s[8:11], s77 offen lds
    s_add_u32 m0, s56, 63488
    s_nop 0
    buffer_load_dwordx4 v26, s[16:19], s49 offen lds
    s_add_u32 m0, s56, 64512
    s_nop 0
    buffer_load_dwordx4 v27, s[16:19], s49 offen lds
    s_add_u32 m0, s75, 72704
    s_nop 0
    buffer_load_dwordx4 v28, s[12:15], s48 offen lds
    s_add_u32 m0, s75, 73728
    s_nop 0
    buffer_load_dwordx4 v29, s[12:15], s48 offen lds
    s_add_u32 m0, s75, 74752
    s_nop 0
    buffer_load_dwordx4 v30, s[12:15], s48 offen lds
    s_add_u32 s60, s60, 128
    s_cmp_ge_u32 s60, s43
    s_cselect_b32 s69, 1280, 0
    s_sub_u32 s60, s60, s69
    s_add_u32 s77, s60, 40960
    s_add_u32 s61, s61, 196608
    s_cmp_ge_u32 s61, 1966080
    s_cselect_b32 s69, 1966080, 0
    s_sub_u32 s61, s61, s69
    s_add_u32 s49, s61, 49152
    s_add_u32 s62, s62, 245760
    s_cmp_ge_u32 s62, 2457600
    s_cselect_b32 s69, 2457600, 0
    s_sub_u32 s62, s62, s69
    s_add_u32 s48, s62, 61440
    s_waitcnt vmcnt(18) lgkmcnt(0)
    s_barrier
    s_lshl_b32 s91, s47, 14
    s_add_u32 s91, s91, s76
    s_add_u32 m0, s57, 90112
    s_nop 0
    buffer_load_dwordx4 v5, s[20:23], s91 offen offset:0 sc1 lds
    buffer_load_dwordx4 v5, s[20:23], s91 offen offset:1024 sc1 lds
    buffer_load_dwordx4 v5, s[20:23], s91 offen offset:2048 sc1 lds
    buffer_load_dwordx4 v5, s[20:23], s91 offen offset:3072 sc1 lds
    s_add_u32 m0, s57, 98304
    s_nop 0
    buffer_load_dwordx4 v6, s[20:23], s91 offen offset:0 sc1 lds
    buffer_load_dwordx4 v6, s[20:23], s91 offen offset:1024 sc1 lds
    buffer_load_dwordx4 v6, s[20:23], s91 offen offset:2048 sc1 lds
    buffer_load_dwordx4 v6, s[20:23], s91 offen offset:3072 sc1 lds
    s_add_u32 s47, s47, 1
    s_mul_i32 s92, s50, 40960
    s_add_u32 s92, s92, s79
    s_add_u32 m0, s57, 94208
    s_nop 0
    buffer_load_dwordx4 v5, s[20:23], s92 offen offset:0 sc1 lds
    buffer_load_dwordx4 v5, s[20:23], s92 offen offset:1024 sc1 lds
    buffer_load_dwordx4 v5, s[20:23], s92 offen offset:2048 sc1 lds
    buffer_load_dwordx4 v5, s[20:23], s92 offen offset:3072 sc1 lds
    s_add_u32 s92, s92, 10240
    s_add_u32 m0, s57, 102400
    s_nop 0
    buffer_load_dwordx4 v5, s[20:23], s92 offen offset:0 sc1 lds
    buffer_load_dwordx4 v5, s[20:23], s92 offen offset:1024 sc1 lds
    buffer_load_dwordx4 v5, s[20:23], s92 offen offset:2048 sc1 lds
    buffer_load_dwordx4 v5, s[20:23], s92 offen offset:3072 sc1 lds
    s_add_u32 s50, s50, 1
    s_waitcnt vmcnt(16) lgkmcnt(0)
    s_barrier
    s_lshl_b32 s91, s47, 14
    s_add_u32 s91, s91, s76
    s_add_u32 m0, s57, 0
    s_nop 0
    buffer_load_dwordx4 v5, s[20:23], s91 offen offset:0 sc1 lds
    buffer_load_dwordx4 v5, s[20:23], s91 offen offset:1024 sc1 lds
    buffer_load_dwordx4 v5, s[20:23], s91 offen offset:2048 sc1 lds
    buffer_load_dwordx4 v5, s[20:23], s91 offen offset:3072 sc1 lds
    s_add_u32 m0, s57, 8192
    s_nop 0
    buffer_load_dwordx4 v6, s[20:23], s91 offen offset:0 sc1 lds
    buffer_load_dwordx4 v6, s[20:23], s91 offen offset:1024 sc1 lds
    buffer_load_dwordx4 v6, s[20:23], s91 offen offset:2048 sc1 lds
    buffer_load_dwordx4 v6, s[20:23], s91 offen offset:3072 sc1 lds
    s_add_u32 s47, s47, 1
    s_barrier
    s_mul_i32 s92, s50, 40960
    s_add_u32 s92, s92, s79
    s_add_u32 m0, s57, 4096
    s_nop 0
    buffer_load_dwordx4 v5, s[20:23], s92 offen offset:0 sc1 lds
    buffer_load_dwordx4 v5, s[20:23], s92 offen offset:1024 sc1 lds
    buffer_load_dwordx4 v5, s[20:23], s92 offen offset:2048 sc1 lds
    buffer_load_dwordx4 v5, s[20:23], s92 offen offset:3072 sc1 lds
    s_add_u32 s92, s92, 10240
    s_add_u32 m0, s57, 12288
    s_nop 0
    buffer_load_dwordx4 v5, s[20:23], s92 offen offset:0 sc1 lds
    buffer_load_dwordx4 v5, s[20:23], s92 offen offset:1024 sc1 lds
    buffer_load_dwordx4 v5, s[20:23], s92 offen offset:2048 sc1 lds
    buffer_load_dwordx4 v5, s[20:23], s92 offen offset:3072 sc1 lds
    s_add_u32 s50, s50, 1
    s_lshl_b32 s91, s47, 14
    s_add_u32 s91, s91, s76
    s_add_u32 m0, s57, 45056
    s_nop 0
    buffer_load_dwordx4 v5, s[20:23], s91 offen offset:0 sc1 lds
    buffer_load_dwordx4 v5, s[20:23], s91 offen offset:1024 sc1 lds
    buffer_load_dwordx4 v5, s[20:23], s91 offen offset:2048 sc1 lds
    buffer_load_dwordx4 v5, s[20:23], s91 offen offset:3072 sc1 lds
    s_add_u32 m0, s57, 53248
    s_nop 0
    buffer_load_dwordx4 v6, s[20:23], s91 offen offset:0 sc1 lds
    buffer_load_dwordx4 v6, s[20:23], s91 offen offset:1024 sc1 lds
    buffer_load_dwordx4 v6, s[20:23], s91 offen offset:2048 sc1 lds
    buffer_load_dwordx4 v6, s[20:23], s91 offen offset:3072 sc1 lds
    s_add_u32 s47, s47, 1
    s_mul_i32 s92, s50, 40960
    s_add_u32 s92, s92, s79
    s_add_u32 m0, s57, 49152
    s_nop 0
    buffer_load_dwordx4 v5, s[20:23], s92 offen offset:0 sc1 lds
    buffer_load_dwordx4 v5, s[20:23], s92 offen offset:1024 sc1 lds
    buffer_load_dwordx4 v5, s[20:23], s92 offen offset:2048 sc1 lds
    buffer_load_dwordx4 v5, s[20:23], s92 offen offset:3072 sc1 lds
    s_add_u32 s92, s92, 10240
    s_add_u32 m0, s57, 57344
    s_nop 0
    buffer_load_dwordx4 v5, s[20:23], s92 offen offset:0 sc1 lds
    buffer_load_dwordx4 v5, s[20:23], s92 offen offset:1024 sc1 lds
    buffer_load_dwordx4 v5, s[20:23], s92 offen offset:2048 sc1 lds
    buffer_load_dwordx4 v5, s[20:23], s92 offen offset:3072 sc1 lds
    s_add_u32 s50, s50, 1
    s_waitcnt vmcnt(32)
    s_barrier
    s_waitcnt vmcnt(16)
    s_barrier
    s_lshl_b32 s91, s47, 14
    s_add_u32 s91, s91, s76
    s_add_u32 m0, s57, 90112
    s_nop 0
    buffer_load_dwordx4 v5, s[20:23], s91 offen offset:0 sc1 lds
    buffer_load_dwordx4 v5, s[20:23], s91 offen offset:1024 sc1 lds
    buffer_load_dwordx4 v5, s[20:23], s91 offen offset:2048 sc1 lds
    buffer_load_dwordx4 v5, s[20:23], s91 offen offset:3072 sc1 lds
    s_add_u32 m0, s57, 98304
    s_nop 0
    buffer_load_dwordx4 v6, s[20:23], s91 offen offset:0 sc1 lds
    buffer_load_dwordx4 v6, s[20:23], s91 offen offset:1024 sc1 lds
    buffer_load_dwordx4 v6, s[20:23], s91 offen offset:2048 sc1 lds
    buffer_load_dwordx4 v6, s[20:23], s91 offen offset:3072 sc1 lds
    s_add_u32 s47, s47, 1
    s_mul_i32 s92, s50, 40960
    s_add_u32 s92, s92, s79
    s_add_u32 m0, s57, 94208
    s_nop 0
    buffer_load_dwordx4 v5, s[20:23], s92 offen offset:0 sc1 lds
    buffer_load_dwordx4 v5, s[20:23], s92 offen offset:1024 sc1 lds
    buffer_load_dwordx4 v5, s[20:23], s92 offen offset:2048 sc1 lds
    buffer_load_dwordx4 v5, s[20:23], s92 offen offset:3072 sc1 lds
    s_add_u32 s92, s92, 10240
    s_add_u32 m0, s57, 102400
    s_nop 0
    buffer_load_dwordx4 v5, s[20:23], s92 offen offset:0 sc1 lds
    buffer_load_dwordx4 v5, s[20:23], s92 offen offset:1024 sc1 lds
    buffer_load_dwordx4 v5, s[20:23], s92 offen offset:2048 sc1 lds
    buffer_load_dwordx4 v5, s[20:23], s92 offen offset:3072 sc1 lds
    s_add_u32 s50, s50, 1
    s_waitcnt vmcnt(16)
    s_barrier
    s_lshl_b32 s91, s47, 14
    s_add_u32 s91, s91, s76
    s_add_u32 m0, s57, 0
    s_nop 0
    buffer_load_dwordx4 v5, s[20:23], s91 offen offset:0 sc1 lds
    buffer_load_dwordx4 v5, s[20:23], s91 offen offset:1024 sc1 lds
    buffer_load_dwordx4 v5, s[20:23], s91 offen offset:2048 sc1 lds
    buffer_load_dwordx4 v5, s[20:23], s91 offen offset:3072 sc1 lds
    s_add_u32 m0, s57, 8192
    s_nop 0
    buffer_load_dwordx4 v6, s[20:23], s91 offen offset:0 sc1 lds
    buffer_load_dwordx4 v6, s[20:23], s91 offen offset:1024 sc1 lds
    buffer_load_dwordx4 v6, s[20:23], s91 offen offset:2048 sc1 lds
    buffer_load_dwordx4 v6, s[20:23], s91 offen offset:3072 sc1 lds
    s_add_u32 s47, s47, 1
    s_mul_i32 s92, s50, 40960
    s_add_u32 s92, s92, s79
    s_add_u32 m0, s57, 4096
    s_nop 0
    buffer_load_dwordx4 v5, s[20:23], s92 offen offset:0 sc1 lds
    buffer_load_dwordx4 v5, s[20:23], s92 offen offset:1024 sc1 lds
    buffer_load_dwordx4 v5, s[20:23], s92 offen offset:2048 sc1 lds
    buffer_load_dwordx4 v5, s[20:23], s92 offen offset:3072 sc1 lds
    s_add_u32 s92, s92, 10240
    s_add_u32 m0, s57, 12288
    s_nop 0
    buffer_load_dwordx4 v5, s[20:23], s92 offen offset:0 sc1 lds
    buffer_load_dwordx4 v5, s[20:23], s92 offen offset:1024 sc1 lds
    buffer_load_dwordx4 v5, s[20:23], s92 offen offset:2048 sc1 lds
    buffer_load_dwordx4 v5, s[20:23], s92 offen offset:3072 sc1 lds
    s_add_u32 s50, s50, 1
    s_waitcnt vmcnt(16)
    s_barrier
    s_lshl_b32 s91, s47, 14
    s_add_u32 s91, s91, s76
    s_add_u32 m0, s57, 45056
    s_nop 0
    buffer_load_dwordx4 v5, s[20:23], s91 offen offset:0 sc1 lds
    buffer_load_dwordx4 v5, s[20:23], s91 offen offset:1024 sc1 lds
    buffer_load_dwordx4 v5, s[20:23], s91 offen offset:2048 sc1 lds
    buffer_load_dwordx4 v5, s[20:23], s91 offen offset:3072 sc1 lds
    s_add_u32 m0, s57, 53248
    s_nop 0
    buffer_load_dwordx4 v6, s[20:23], s91 offen offset:0 sc1 lds
    buffer_load_dwordx4 v6, s[20:23], s91 offen offset:1024 sc1 lds
    buffer_load_dwordx4 v6, s[20:23], s91 offen offset:2048 sc1 lds
    buffer_load_dwordx4 v6, s[20:23], s91 offen offset:3072 sc1 lds
    s_add_u32 s47, s47, 1
    s_mul_i32 s92, s50, 40960
    s_add_u32 s92, s92, s79
    s_add_u32 m0, s57, 49152
    s_nop 0
    buffer_load_dwordx4 v5, s[20:23], s92 offen offset:0 sc1 lds
    buffer_load_dwordx4 v5, s[20:23], s92 offen offset:1024 sc1 lds
    buffer_load_dwordx4 v5, s[20:23], s92 offen offset:2048 sc1 lds
    buffer_load_dwordx4 v5, s[20:23], s92 offen offset:3072 sc1 lds
    s_add_u32 s92, s92, 10240
    s_add_u32 m0, s57, 57344
    s_nop 0
    buffer_load_dwordx4 v5, s[20:23], s92 offen offset:0 sc1 lds
    buffer_load_dwordx4 v5, s[20:23], s92 offen offset:1024 sc1 lds
    buffer_load_dwordx4 v5, s[20:23], s92 offen offset:2048 sc1 lds
    buffer_load_dwordx4 v5, s[20:23], s92 offen offset:3072 sc1 lds
    s_add_u32 s50, s50, 1
    s_waitcnt vmcnt(16)
    s_barrier
    s_lshl_b32 s91, s47, 14
    s_add_u32 s91, s91, s76
    s_add_u32 m0, s57, 90112
    s_nop 0
    buffer_load_dwordx4 v5, s[20:23], s91 offen offset:0 sc1 lds
    buffer_load_dwordx4 v5, s[20:23], s91 offen offset:1024 sc1 lds
    buffer_load_dwordx4 v5, s[20:23], s91 offen offset:2048 sc1 lds
    buffer_load_dwordx4 v5, s[20:23], s91 offen offset:3072 sc1 lds
    s_add_u32 m0, s57, 98304
    s_nop 0
    buffer_load_dwordx4 v6, s[20:23], s91 offen offset:0 sc1 lds
    buffer_load_dwordx4 v6, s[20:23], s91 offen offset:1024 sc1 lds
    buffer_load_dwordx4 v6, s[20:23], s91 offen offset:2048 sc1 lds
    buffer_load_dwordx4 v6, s[20:23], s91 offen offset:3072 sc1 lds
    s_add_u32 s47, s47, 1
    s_mul_i32 s92, s50, 40960
    s_add_u32 s92, s92, s79
    s_add_u32 m0, s57, 94208
    s_nop 0
    buffer_load_dwordx4 v5, s[20:23], s92 offen offset:0 sc1 lds
    buffer_load_dwordx4 v5, s[20:23], s92 offen offset:1024 sc1 lds
    buffer_load_dwordx4 v5, s[20:23], s92 offen offset:2048 sc1 lds
    buffer_load_dwordx4 v5, s[20:23], s92 offen offset:3072 sc1 lds
    s_add_u32 s92, s92, 10240
    s_add_u32 m0, s57, 102400
    s_nop 0
    buffer_load_dwordx4 v5, s[20:23], s92 offen offset:0 sc1 lds
    buffer_load_dwordx4 v5, s[20:23], s92 offen offset:1024 sc1 lds
    buffer_load_dwordx4 v5, s[20:23], s92 offen offset:2048 sc1 lds
    buffer_load_dwordx4 v5, s[20:23], s92 offen offset:3072 sc1 lds
    s_add_u32 s50, s50, 1
    s_waitcnt vmcnt(16)
    s_barrier
    s_lshl_b32 s91, s47, 14
    s_add_u32 s91, s91, s76
    s_add_u32 m0, s57, 0
    s_nop 0
    buffer_load_dwordx4 v5, s[20:23], s91 offen offset:0 sc1 lds
    buffer_load_dwordx4 v5, s[20:23], s91 offen offset:1024 sc1 lds
    buffer_load_dwordx4 v5, s[20:23], s91 offen offset:2048 sc1 lds
    buffer_load_dwordx4 v5, s[20:23], s91 offen offset:3072 sc1 lds
    s_add_u32 m0, s57, 8192
    s_nop 0
    buffer_load_dwordx4 v6, s[20:23], s91 offen offset:0 sc1 lds
    buffer_load_dwordx4 v6, s[20:23], s91 offen offset:1024 sc1 lds
    buffer_load_dwordx4 v6, s[20:23], s91 offen offset:2048 sc1 lds
    buffer_load_dwordx4 v6, s[20:23], s91 offen offset:3072 sc1 lds
    s_add_u32 s47, s47, 1
    s_mul_i32 s92, s50, 40960
    s_add_u32 s92, s92, s79
    s_add_u32 m0, s57, 4096
    s_nop 0
    buffer_load_dwordx4 v5, s[20:23], s92 offen offset:0 sc1 lds
    buffer_load_dwordx4 v5, s[20:23], s92 offen offset:1024 sc1 lds
    buffer_load_dwordx4 v5, s[20:23], s92 offen offset:2048 sc1 lds
    buffer_load_dwordx4 v5, s[20:23], s92 offen offset:3072 sc1 lds
    s_add_u32 s92, s92, 10240
    s_add_u32 m0, s57, 12288
    s_nop 0
    buffer_load_dwordx4 v5, s[20:23], s92 offen offset:0 sc1 lds
    buffer_load_dwordx4 v5, s[20:23], s92 offen offset:1024 sc1 lds
    buffer_load_dwordx4 v5, s[20:23], s92 offen offset:2048 sc1 lds
    buffer_load_dwordx4 v5, s[20:23], s92 offen offset:3072 sc1 lds
    s_add_u32 s50, s50, 1
    s_waitcnt vmcnt(16)
    s_barrier
    s_lshl_b32 s91, s47, 14
    s_add_u32 s91, s91, s76
    s_add_u32 m0, s57, 45056
    s_nop 0
    buffer_load_dwordx4 v5, s[20:23], s91 offen offset:0 sc1 lds
    buffer_load_dwordx4 v5, s[20:23], s91 offen offset:1024 sc1 lds
    buffer_load_dwordx4 v5, s[20:23], s91 offen offset:2048 sc1 lds
    buffer_load_dwordx4 v5, s[20:23], s91 offen offset:3072 sc1 lds
    s_add_u32 m0, s57, 53248
    s_nop 0
    buffer_load_dwordx4 v6, s[20:23], s91 offen offset:0 sc1 lds
    buffer_load_dwordx4 v6, s[20:23], s91 offen offset:1024 sc1 lds
    buffer_load_dwordx4 v6, s[20:23], s91 offen offset:2048 sc1 lds
    buffer_load_dwordx4 v6, s[20:23], s91 offen offset:3072 sc1 lds
    s_add_u32 s47, s47, 1
    s_mul_i32 s92, s50, 40960
    s_add_u32 s92, s92, s79
    s_add_u32 m0, s57, 49152
    s_nop 0
    buffer_load_dwordx4 v5, s[20:23], s92 offen offset:0 sc1 lds
    buffer_load_dwordx4 v5, s[20:23], s92 offen offset:1024 sc1 lds
    buffer_load_dwordx4 v5, s[20:23], s92 offen offset:2048 sc1 lds
    buffer_load_dwordx4 v5, s[20:23], s92 offen offset:3072 sc1 lds
    s_add_u32 s92, s92, 10240
    s_add_u32 m0, s57, 57344
    s_nop 0
    buffer_load_dwordx4 v5, s[20:23], s92 offen offset:0 sc1 lds
    buffer_load_dwordx4 v5, s[20:23], s92 offen offset:1024 sc1 lds
    buffer_load_dwordx4 v5, s[20:23], s92 offen offset:2048 sc1 lds
    buffer_load_dwordx4 v5, s[20:23], s92 offen offset:3072 sc1 lds
    s_add_u32 s50, s50, 1
    s_waitcnt vmcnt(16)
    s_barrier
    s_lshl_b32 s91, s47, 14
    s_add_u32 s91, s91, s76
    s_add_u32 m0, s57, 90112
    s_nop 0
    buffer_load_dwordx4 v5, s[20:23], s91 offen offset:0 sc1 lds
    buffer_load_dwordx4 v5, s[20:23], s91 offen offset:1024 sc1 lds
    buffer_load_dwordx4 v5, s[20:23], s91 offen offset:2048 sc1 lds
    buffer_load_dwordx4 v5, s[20:23], s91 offen offset:3072 sc1 lds
    s_add_u32 m0, s57, 98304
    s_nop 0
    buffer_load_dwordx4 v6, s[20:23], s91 offen offset:0 sc1 lds
    buffer_load_dwordx4 v6, s[20:23], s91 offen offset:1024 sc1 lds
    buffer_load_dwordx4 v6, s[20:23], s91 offen offset:2048 sc1 lds
    buffer_load_dwordx4 v6, s[20:23], s91 offen offset:3072 sc1 lds
    s_add_u32 s47, s47, 1
    s_mul_i32 s92, s50, 40960
    s_add_u32 s92, s92, s79
    s_add_u32 m0, s57, 94208
    s_nop 0
    buffer_load_dwordx4 v5, s[20:23], s92 offen offset:0 sc1 lds
    buffer_load_dwordx4 v5, s[20:23], s92 offen offset:1024 sc1 lds
    buffer_load_dwordx4 v5, s[20:23], s92 offen offset:2048 sc1 lds
    buffer_load_dwordx4 v5, s[20:23], s92 offen offset:3072 sc1 lds
    s_add_u32 s92, s92, 10240
    s_add_u32 m0, s57, 102400
    s_nop 0
    buffer_load_dwordx4 v5, s[20:23], s92 offen offset:0 sc1 lds
    buffer_load_dwordx4 v5, s[20:23], s92 offen offset:1024 sc1 lds
    buffer_load_dwordx4 v5, s[20:23], s92 offen offset:2048 sc1 lds
    buffer_load_dwordx4 v5, s[20:23], s92 offen offset:3072 sc1 lds
    s_add_u32 s50, s50, 1
    s_waitcnt vmcnt(16)
    s_barrier
    s_lshl_b32 s91, s47, 14
    s_add_u32 s91, s91, s76
    s_add_u32 m0, s57, 0
    s_nop 0
    buffer_load_dwordx4 v5, s[20:23], s91 offen offset:0 sc1 lds
    buffer_load_dwordx4 v5, s[20:23], s91 offen offset:1024 sc1 lds
    buffer_load_dwordx4 v5, s[20:23], s91 offen offset:2048 sc1 lds
    buffer_load_dwordx4 v5, s[20:23], s91 offen offset:3072 sc1 lds
    s_add_u32 m0, s57, 8192
    s_nop 0
    buffer_load_dwordx4 v6, s[20:23], s91 offen offset:0 sc1 lds
    buffer_load_dwordx4 v6, s[20:23], s91 offen offset:1024 sc1 lds
    buffer_load_dwordx4 v6, s[20:23], s91 offen offset:2048 sc1 lds
    buffer_load_dwordx4 v6, s[20:23], s91 offen offset:3072 sc1 lds
    s_add_u32 s47, s47, 1
    s_mul_i32 s92, s50, 40960
    s_add_u32 s92, s92, s79
    s_add_u32 m0, s57, 4096
    s_nop 0
    buffer_load_dwordx4 v5, s[20:23], s92 offen offset:0 sc1 lds
    buffer_load_dwordx4 v5, s[20:23], s92 offen offset:1024 sc1 lds
    buffer_load_dwordx4 v5, s[20:23], s92 offen offset:2048 sc1 lds
    buffer_load_dwordx4 v5, s[20:23], s92 offen offset:3072 sc1 lds
    s_add_u32 s92, s92, 10240
    s_add_u32 m0, s57, 12288
    s_nop 0
    buffer_load_dwordx4 v5, s[20:23], s92 offen offset:0 sc1 lds
    buffer_load_dwordx4 v5, s[20:23], s92 offen offset:1024 sc1 lds
    buffer_load_dwordx4 v5, s[20:23], s92 offen offset:2048 sc1 lds
    buffer_load_dwordx4 v5, s[20:23], s92 offen offset:3072 sc1 lds
    s_add_u32 s50, s50, 1
    s_waitcnt vmcnt(16)
    s_barrier
    s_lshl_b32 s91, s47, 14
    s_add_u32 s91, s91, s76
    s_add_u32 m0, s57, 45056
    s_nop 0
    buffer_load_dwordx4 v5, s[20:23], s91 offen offset:0 sc1 lds
    buffer_load_dwordx4 v5, s[20:23], s91 offen offset:1024 sc1 lds
    buffer_load_dwordx4 v5, s[20:23], s91 offen offset:2048 sc1 lds
    buffer_load_dwordx4 v5, s[20:23], s91 offen offset:3072 sc1 lds
    s_add_u32 m0, s57, 53248
    s_nop 0
    buffer_load_dwordx4 v6, s[20:23], s91 offen offset:0 sc1 lds
    buffer_load_dwordx4 v6, s[20:23], s91 offen offset:1024 sc1 lds
    buffer_load_dwordx4 v6, s[20:23], s91 offen offset:2048 sc1 lds
    buffer_load_dwordx4 v6, s[20:23], s91 offen offset:3072 sc1 lds
    s_add_u32 s47, s47, 1
    s_mul_i32 s92, s50, 40960
    s_add_u32 s92, s92, s79
    s_add_u32 m0, s57, 49152
    s_nop 0
    buffer_load_dwordx4 v5, s[20:23], s92 offen offset:0 sc1 lds
    buffer_load_dwordx4 v5, s[20:23], s92 offen offset:1024 sc1 lds
    buffer_load_dwordx4 v5, s[20:23], s92 offen offset:2048 sc1 lds
    buffer_load_dwordx4 v5, s[20:23], s92 offen offset:3072 sc1 lds
    s_add_u32 s92, s92, 10240
    s_add_u32 m0, s57, 57344
    s_nop 0
    buffer_load_dwordx4 v5, s[20:23], s92 offen offset:0 sc1 lds
    buffer_load_dwordx4 v5, s[20:23], s92 offen offset:1024 sc1 lds
    buffer_load_dwordx4 v5, s[20:23], s92 offen offset:2048 sc1 lds
    buffer_load_dwordx4 v5, s[20:23], s92 offen offset:3072 sc1 lds
    s_add_u32 s50, s50, 1
    s_waitcnt vmcnt(16)
    s_barrier
    s_lshl_b32 s91, s47, 14
    s_add_u32 s91, s91, s76
    s_add_u32 m0, s57, 90112
    s_nop 0
    buffer_load_dwordx4 v5, s[20:23], s91 offen offset:0 sc1 lds
    buffer_load_dwordx4 v5, s[20:23], s91 offen offset:1024 sc1 lds
    buffer_load_dwordx4 v5, s[20:23], s91 offen offset:2048 sc1 lds
    buffer_load_dwordx4 v5, s[20:23], s91 offen offset:3072 sc1 lds
    s_add_u32 m0, s57, 98304
    s_nop 0
    buffer_load_dwordx4 v6, s[20:23], s91 offen offset:0 sc1 lds
    buffer_load_dwordx4 v6, s[20:23], s91 offen offset:1024 sc1 lds
    buffer_load_dwordx4 v6, s[20:23], s91 offen offset:2048 sc1 lds
    buffer_load_dwordx4 v6, s[20:23], s91 offen offset:3072 sc1 lds
    s_add_u32 s47, s47, 1
    s_mul_i32 s92, s50, 40960
    s_add_u32 s92, s92, s79
    s_add_u32 m0, s57, 94208
    s_nop 0
    buffer_load_dwordx4 v5, s[20:23], s92 offen offset:0 sc1 lds
    buffer_load_dwordx4 v5, s[20:23], s92 offen offset:1024 sc1 lds
    buffer_load_dwordx4 v5, s[20:23], s92 offen offset:2048 sc1 lds
    buffer_load_dwordx4 v5, s[20:23], s92 offen offset:3072 sc1 lds
    s_add_u32 s92, s92, 10240
    s_add_u32 m0, s57, 102400
    s_nop 0
    buffer_load_dwordx4 v5, s[20:23], s92 offen offset:0 sc1 lds
    buffer_load_dwordx4 v5, s[20:23], s92 offen offset:1024 sc1 lds
    buffer_load_dwordx4 v5, s[20:23], s92 offen offset:2048 sc1 lds
    buffer_load_dwordx4 v5, s[20:23], s92 offen offset:3072 sc1 lds
    s_add_u32 s50, s50, 1
    s_waitcnt vmcnt(16)
    s_barrier
    s_lshl_b32 s91, s47, 14
    s_add_u32 s91, s91, s76
    s_add_u32 m0, s57, 0
    s_nop 0
    buffer_load_dwordx4 v5, s[20:23], s91 offen offset:0 sc1 lds
    buffer_load_dwordx4 v5, s[20:23], s91 offen offset:1024 sc1 lds
    buffer_load_dwordx4 v5, s[20:23], s91 offen offset:2048 sc1 lds
    buffer_load_dwordx4 v5, s[20:23], s91 offen offset:3072 sc1 lds
    s_add_u32 m0, s57, 8192
    s_nop 0
    buffer_load_dwordx4 v6, s[20:23], s91 offen offset:0 sc1 lds
    buffer_load_dwordx4 v6, s[20:23], s91 offen offset:1024 sc1 lds
    buffer_load_dwordx4 v6, s[20:23], s91 offen offset:2048 sc1 lds
    buffer_load_dwordx4 v6, s[20:23], s91 offen offset:3072 sc1 lds
    s_add_u32 s47, s47, 1
    s_mul_i32 s92, s50, 40960
    s_add_u32 s92, s92, s79
    s_add_u32 m0, s57, 4096
    s_nop 0
    buffer_load_dwordx4 v5, s[20:23], s92 offen offset:0 sc1 lds
    buffer_load_dwordx4 v5, s[20:23], s92 offen offset:1024 sc1 lds
    buffer_load_dwordx4 v5, s[20:23], s92 offen offset:2048 sc1 lds
    buffer_load_dwordx4 v5, s[20:23], s92 offen offset:3072 sc1 lds
    s_add_u32 s92, s92, 10240
    s_add_u32 m0, s57, 12288
    s_nop 0
    buffer_load_dwordx4 v5, s[20:23], s92 offen offset:0 sc1 lds
    buffer_load_dwordx4 v5, s[20:23], s92 offen offset:1024 sc1 lds
    buffer_load_dwordx4 v5, s[20:23], s92 offen offset:2048 sc1 lds
    buffer_load_dwordx4 v5, s[20:23], s92 offen offset:3072 sc1 lds
    s_add_u32 s50, s50, 1
    s_waitcnt vmcnt(16)
    s_barrier
    s_lshl_b32 s91, s47, 14
    s_add_u32 s91, s91, s76
    s_add_u32 m0, s57, 45056
    s_nop 0
    buffer_load_dwordx4 v5, s[20:23], s91 offen offset:0 sc1 lds
    buffer_load_dwordx4 v5, s[20:23], s91 offen offset:1024 sc1 lds
    buffer_load_dwordx4 v5, s[20:23], s91 offen offset:2048 sc1 lds
    buffer_load_dwordx4 v5, s[20:23], s91 offen offset:3072 sc1 lds
    s_add_u32 m0, s57, 53248
    s_nop 0
    buffer_load_dwordx4 v6, s[20:23], s91 offen offset:0 sc1 lds
    buffer_load_dwordx4 v6, s[20:23], s91 offen offset:1024 sc1 lds
    buffer_load_dwordx4 v6, s[20:23], s91 offen offset:2048 sc1 lds
    buffer_load_dwordx4 v6, s[20:23], s91 offen offset:3072 sc1 lds
    s_add_u32 s47, s47, 1
    s_mul_i32 s92, s50, 40960
    s_add_u32 s92, s92, s79
    s_add_u32 m0, s57, 49152
    s_nop 0
    buffer_load_dwordx4 v5, s[20:23], s92 offen offset:0 sc1 lds
    buffer_load_dwordx4 v5, s[20:23], s92 offen offset:1024 sc1 lds
    buffer_load_dwordx4 v5, s[20:23], s92 offen offset:2048 sc1 lds
    buffer_load_dwordx4 v5, s[20:23], s92 offen offset:3072 sc1 lds
    s_add_u32 s92, s92, 10240
    s_add_u32 m0, s57, 57344
    s_nop 0
    buffer_load_dwordx4 v5, s[20:23], s92 offen offset:0 sc1 lds
    buffer_load_dwordx4 v5, s[20:23], s92 offen offset:1024 sc1 lds
    buffer_load_dwordx4 v5, s[20:23], s92 offen offset:2048 sc1 lds
    buffer_load_dwordx4 v5, s[20:23], s92 offen offset:3072 sc1 lds
    s_add_u32 s50, s50, 1
    s_waitcnt vmcnt(16)
    s_barrier
    s_lshl_b32 s91, s47, 14
    s_add_u32 s91, s91, s76
    s_add_u32 m0, s57, 90112
    s_nop 0
    buffer_load_dwordx4 v5, s[20:23], s91 offen offset:0 sc1 lds
    buffer_load_dwordx4 v5, s[20:23], s91 offen offset:1024 sc1 lds
    buffer_load_dwordx4 v5, s[20:23], s91 offen offset:2048 sc1 lds
    buffer_load_dwordx4 v5, s[20:23], s91 offen offset:3072 sc1 lds
    s_add_u32 m0, s57, 98304
    s_nop 0
    buffer_load_dwordx4 v6, s[20:23], s91 offen offset:0 sc1 lds
    buffer_load_dwordx4 v6, s[20:23], s91 offen offset:1024 sc1 lds
    buffer_load_dwordx4 v6, s[20:23], s91 offen offset:2048 sc1 lds
    buffer_load_dwordx4 v6, s[20:23], s91 offen offset:3072 sc1 lds
    s_add_u32 s47, s47, 1
    s_mul_i32 s92, s50, 40960
    s_add_u32 s92, s92, s79
    s_add_u32 m0, s57, 94208
    s_nop 0
    buffer_load_dwordx4 v5, s[20:23], s92 offen offset:0 sc1 lds
    buffer_load_dwordx4 v5, s[20:23], s92 offen offset:1024 sc1 lds
    buffer_load_dwordx4 v5, s[20:23], s92 offen offset:2048 sc1 lds
    buffer_load_dwordx4 v5, s[20:23], s92 offen offset:3072 sc1 lds
    s_add_u32 s92, s92, 10240
    s_add_u32 m0, s57, 102400
    s_nop 0
    buffer_load_dwordx4 v5, s[20:23], s92 offen offset:0 sc1 lds
    buffer_load_dwordx4 v5, s[20:23], s92 offen offset:1024 sc1 lds
    buffer_load_dwordx4 v5, s[20:23], s92 offen offset:2048 sc1 lds
    buffer_load_dwordx4 v5, s[20:23], s92 offen offset:3072 sc1 lds
    s_add_u32 s50, s50, 1
    s_waitcnt vmcnt(16)
    s_barrier
    s_lshl_b32 s91, s47, 14
    s_add_u32 s91, s91, s76
    s_add_u32 m0, s57, 0
    s_nop 0
    buffer_load_dwordx4 v5, s[20:23], s91 offen offset:0 sc1 lds
    buffer_load_dwordx4 v5, s[20:23], s91 offen offset:1024 sc1 lds
    buffer_load_dwordx4 v5, s[20:23], s91 offen offset:2048 sc1 lds
    buffer_load_dwordx4 v5, s[20:23], s91 offen offset:3072 sc1 lds
    s_add_u32 m0, s57, 8192
    s_nop 0
    buffer_load_dwordx4 v6, s[20:23], s91 offen offset:0 sc1 lds
    buffer_load_dwordx4 v6, s[20:23], s91 offen offset:1024 sc1 lds
    buffer_load_dwordx4 v6, s[20:23], s91 offen offset:2048 sc1 lds
    buffer_load_dwordx4 v6, s[20:23], s91 offen offset:3072 sc1 lds
    s_add_u32 s47, s47, 1
    s_mul_i32 s92, s50, 40960
    s_add_u32 s92, s92, s79
    s_add_u32 m0, s57, 4096
    s_nop 0
    buffer_load_dwordx4 v5, s[20:23], s92 offen offset:0 sc1 lds
    buffer_load_dwordx4 v5, s[20:23], s92 offen offset:1024 sc1 lds
    buffer_load_dwordx4 v5, s[20:23], s92 offen offset:2048 sc1 lds
    buffer_load_dwordx4 v5, s[20:23], s92 offen offset:3072 sc1 lds
    s_add_u32 s92, s92, 10240
    s_add_u32 m0, s57, 12288
    s_nop 0
    buffer_load_dwordx4 v5, s[20:23], s92 offen offset:0 sc1 lds
    buffer_load_dwordx4 v5, s[20:23], s92 offen offset:1024 sc1 lds
    buffer_load_dwordx4 v5, s[20:23], s92 offen offset:2048 sc1 lds
    buffer_load_dwordx4 v5, s[20:23], s92 offen offset:3072 sc1 lds
    s_add_u32 s50, s50, 1
    s_waitcnt vmcnt(16)
    s_barrier
    s_waitcnt vmcnt(0)
    s_barrier
    s_endpgm
L_SQ:
    v_mov_b32 v45, 1073741824
    v_bfe_u32 v10, v1, 2, 2
    v_and_b32 v11, 3, v1
    v_lshlrev_b32 v11, 3, v11
    v_and_b32 v12, 16, v1
    v_lshl_add_u32 v11, v12, 1, v11
    v_lshl_add_u32 v58, v10, 6, v11
    v_mul_u32_u24 v12, 2048, v2
    v_add_u32 v58, v58, v12
    s_mul_i32 s39, s36, 512
    s_add_u32 s39, s39, 16384
    v_add_u32 v32, s39, v58
    s_lshl_b32 s96, s36, 7
    v_bfe_u32 v10, v1, 2, 2
    v_and_b32 v11, 3, v1
    v_lshlrev_b32 v11, 3, v11
    v_and_b32 v12, 16, v1
    v_lshl_add_u32 v11, v12, 1, v11
    v_lshl_add_u32 v58, v10, 6, v11
    v_mul_u32_u24 v12, 1024, v2
    v_add_u32 v58, v58, v12
    s_and_b32 s97, s36, 1
    s_lshl_b32 s39, s97, 9
    s_add_u32 s39, s39, 32768
    v_add_u32 v33, s39, v58
    s_add_u32 s97, s97, 4
    s_lshl_b32 s97, s97, 7
    v_bfe_u32 v10, v1, 2, 2
    v_and_b32 v11, 3, v1
    v_lshlrev_b32 v11, 3, v11
    v_and_b32 v12, 16, v1
    v_lshl_add_u32 v11, v12, 1, v11
    v_lshl_add_u32 v12, v2, 3, v10
    v_mul_u32_u24 v58, 192, v12
    v_add_u32 v58, v58, v11
    s_min_u32 s78, s36, 2
    s_lshl_b32 s39, s78, 6
    s_add_u32 s39, s39, 135168
    v_add_u32 v34, s39, v58
    s_add_u32 s78, s78, 6
    s_lshl_b32 s78, s78, 7
    v_and_b32 v10, 31, v1
    v_bfe_u32 v11, v1, 1, 3
    v_xor_b32 v11, v11, v2
    s_lshl_b32 s39, s36, 12
    v_lshl_add_u32 v10, v10, 7, s39
    v_xor_b32 v12, 0, v11
    v_lshl_add_u32 v112, v12, 4, v10
    v_xor_b32 v12, 2, v11
    v_lshl_add_u32 v113, v12, 4, v10
    v_xor_b32 v12, 4, v11
    v_lshl_add_u32 v114, v12, 4, v10
    v_xor_b32 v12, 6, v11
    v_lshl_add_u32 v115, v12, 4, v10
    s_sub_u32 s69, s36, 2
    s_waitcnt lgkmcnt(0)
    s_mov_b32 s20, s58
    s_mov_b32 s21, s59
    s_mov_b32 s22, 14680064
    s_mov_b32 s23, 0x00020000
    s_mov_b32 s24, s56
    s_mov_b32 s25, s57
    s_mov_b32 s26, 256
    s_mov_b32 s27, 0x00020000
    s_lshl_b32 s40, s69, 5
    s_add_u32 s40, s40, s89
    s_sub_u32 s76, s40, 48
    s_mul_i32 s60, s76, 13108
    s_lshr_b32 s60, s60, 16
    s_mul_i32 s61, s60, 5
    s_sub_u32 s61, s76, s61
    s_lshl_b32 s79, s61, 1
    s_cmp_lt_u32 s61, 3
    s_cselect_b32 s41, 0, 1
    s_sub_u32 s79, s79, s41
    s_add_u32 s41, s79, 1
    s_cmp_eq_u32 s61, 2
    s_cselect_b32 s41, 9, s41
    s_mul_i32 s60, s60, 10
    s_add_u32 s79, s79, s60
    s_add_u32 s41, s41, s60
    s_lshr_b32 s76, s40, 2
    s_mul_i32 s76, s76, 12
    s_and_b32 s60, s40, 3
    s_lshl_b32 s60, s60, 1
    s_add_u32 s76, s76, s60
    s_add_u32 s76, s76, 4
    s_sub_u32 s60, s40, 32
    s_lshr_b32 s60, s60, 1
    s_mul_i32 s60, s60, 12
    s_and_b32 s61, s40, 1
    s_lshl_b32 s61, s61, 1
    s_add_u32 s60, s60, s61
    s_cmp_lt_u32 s40, 32
    s_cselect_b32 s76, s76, s60
    s_add_u32 s60, s76, 1
    s_cmp_lt_u32 s40, 48
    s_cselect_b32 s79, s76, s79
    s_cselect_b32 s41, s60, s41
    s_cselect_b32 s28, s54, s48
    s_cselect_b32 s29, s55, s49
    s_mov_b32 s30, 819200
    s_cselect_b32 s30, 1966080, s30
    s_mov_b32 s31, 0x00020000
    s_mul_i32 s76, s90, 320
    s_add_u32 s76, s76, 160
    s_mul_i32 s79, s79, 20480
    s_mul_i32 s41, s41, 20480
    s_sub_u32 s41, s41, 20480
    s_add_u32 s79, s79, s76
    s_add_u32 s41, s41, s76
    s_mul_i32 s77, s90, 68
    s_add_u32 s77, s77, s40
    s_mul_i32 s77, s77, 10240
    s_add_u32 s77, s77, 9442304
    s_cmp_lt_u32 s40, 68
    s_cselect_b32 s79, s79, 1073741824
    s_cselect_b32 s41, s41, 1073741824
    s_cselect_b32 s77, s77, 1073741824
    v_mov_b32 v13, s79
    v_mov_b32 v14, s41
    v_add_u32 v58, 0, v1
    v_mul_u32_u24 v11, 6554, v58
    v_lshrrev_b32 v11, 16, v11
    v_mul_u32_u24 v12, 10, v11
    v_sub_u32 v12, v58, v12
    v_cmp_lt_u32 vcc, 15, v11
    v_mul_u32_u24 v11, 1280, v11
    v_lshl_add_u32 v11, v12, 4, v11
    v_cndmask_b32 v15, v13, v14, vcc
    v_add_u32 v140, v11, v15
    v_add_u32 v58, 64, v1
    v_mul_u32_u24 v11, 6554, v58
    v_lshrrev_b32 v11, 16, v11
    v_mul_u32_u24 v12, 10, v11
    v_sub_u32 v12, v58, v12
    v_cmp_lt_u32 vcc, 15, v11
    v_mul_u32_u24 v11, 1280, v11
    v_lshl_add_u32 v11, v12, 4, v11
    v_cndmask_b32 v15, v13, v14, vcc
    v_add_u32 v141, v11, v15
    v_add_u32 v58, 128, v1
    v_mul_u32_u24 v11, 6554, v58
    v_lshrrev_b32 v11, 16, v11
    v_mul_u32_u24 v12, 10, v11
    v_sub_u32 v12, v58, v12
    v_cmp_lt_u32 vcc, 15, v11
    v_mul_u32_u24 v11, 1280, v11
    v_lshl_add_u32 v11, v12, 4, v11
    v_cndmask_b32 v15, v13, v14, vcc
    v_add_u32 v142, v11, v15
    v_add_u32 v58, 192, v1
    v_mul_u32_u24 v11, 6554, v58
    v_lshrrev_b32 v11, 16, v11
    v_mul_u32_u24 v12, 10, v11
    v_sub_u32 v12, v58, v12
    v_cmp_lt_u32 vcc, 15, v11
    v_mul_u32_u24 v11, 1280, v11
    v_lshl_add_u32 v11, v12, 4, v11
    v_cndmask_b32 v15, v13, v14, vcc
    v_add_u32 v143, v11, v15
    v_add_u32 v58, 256, v1
    v_mul_u32_u24 v11, 6554, v58
    v_lshrrev_b32 v11, 16, v11
    v_mul_u32_u24 v12, 10, v11
    v_sub_u32 v12, v58, v12
    v_cmp_lt_u32 vcc, 15, v11
    v_mul_u32_u24 v11, 1280, v11
    v_lshl_add_u32 v11, v12, 4, v11
    v_cndmask_b32 v15, v13, v14, vcc
    v_add_u32 v144, v11, v15
    s_lshl_b32 s40, s69, 5
    s_add_u32 s40, s40, s89
    s_add_u32 s40, s40, 64
    s_sub_u32 s76, s40, 48
    s_mul_i32 s60, s76, 13108
    s_lshr_b32 s60, s60, 16
    s_mul_i32 s61, s60, 5
    s_sub_u32 s61, s76, s61
    s_lshl_b32 s79, s61, 1
    s_cmp_lt_u32 s61, 3
    s_cselect_b32 s41, 0, 1
    s_sub_u32 s79, s79, s41
    s_add_u32 s41, s79, 1
    s_cmp_eq_u32 s61, 2
    s_cselect_b32 s41, 9, s41
    s_mul_i32 s60, s60, 10
    s_add_u32 s79, s79, s60
    s_add_u32 s41, s41, s60
    s_lshr_b32 s76, s40, 2
    s_mul_i32 s76, s76, 12
    s_and_b32 s60, s40, 3
    s_lshl_b32 s60, s60, 1
    s_add_u32 s76, s76, s60
    s_add_u32 s76, s76, 4
    s_sub_u32 s60, s40, 32
    s_lshr_b32 s60, s60, 1
    s_mul_i32 s60, s60, 12
    s_and_b32 s61, s40, 1
    s_lshl_b32 s61, s61, 1
    s_add_u32 s60, s60, s61
    s_cmp_lt_u32 s40, 32
    s_cselect_b32 s76, s76, s60
    s_add_u32 s60, s76, 1
    s_cmp_lt_u32 s40, 48
    s_cselect_b32 s79, s76, s79
    s_cselect_b32 s41, s60, s41
    s_cselect_b32 s12, s54, s48
    s_cselect_b32 s13, s55, s49
    s_mov_b32 s14, 819200
    s_cselect_b32 s14, 1966080, s14
    s_mov_b32 s15, 0x00020000
    s_mul_i32 s76, s90, 320
    s_add_u32 s76, s76, 160
    s_mul_i32 s79, s79, 20480
    s_mul_i32 s41, s41, 20480
    s_sub_u32 s41, s41, 20480
    s_add_u32 s79, s79, s76
    s_add_u32 s41, s41, s76
    s_mul_i32 s63, s90, 68
    s_add_u32 s63, s63, s40
    s_mul_i32 s63, s63, 10240
    s_add_u32 s63, s63, 9442304
    s_cmp_lt_u32 s40, 68
    s_cselect_b32 s79, s79, 1073741824
    s_cselect_b32 s41, s41, 1073741824
    s_cselect_b32 s63, s63, 1073741824
    v_mov_b32 v13, s79
    v_mov_b32 v14, s41
    v_add_u32 v58, 0, v1
    v_mul_u32_u24 v11, 6554, v58
    v_lshrrev_b32 v11, 16, v11
    v_mul_u32_u24 v12, 10, v11
    v_sub_u32 v12, v58, v12
    v_cmp_lt_u32 vcc, 15, v11
    v_mul_u32_u24 v11, 1280, v11
    v_lshl_add_u32 v11, v12, 4, v11
    v_cndmask_b32 v15, v13, v14, vcc
    v_add_u32 v145, v11, v15
    v_add_u32 v58, 64, v1
    v_mul_u32_u24 v11, 6554, v58
    v_lshrrev_b32 v11, 16, v11
    v_mul_u32_u24 v12, 10, v11
    v_sub_u32 v12, v58, v12
    v_cmp_lt_u32 vcc, 15, v11
    v_mul_u32_u24 v11, 1280, v11
    v_lshl_add_u32 v11, v12, 4, v11
    v_cndmask_b32 v15, v13, v14, vcc
    v_add_u32 v146, v11, v15
    v_add_u32 v58, 128, v1
    v_mul_u32_u24 v11, 6554, v58
    v_lshrrev_b32 v11, 16, v11
    v_mul_u32_u24 v12, 10, v11
    v_sub_u32 v12, v58, v12
    v_cmp_lt_u32 vcc, 15, v11
    v_mul_u32_u24 v11, 1280, v11
    v_lshl_add_u32 v11, v12, 4, v11
    v_cndmask_b32 v15, v13, v14, vcc
    v_add_u32 v147, v11, v15
    v_add_u32 v58, 192, v1
    v_mul_u32_u24 v11, 6554, v58
    v_lshrrev_b32 v11, 16, v11
    v_mul_u32_u24 v12, 10, v11
    v_sub_u32 v12, v58, v12
    v_cmp_lt_u32 vcc, 15, v11
    v_mul_u32_u24 v11, 1280, v11
    v_lshl_add_u32 v11, v12, 4, v11
    v_cndmask_b32 v15, v13, v14, vcc
    v_add_u32 v148, v11, v15
    v_add_u32 v58, 256, v1
    v_mul_u32_u24 v11, 6554, v58
    v_lshrrev_b32 v11, 16, v11
    v_mul_u32_u24 v12, 10, v11
    v_sub_u32 v12, v58, v12
    v_cmp_lt_u32 vcc, 15, v11
    v_mul_u32_u24 v11, 1280, v11
    v_lshl_add_u32 v11, v12, 4, v11
    v_cndmask_b32 v15, v13, v14, vcc
    v_add_u32 v149, v11, v15
    s_mov_b32 s49, s69
    s_mul_i32 s64, s49, 10240
    s_add_u32 s64, s64, 135168
    v_bfe_u32 v58, v1, 4, 1
    v_bfe_u32 v11, v1, 2, 2
    v_lshl_add_u32 v58, v58, 2, v11
    v_lshl_add_u32 v58, v2, 4, v58
    v_mul_u32_u24 v58, 160, v58
    v_and_b32 v11, 3, v1
    v_lshl_add_u32 v58, v11, 3, v58
    v_add_u32 v150, s64, v58
    v_subrev_u32 v56, 384, v0
    v_mov_b32 v46, 1
    v_mov_b32 v31, 3
    v_cmp_gt_u32 vcc, 2, v56
    v_lshlrev_b32 v11, 7, v1
    v_mov_b32 v13, 128
    v_cndmask_b32 v51, v45, v11, vcc
    v_cndmask_b32 v55, 0, v13, vcc
    s_lshr_b32 s39, s89, 1
    s_lshl_b32 s39, s39, 11
    s_and_b32 s40, s89, 1
    s_lshl_b32 s40, s40, 5
    s_add_u32 s39, s39, s40
    s_add_u32 s39, s39, 13697152
    v_lshrrev_b32 v10, 1, v1
    v_and_b32 v11, 1, v1
    v_lshl_add_u32 v11, v11, 4, s39
    v_lshl_add_u32 v12, v10, 8, v11
    v_cmp_gt_u32 vcc, 16, v56
    v_mov_b32 v13, 2
    s_nop 0
    v_cndmask_b32 v48, v45, v12, vcc
    v_cndmask_b32 v52, 0, v46, vcc
    v_cndmask_b32 v53, 0, v13, vcc
    v_cndmask_b32 v49, 0, v31, vcc
    s_lshr_b32 s39, s90, 1
    s_lshl_b32 s39, s39, 8
    s_and_b32 s40, s90, 1
    s_lshl_b32 s40, s40, 13
    s_add_u32 s39, s39, s40
    s_add_u32 s39, s39, 13697120
    v_and_b32 v10, 3, v1
    v_lshl_add_u32 v10, v10, 11, s39
    v_and_b32 v11, 4, v1
    v_lshl_add_u32 v10, v11, 12, v10
    v_and_b32 v11, 8, v1
    v_lshl_add_u32 v10, v11, 4, v10
    v_and_b32 v11, 48, v1
    v_lshl_add_u32 v12, v11, 5, v10
    v_cmp_gt_u32 vcc, 64, v56
    s_nop 1
    v_cndmask_b32 v47, v45, v12, vcc
    v_cndmask_b32 v54, 0, v13, vcc
    v_lshlrev_b32 v11, 2, v3
    s_lshl_b32 s39, s49, 9
    v_add_u32 v11, s39, v11
    v_lshl_add_u32 v152, v2, 10, v11
    v_cmp_gt_u32 vcc, 1024, v11
    v_and_b32 v12, 0x7f, v11
    s_mul_i32 s44, s37, 10240
    s_add_u32 s44, s44, 13762560
    v_cndmask_b32 v13, v12, v11, vcc
    v_lshl_add_u32 v153, v2, 11, v13
    v_lshl_add_u32 v156, v2, 11, v12
    s_mul_i32 s45, s88, 20480
    s_add_u32 s45, s45, 12845056
    v_lshlrev_b32 v155, 1, v11
    v_lshl_add_u32 v155, v2, 4, v155
    v_add_u32 v155, 159744, v155
    v_lshlrev_b32 v12, 1, v12
    v_lshl_add_u32 v12, v2, 4, v12
    v_add_u32 v157, 161792, v12
    v_lshrrev_b32 v11, 3, v11
    v_add_u32 v154, v11, v2
    s_lshl_b32 s39, s38, 8
    s_add_u32 s39, s39, 13697124
    v_lshrrev_b32 v11, 1, v1
    v_lshlrev_b32 v11, 11, v11
    v_and_b32 v13, 1, v1
    v_lshl_add_u32 v11, v13, 4, v11
    v_add_u32 v11, s39, v11
    v_cndmask_b32 v50, v11, v45, s[70:71]
    v_cndmask_b32 v44, v31, 0, s[70:71]
    v_add_u32 v10, 0, v56
    v_mul_u32_u24 v11, 3121, v10
    v_lshrrev_b32 v11, 16, v11
    v_mul_u32_u24 v12, 21, v11
    v_sub_u32 v12, v10, v12
    v_mul_u32_u24 v13, 13108, v11
    v_lshrrev_b32 v13, 16, v13
    v_mul_u32_u24 v14, 20, v13
    v_add_u32 v14, v14, v12
    v_add_u32 v15, 16, v14
    v_cmp_lt_u32 vcc, 63, v14
    v_add_u32 v13, 64, v13
    v_lshlrev_b32 v168, 4, v10
    v_cndmask_b32 v14, v14, v15, vcc
    v_cmp_eq_u32 vcc, 20, v12
    v_add_u32 v15, 4, v13
    s_nop 0
    v_cndmask_b32 v15, v14, v15, vcc
    v_cndmask_b32 v14, v14, v13, vcc
    v_lshrrev_b32 v12, 2, v11
    v_lshlrev_b32 v12, 5, v12
    v_and_b32 v13, 1, v11
    v_lshl_add_u32 v12, v13, 4, v12
    v_and_b32 v13, 2, v11
    v_lshl_add_u32 v12, v13, 2, v12
    v_add_u32 v12, 135168, v12
    v_mad_u32_u24 v160, v14, s81, v12
    v_mad_u32_u24 v161, v15, s81, v12
    v_add_u32 v10, 128, v56
    v_mul_u32_u24 v11, 3121, v10
    v_lshrrev_b32 v11, 16, v11
    v_mul_u32_u24 v12, 21, v11
    v_sub_u32 v12, v10, v12
    v_mul_u32_u24 v13, 13108, v11
    v_lshrrev_b32 v13, 16, v13
    v_mul_u32_u24 v14, 20, v13
    v_add_u32 v14, v14, v12
    v_add_u32 v15, 16, v14
    v_cmp_lt_u32 vcc, 63, v14
    v_add_u32 v13, 64, v13
    v_lshlrev_b32 v169, 4, v10
    v_cndmask_b32 v14, v14, v15, vcc
    v_cmp_eq_u32 vcc, 20, v12
    v_add_u32 v15, 4, v13
    s_nop 0
    v_cndmask_b32 v15, v14, v15, vcc
    v_cndmask_b32 v14, v14, v13, vcc
    v_lshrrev_b32 v12, 2, v11
    v_lshlrev_b32 v12, 5, v12
    v_and_b32 v13, 1, v11
    v_lshl_add_u32 v12, v13, 4, v12
    v_and_b32 v13, 2, v11
    v_lshl_add_u32 v12, v13, 2, v12
    v_add_u32 v12, 135168, v12
    v_mad_u32_u24 v162, v14, s81, v12
    v_mad_u32_u24 v163, v15, s81, v12
    v_add_u32 v10, 256, v56
    v_mul_u32_u24 v11, 3121, v10
    v_lshrrev_b32 v11, 16, v11
    v_mul_u32_u24 v12, 21, v11
    v_sub_u32 v12, v10, v12
    v_mul_u32_u24 v13, 13108, v11
    v_lshrrev_b32 v13, 16, v13
    v_mul_u32_u24 v14, 20, v13
    v_add_u32 v14, v14, v12
    v_add_u32 v15, 16, v14
    v_cmp_lt_u32 vcc, 63, v14
    v_add_u32 v13, 64, v13
    v_lshlrev_b32 v170, 4, v10
    v_cndmask_b32 v14, v14, v15, vcc
    v_cmp_eq_u32 vcc, 20, v12
    v_add_u32 v15, 4, v13
    s_nop 0
    v_cndmask_b32 v15, v14, v15, vcc
    v_cndmask_b32 v14, v14, v13, vcc
    v_lshrrev_b32 v12, 2, v11
    v_lshlrev_b32 v12, 5, v12
    v_and_b32 v13, 1, v11
    v_lshl_add_u32 v12, v13, 4, v12
    v_and_b32 v13, 2, v11
    v_lshl_add_u32 v12, v13, 2, v12
    v_add_u32 v12, 135168, v12
    v_mad_u32_u24 v164, v14, s81, v12
    v_mad_u32_u24 v165, v15, s81, v12
    v_add_u32 v10, 384, v56
    v_mul_u32_u24 v11, 3121, v10
    v_lshrrev_b32 v11, 16, v11
    v_mul_u32_u24 v12, 21, v11
    v_sub_u32 v12, v10, v12
    v_mul_u32_u24 v13, 13108, v11
    v_lshrrev_b32 v13, 16, v13
    v_mul_u32_u24 v14, 20, v13
    v_add_u32 v14, v14, v12
    v_add_u32 v15, 16, v14
    v_cmp_lt_u32 vcc, 63, v14
    v_add_u32 v13, 64, v13
    v_lshlrev_b32 v171, 4, v10
    v_cndmask_b32 v14, v14, v15, vcc
    v_cmp_eq_u32 vcc, 20, v12
    v_add_u32 v15, 4, v13
    s_nop 0
    v_cndmask_b32 v15, v14, v15, vcc
    v_cndmask_b32 v14, v14, v13, vcc
    v_lshrrev_b32 v12, 2, v11
    v_lshlrev_b32 v12, 5, v12
    v_and_b32 v13, 1, v11
    v_lshl_add_u32 v12, v13, 4, v12
    v_and_b32 v13, 2, v11
    v_lshl_add_u32 v12, v13, 2, v12
    v_add_u32 v12, 135168, v12
    v_mad_u32_u24 v166, v14, s81, v12
    v_mad_u32_u24 v167, v15, s81, v12
    v_mov_b32 v10, 152768
    v_cmp_gt_u32 vcc, 36, v56
    s_nop 1
    v_cndmask_b32 v166, v10, v166, vcc
    v_cndmask_b32 v167, v10, v167, vcc
    v_cndmask_b32 v171, v45, v171, vcc
    s_waitcnt lgkmcnt(0)
    s_barrier
    ds_read_b128 v[120:123], v112
    ds_read_b128 v[124:127], v113
    ds_read_b128 v[128:131], v114
    ds_read_b128 v[132:135], v115
    ds_read_b64_tr_b16 v[64:65], v32 offset:0
    ds_read_b64_tr_b16 v[66:67], v32 offset:256
    ds_read_b64_tr_b16 v[68:69], v32 offset:4096
    ds_read_b64_tr_b16 v[70:71], v32 offset:4352
    ds_read_b64_tr_b16 v[72:73], v32 offset:8192
    ds_read_b64_tr_b16 v[74:75], v32 offset:8448
    ds_read_b64_tr_b16 v[76:77], v32 offset:12288
    ds_read_b64_tr_b16 v[78:79], v32 offset:12544
    ds_read_b64_tr_b16 v[80:81], v33 offset:0
    ds_read_b64_tr_b16 v[82:83], v33 offset:256
    ds_read_b64_tr_b16 v[84:85], v33 offset:2048
    ds_read_b64_tr_b16 v[86:87], v33 offset:2304
    ds_read_b64_tr_b16 v[88:89], v33 offset:4096
    ds_read_b64_tr_b16 v[90:91], v33 offset:4352
    ds_read_b64_tr_b16 v[92:93], v33 offset:6144
    ds_read_b64_tr_b16 v[94:95], v33 offset:6400
    ds_read_b64_tr_b16 v[96:97], v34 offset:0
    ds_read_b64_tr_b16 v[98:99], v34 offset:768
    ds_read_b64_tr_b16 v[100:101], v34 offset:3072
    ds_read_b64_tr_b16 v[102:103], v34 offset:3840
    ds_read_b64_tr_b16 v[104:105], v34 offset:6144
    ds_read_b64_tr_b16 v[106:107], v34 offset:6912
    ds_read_b64_tr_b16 v[108:109], v34 offset:9216
    ds_read_b64_tr_b16 v[110:111], v34 offset:9984
    s_waitcnt lgkmcnt(0)
    v_mov_b32 v116, 0
    v_mov_b32 v117, 0
    v_mov_b32 v118, 0
    v_mov_b32 v119, 0
    v_mov_b32 v36, 0
    v_mov_b32 v37, 0
    v_mov_b32 v38, 0
    v_mov_b32 v39, 0
    v_mov_b32 v40, 0
    v_mov_b32 v41, 0
    v_lshlrev_b32 v58, 16, v120
    v_and_b32 v59, s67, v120
    v_lshlrev_b32 v60, 16, v121
    v_and_b32 v61, s67, v121
    v_add_f32 v116, v116, v58
    v_add_f32 v117, v117, v59
    v_fmac_f32 v118, v58, v58
    v_fmac_f32 v119, v59, v59
    v_add_f32 v116, v116, v60
    v_add_f32 v117, v117, v61
    v_fmac_f32 v118, v60, v60
    v_fmac_f32 v119, v61, v61
    v_lshlrev_b32 v58, 16, v122
    v_and_b32 v59, s67, v122
    v_lshlrev_b32 v60, 16, v123
    v_and_b32 v61, s67, v123
    v_add_f32 v116, v116, v58
    v_add_f32 v117, v117, v59
    v_fmac_f32 v118, v58, v58
    v_fmac_f32 v119, v59, v59
    v_add_f32 v116, v116, v60
    v_add_f32 v117, v117, v61
    v_fmac_f32 v118, v60, v60
    v_fmac_f32 v119, v61, v61
    v_lshlrev_b32 v58, 16, v124
    v_and_b32 v59, s67, v124
    v_lshlrev_b32 v60, 16, v125
    v_and_b32 v61, s67, v125
    v_add_f32 v116, v116, v58
    v_add_f32 v117, v117, v59
    v_fmac_f32 v118, v58, v58
    v_fmac_f32 v119, v59, v59
    v_add_f32 v116, v116, v60
    v_add_f32 v117, v117, v61
    v_fmac_f32 v118, v60, v60
    v_fmac_f32 v119, v61, v61
    v_lshlrev_b32 v58, 16, v126
    v_and_b32 v59, s67, v126
    v_lshlrev_b32 v60, 16, v127
    v_and_b32 v61, s67, v127
    v_add_f32 v116, v116, v58
    v_add_f32 v117, v117, v59
    v_fmac_f32 v118, v58, v58
    v_fmac_f32 v119, v59, v59
    v_add_f32 v116, v116, v60
    v_add_f32 v117, v117, v61
    v_fmac_f32 v118, v60, v60
    v_fmac_f32 v119, v61, v61
    v_lshlrev_b32 v58, 16, v128
    v_and_b32 v59, s67, v128
    v_lshlrev_b32 v60, 16, v129
    v_and_b32 v61, s67, v129
    v_add_f32 v116, v116, v58
    v_add_f32 v117, v117, v59
    v_fmac_f32 v118, v58, v58
    v_fmac_f32 v119, v59, v59
    v_add_f32 v116, v116, v60
    v_add_f32 v117, v117, v61
    v_fmac_f32 v118, v60, v60
    v_fmac_f32 v119, v61, v61
    v_lshlrev_b32 v58, 16, v130
    v_and_b32 v59, s67, v130
    v_lshlrev_b32 v60, 16, v131
    v_and_b32 v61, s67, v131
    v_add_f32 v116, v116, v58
    v_add_f32 v117, v117, v59
    v_fmac_f32 v118, v58, v58
    v_fmac_f32 v119, v59, v59
    v_add_f32 v116, v116, v60
    v_add_f32 v117, v117, v61
    v_fmac_f32 v118, v60, v60
    v_fmac_f32 v119, v61, v61
    v_lshlrev_b32 v58, 16, v132
    v_and_b32 v59, s67, v132
    v_lshlrev_b32 v60, 16, v133
    v_and_b32 v61, s67, v133
    v_add_f32 v116, v116, v58
    v_add_f32 v117, v117, v59
    v_fmac_f32 v118, v58, v58
    v_fmac_f32 v119, v59, v59
    v_add_f32 v116, v116, v60
    v_add_f32 v117, v117, v61
    v_fmac_f32 v118, v60, v60
    v_fmac_f32 v119, v61, v61
    v_lshlrev_b32 v58, 16, v134
    v_and_b32 v59, s67, v134
    v_lshlrev_b32 v60, 16, v135
    v_and_b32 v61, s67, v135
    v_add_f32 v116, v116, v58
    v_add_f32 v117, v117, v59
    v_fmac_f32 v118, v58, v58
    v_fmac_f32 v119, v59, v59
    v_add_f32 v116, v116, v60
    v_add_f32 v117, v117, v61
    v_fmac_f32 v118, v60, v60
    v_fmac_f32 v119, v61, v61
    v_lshlrev_b32 v58, 16, v64
    v_and_b32 v59, s67, v64
    v_lshlrev_b32 v60, 16, v80
    v_and_b32 v61, s67, v80
    v_lshlrev_b32 v62, 16, v96
    v_and_b32 v63, s67, v96
    v_add_f32 v36, v36, v58
    v_add_f32 v37, v37, v59
    v_add_f32 v38, v38, v60
    v_add_f32 v39, v39, v61
    v_add_f32 v40, v40, v62
    v_add_f32 v41, v41, v63
    v_lshlrev_b32 v58, 16, v65
    v_and_b32 v59, s67, v65
    v_lshlrev_b32 v60, 16, v81
    v_and_b32 v61, s67, v81
    v_lshlrev_b32 v62, 16, v97
    v_and_b32 v63, s67, v97
    v_add_f32 v36, v36, v58
    v_add_f32 v37, v37, v59
    v_add_f32 v38, v38, v60
    v_add_f32 v39, v39, v61
    v_add_f32 v40, v40, v62
    v_add_f32 v41, v41, v63
    v_lshlrev_b32 v58, 16, v66
    v_and_b32 v59, s67, v66
    v_lshlrev_b32 v60, 16, v82
    v_and_b32 v61, s67, v82
    v_lshlrev_b32 v62, 16, v98
    v_and_b32 v63, s67, v98
    v_add_f32 v36, v36, v58
    v_add_f32 v37, v37, v59
    v_add_f32 v38, v38, v60
    v_add_f32 v39, v39, v61
    v_add_f32 v40, v40, v62
    v_add_f32 v41, v41, v63
    v_lshlrev_b32 v58, 16, v67
    v_and_b32 v59, s67, v67
    v_lshlrev_b32 v60, 16, v83
    v_and_b32 v61, s67, v83
    v_lshlrev_b32 v62, 16, v99
    v_and_b32 v63, s67, v99
    v_add_f32 v36, v36, v58
    v_add_f32 v37, v37, v59
    v_add_f32 v38, v38, v60
    v_add_f32 v39, v39, v61
    v_add_f32 v40, v40, v62
    v_add_f32 v41, v41, v63
    v_lshlrev_b32 v58, 16, v68
    v_and_b32 v59, s67, v68
    v_lshlrev_b32 v60, 16, v84
    v_and_b32 v61, s67, v84
    v_lshlrev_b32 v62, 16, v100
    v_and_b32 v63, s67, v100
    v_add_f32 v36, v36, v58
    v_add_f32 v37, v37, v59
    v_add_f32 v38, v38, v60
    v_add_f32 v39, v39, v61
    v_add_f32 v40, v40, v62
    v_add_f32 v41, v41, v63
    v_lshlrev_b32 v58, 16, v69
    v_and_b32 v59, s67, v69
    v_lshlrev_b32 v60, 16, v85
    v_and_b32 v61, s67, v85
    v_lshlrev_b32 v62, 16, v101
    v_and_b32 v63, s67, v101
    v_add_f32 v36, v36, v58
    v_add_f32 v37, v37, v59
    v_add_f32 v38, v38, v60
    v_add_f32 v39, v39, v61
    v_add_f32 v40, v40, v62
    v_add_f32 v41, v41, v63
    v_lshlrev_b32 v58, 16, v70
    v_and_b32 v59, s67, v70
    v_lshlrev_b32 v60, 16, v86
    v_and_b32 v61, s67, v86
    v_lshlrev_b32 v62, 16, v102
    v_and_b32 v63, s67, v102
    v_add_f32 v36, v36, v58
    v_add_f32 v37, v37, v59
    v_add_f32 v38, v38, v60
    v_add_f32 v39, v39, v61
    v_add_f32 v40, v40, v62
    v_add_f32 v41, v41, v63
    s_waitcnt lgkmcnt(0)
    s_barrier
    s_add_u32 m0, s64, 0
    s_nop 0
    buffer_load_dwordx4 v140, s[28:31], 0 offen lds
    s_add_u32 m0, s64, 1024
    s_nop 0
    buffer_load_dwordx4 v141, s[28:31], 0 offen lds
    s_add_u32 m0, s64, 2048
    s_nop 0
    buffer_load_dwordx4 v142, s[28:31], 0 offen lds
    s_add_u32 m0, s64, 3072
    s_nop 0
    buffer_load_dwordx4 v143, s[28:31], 0 offen lds
    s_add_u32 m0, s64, 4096
    s_nop 0
    buffer_load_dwordx4 v144, s[28:31], 0 offen lds
    s_add_u32 m0, s64, 5120
    s_nop 0
    buffer_load_dwordx4 v145, s[12:15], 0 offen lds
    s_add_u32 m0, s64, 6144
    s_nop 0
    buffer_load_dwordx4 v146, s[12:15], 0 offen lds
    s_add_u32 m0, s64, 7168
    s_nop 0
    buffer_load_dwordx4 v147, s[12:15], 0 offen lds
    s_add_u32 m0, s64, 8192
    s_nop 0
    buffer_load_dwordx4 v148, s[12:15], 0 offen lds
    s_add_u32 m0, s64, 9216
    s_nop 0
    buffer_load_dwordx4 v149, s[12:15], 0 offen lds
    buffer_load_dword v8, v51, s[24:27], 0 offen sc1
    v_lshlrev_b32 v58, 16, v71
    v_and_b32 v59, s67, v71
    v_lshlrev_b32 v60, 16, v87
    v_and_b32 v61, s67, v87
    v_lshlrev_b32 v62, 16, v103
    v_and_b32 v63, s67, v103
    v_add_f32 v36, v36, v58
    v_add_f32 v37, v37, v59
    v_add_f32 v38, v38, v60
    v_add_f32 v39, v39, v61
    v_add_f32 v40, v40, v62
    v_add_f32 v41, v41, v63
    v_lshlrev_b32 v58, 16, v72
    v_and_b32 v59, s67, v72
    v_lshlrev_b32 v60, 16, v88
    v_and_b32 v61, s67, v88
    v_lshlrev_b32 v62, 16, v104
    v_and_b32 v63, s67, v104
    v_add_f32 v36, v36, v58
    v_add_f32 v37, v37, v59
    v_add_f32 v38, v38, v60
    v_add_f32 v39, v39, v61
    v_add_f32 v40, v40, v62
    v_add_f32 v41, v41, v63
    v_lshlrev_b32 v58, 16, v73
    v_and_b32 v59, s67, v73
    v_lshlrev_b32 v60, 16, v89
    v_and_b32 v61, s67, v89
    v_lshlrev_b32 v62, 16, v105
    v_and_b32 v63, s67, v105
    v_add_f32 v36, v36, v58
    v_add_f32 v37, v37, v59
    v_add_f32 v38, v38, v60
    v_add_f32 v39, v39, v61
    v_add_f32 v40, v40, v62
    v_add_f32 v41, v41, v63
    v_lshlrev_b32 v58, 16, v74
    v_and_b32 v59, s67, v74
    v_lshlrev_b32 v60, 16, v90
    v_and_b32 v61, s67, v90
    v_lshlrev_b32 v62, 16, v106
    v_and_b32 v63, s67, v106
    v_add_f32 v36, v36, v58
    v_add_f32 v37, v37, v59
    v_add_f32 v38, v38, v60
    v_add_f32 v39, v39, v61
    v_add_f32 v40, v40, v62
    v_add_f32 v41, v41, v63
    v_lshlrev_b32 v58, 16, v75
    v_and_b32 v59, s67, v75
    v_lshlrev_b32 v60, 16, v91
    v_and_b32 v61, s67, v91
    v_lshlrev_b32 v62, 16, v107
    v_and_b32 v63, s67, v107
    v_add_f32 v36, v36, v58
    v_add_f32 v37, v37, v59
    v_add_f32 v38, v38, v60
    v_add_f32 v39, v39, v61
    v_add_f32 v40, v40, v62
    v_add_f32 v41, v41, v63
    v_lshlrev_b32 v58, 16, v76
    v_and_b32 v59, s67, v76
    v_lshlrev_b32 v60, 16, v92
    v_and_b32 v61, s67, v92
    v_lshlrev_b32 v62, 16, v108
    v_and_b32 v63, s67, v108
    v_add_f32 v36, v36, v58
    v_add_f32 v37, v37, v59
    v_add_f32 v38, v38, v60
    v_add_f32 v39, v39, v61
    v_add_f32 v40, v40, v62
    v_add_f32 v41, v41, v63
    v_lshlrev_b32 v58, 16, v77
    v_and_b32 v59, s67, v77
    v_lshlrev_b32 v60, 16, v93
    v_and_b32 v61, s67, v93
    v_lshlrev_b32 v62, 16, v109
    v_and_b32 v63, s67, v109
    v_add_f32 v36, v36, v58
    v_add_f32 v37, v37, v59
    v_add_f32 v38, v38, v60
    v_add_f32 v39, v39, v61
    v_add_f32 v40, v40, v62
    v_add_f32 v41, v41, v63
    v_lshlrev_b32 v58, 16, v78
    v_and_b32 v59, s67, v78
    v_lshlrev_b32 v60, 16, v94
    v_and_b32 v61, s67, v94
    v_lshlrev_b32 v62, 16, v110
    v_and_b32 v63, s67, v110
    v_add_f32 v36, v36, v58
    v_add_f32 v37, v37, v59
    v_add_f32 v38, v38, v60
    v_add_f32 v39, v39, v61
    v_add_f32 v40, v40, v62
    v_add_f32 v41, v41, v63
    v_lshlrev_b32 v58, 16, v79
    v_and_b32 v59, s67, v79
    v_lshlrev_b32 v60, 16, v95
    v_and_b32 v61, s67, v95
    v_lshlrev_b32 v62, 16, v111
    v_and_b32 v63, s67, v111
    v_add_f32 v36, v36, v58
    v_add_f32 v37, v37, v59
    v_add_f32 v38, v38, v60
    v_add_f32 v39, v39, v61
    v_add_f32 v40, v40, v62
    v_add_f32 v41, v41, v63
    v_add_f32 v116, v116, v117
    v_add_f32 v117, v118, v119
    v_add_f32 v36, v36, v37
    v_add_f32 v38, v38, v39
    v_add_f32 v40, v40, v41
    v_mov_b32 v58, v116
    v_mov_b32 v59, v117
    v_mov_b32 v60, v36
    v_mov_b32 v61, v38
    v_mov_b32 v62, v40
    s_nop 1
    v_permlane32_swap_b32 v116, v58
    v_permlane32_swap_b32 v117, v59
    v_permlane32_swap_b32 v36, v60
    v_permlane32_swap_b32 v38, v61
    v_permlane32_swap_b32 v40, v62
    s_nop 1
    v_add_f32 v116, v116, v58
    v_add_f32 v117, v117, v59
    v_add_f32 v36, v36, v60
    v_add_f32 v38, v38, v61
    v_add_f32 v40, v40, v62
    v_max_u32 v116, 1, v116
    v_max_u32 v117, 1, v117
    v_max_u32 v36, 1, v36
    v_max_u32 v38, 1, v38
    v_max_u32 v40, 1, v40
    s_mul_i32 s39, s37, 10
    s_add_u32 s39, s39, s83
    s_lshl_b32 s39, s39, 10
    s_add_u32 s39, s39, 13762560
    s_cmp_lt_u32 s88, 10
    s_cselect_b32 s39, s39, 1073741824
    s_mul_i32 s42, s88, 10
    s_add_u32 s42, s42, s83
    s_lshl_b32 s42, s42, 11
    s_add_u32 s42, s42, 12845056
    s_cmp_lt_u32 s37, 10
    s_cselect_b32 s42, s42, 1073741824
    s_lshl_b32 s40, s36, 8
    s_add_u32 s39, s39, s40
    v_lshlrev_b32 v58, 1, v3
    v_cndmask_b32 v58, v58, v45, s[70:71]
    buffer_store_dwordx2 v[116:117], v58, s[20:23], s39 offen sc1
    v_add_u32 v59, s96, v3
    v_add_u32 v60, s97, v3
    v_cndmask_b32 v59, v59, v60, s[70:71]
    v_cndmask_b32 v36, v36, v38, s[70:71]
    buffer_store_dword v36, v59, s[20:23], s42 offen sc1
    v_add_u32 v61, s78, v3
    v_cndmask_b32 v61, v61, v45, s[70:71]
    buffer_store_dword v40, v61, s[20:23], s42 offen sc1
    s_waitcnt lgkmcnt(0)
    s_barrier
    s_waitcnt lgkmcnt(0)
    s_barrier
    s_waitcnt vmcnt(3)
    v_cmp_lt_u32 vcc, v8, v55
    s_mov_b32 s82, 0
    s_nop 3
    s_cbranch_vccz L_okSQ1
L_spSQ1:
    s_sleep 4
    buffer_load_dword v8, v51, s[24:27], 0 offen sc1
    s_waitcnt vmcnt(0)
    v_cmp_lt_u32 vcc, v8, v55
    s_add_u32 s82, s82, 1
    s_cmp_lt_u32 s82, 0x40000
    s_cselect_b64 s[94:95], -1, 0
    s_and_b64 vcc, vcc, s[94:95]
    s_cbranch_vccnz L_spSQ1
L_okSQ1:
    ds_read_b64_tr_b16 v[176:177], v150 offset:0
    ds_read_b64_tr_b16 v[178:179], v150 offset:1280
    ds_read_b64_tr_b16 v[180:181], v150 offset:32
    ds_read_b64_tr_b16 v[182:183], v150 offset:1312
    ds_read_b64_tr_b16 v[184:185], v150 offset:64
    ds_read_b64_tr_b16 v[186:187], v150 offset:1344
    ds_read_b64_tr_b16 v[188:189], v150 offset:96
    ds_read_b64_tr_b16 v[190:191], v150 offset:1376
    ds_read_b64_tr_b16 v[192:193], v150 offset:128
    ds_read_b64_tr_b16 v[194:195], v150 offset:1408
    ds_read_b64_tr_b16 v[196:197], v150 offset:5120
    ds_read_b64_tr_b16 v[198:199], v150 offset:6400
    ds_read_b64_tr_b16 v[200:201], v150 offset:5152
    ds_read_b64_tr_b16 v[202:203], v150 offset:6432
    ds_read_b64_tr_b16 v[204:205], v150 offset:5184
    ds_read_b64_tr_b16 v[206:207], v150 offset:6464
    ds_read_b64_tr_b16 v[208:209], v150 offset:5216
    ds_read_b64_tr_b16 v[210:211], v150 offset:6496
    ds_read_b64_tr_b16 v[212:213], v150 offset:5248
    ds_read_b64_tr_b16 v[214:215], v150 offset:6528
    s_waitcnt lgkmcnt(0)
    s_barrier
    buffer_store_dwordx4 v[176:179], v5, s[20:23], s77 offen offset:0 sc1
    buffer_store_dwordx4 v[180:183], v5, s[20:23], s77 offen offset:1024 sc1
    buffer_store_dwordx4 v[184:187], v5, s[20:23], s77 offen offset:2048 sc1
    buffer_store_dwordx4 v[196:199], v5, s[20:23], s63 offen offset:0 sc1
    buffer_store_dwordx4 v[200:203], v5, s[20:23], s63 offen offset:1024 sc1
    buffer_store_dwordx4 v[204:207], v5, s[20:23], s63 offen offset:2048 sc1
    s_waitcnt lgkmcnt(0)
    s_barrier
    buffer_store_dwordx4 v[188:191], v5, s[20:23], s77 offen offset:3072 sc1
    buffer_store_dwordx4 v[192:195], v6, s[20:23], s77 offen sc1
    buffer_store_dwordx4 v[208:211], v5, s[20:23], s63 offen offset:3072 sc1
    buffer_store_dwordx4 v[212:215], v6, s[20:23], s63 offen sc1
    s_add_u32 s39, s44, 0
    buffer_load_dwordx4 v[64:67], v152, s[20:23], s39 offen sc1
    s_add_u32 s39, s45, 0
    buffer_load_dwordx4 v[84:87], v153, s[20:23], s39 offen sc1
    s_nop 0
    buffer_load_dwordx4 v[104:107], v156, s[20:23], s39 offen offset:1024 sc1
    s_waitcnt lgkmcnt(0)
    s_barrier
    s_add_u32 s39, s44, 2048
    buffer_load_dwordx4 v[68:71], v152, s[20:23], s39 offen sc1
    s_add_u32 s39, s45, 4096
    buffer_load_dwordx4 v[88:91], v153, s[20:23], s39 offen sc1
    s_nop 0
    buffer_load_dwordx4 v[108:111], v156, s[20:23], s39 offen offset:1024 sc1
    s_add_u32 s39, s44, 4096
    buffer_load_dwordx4 v[72:75], v152, s[20:23], s39 offen sc1
    s_add_u32 s39, s45, 8192
    buffer_load_dwordx4 v[92:95], v153, s[20:23], s39 offen sc1
    s_nop 0
    buffer_load_dwordx4 v[112:115], v156, s[20:23], s39 offen offset:1024 sc1
    s_add_u32 s39, s44, 6144
    buffer_load_dwordx4 v[76:79], v152, s[20:23], s39 offen sc1
    s_add_u32 s39, s45, 12288
    buffer_load_dwordx4 v[96:99], v153, s[20:23], s39 offen sc1
    s_nop 0
    buffer_load_dwordx4 v[116:119], v156, s[20:23], s39 offen offset:1024 sc1
    s_add_u32 s39, s44, 8192
    buffer_load_dwordx4 v[80:83], v152, s[20:23], s39 offen sc1
    s_add_u32 s39, s45, 16384
    buffer_load_dwordx4 v[100:103], v153, s[20:23], s39 offen sc1
    s_nop 0
    buffer_load_dwordx4 v[120:123], v156, s[20:23], s39 offen offset:1024 sc1
    s_waitcnt lgkmcnt(0)
    s_barrier
    s_waitcnt vmcnt(15)
    s_waitcnt lgkmcnt(0)
    s_barrier
    v_mov_b32 v9, 2
    buffer_store_dword v9, v4, s[20:23], s74 offen offset:0 sc1
    s_waitcnt vmcnt(1)
    s_mov_b32 s82, 0
L_pvQ:
    v_min_u32 v58, v64, v65
    v_min_u32 v59, v66, v67
    v_min3_u32 v58, v58, v68, v69
    v_min3_u32 v59, v59, v70, v71
    v_min3_u32 v58, v58, v72, v73
    v_min3_u32 v59, v59, v74, v75
    v_min3_u32 v58, v58, v76, v77
    v_min3_u32 v59, v59, v78, v79
    v_min3_u32 v58, v58, v80, v81
    v_min3_u32 v59, v59, v82, v83
    v_min3_u32 v58, v58, v84, v85
    v_min3_u32 v59, v59, v86, v87
    v_min3_u32 v58, v58, v88, v89
    v_min3_u32 v59, v59, v90, v91
    v_min3_u32 v58, v58, v92, v93
    v_min3_u32 v59, v59, v94, v95
    v_min3_u32 v58, v58, v96, v97
    v_min3_u32 v59, v59, v98, v99
    v_min3_u32 v58, v58, v100, v101
    v_min3_u32 v59, v59, v102, v103
    v_min3_u32 v58, v58, v104, v105
    v_min3_u32 v59, v59, v106, v107
    v_min3_u32 v58, v58, v108, v109
    v_min3_u32 v59, v59, v110, v111
    v_min3_u32 v58, v58, v112, v113
    v_min3_u32 v59, v59, v114, v115
    v_min3_u32 v58, v58, v116, v117
    v_min3_u32 v59, v59, v118, v119
    v_min3_u32 v58, v58, v120, v121
    v_min3_u32 v59, v59, v122, v123
    v_min_u32 v58, v58, v59
    v_cmp_eq_u32 vcc, 0, v58
    s_add_u32 s82, s82, 1
    s_cmp_lt_u32 s82, 0x20000
    s_cselect_b64 s[94:95], -1, 0
    s_and_b64 vcc, vcc, s[94:95]
    s_cbranch_vccz L_pvokQ
    s_sleep 2
    s_add_u32 s39, s44, 0
    buffer_load_dwordx4 v[64:67], v152, s[20:23], s39 offen sc1
    s_add_u32 s39, s45, 0
    buffer_load_dwordx4 v[84:87], v153, s[20:23], s39 offen sc1
    s_nop 0
    buffer_load_dwordx4 v[104:107], v156, s[20:23], s39 offen offset:1024 sc1
    s_add_u32 s39, s44, 2048
    buffer_load_dwordx4 v[68:71], v152, s[20:23], s39 offen sc1
    s_add_u32 s39, s45, 4096
    buffer_load_dwordx4 v[88:91], v153, s[20:23], s39 offen sc1
    s_nop 0
    buffer_load_dwordx4 v[108:111], v156, s[20:23], s39 offen offset:1024 sc1
    s_add_u32 s39, s44, 4096
    buffer_load_dwordx4 v[72:75], v152, s[20:23], s39 offen sc1
    s_add_u32 s39, s45, 8192
    buffer_load_dwordx4 v[92:95], v153, s[20:23], s39 offen sc1
    s_nop 0
    buffer_load_dwordx4 v[112:115], v156, s[20:23], s39 offen offset:1024 sc1
    s_add_u32 s39, s44, 6144
    buffer_load_dwordx4 v[76:79], v152, s[20:23], s39 offen sc1
    s_add_u32 s39, s45, 12288
    buffer_load_dwordx4 v[96:99], v153, s[20:23], s39 offen sc1
    s_nop 0
    buffer_load_dwordx4 v[116:119], v156, s[20:23], s39 offen offset:1024 sc1
    s_add_u32 s39, s44, 8192
    buffer_load_dwordx4 v[80:83], v152, s[20:23], s39 offen sc1
    s_add_u32 s39, s45, 16384
    buffer_load_dwordx4 v[100:103], v153, s[20:23], s39 offen sc1
    s_nop 0
    buffer_load_dwordx4 v[120:123], v156, s[20:23], s39 offen offset:1024 sc1
    s_waitcnt vmcnt(0)
    s_branch L_pvQ
L_pvokQ:
    v_add_f32 v64, v64, v68
    v_add_f32 v84, v84, v88
    v_add_f32 v104, v104, v108
    v_add_f32 v65, v65, v69
    v_add_f32 v85, v85, v89
    v_add_f32 v105, v105, v109
    v_add_f32 v66, v66, v70
    v_add_f32 v86, v86, v90
    v_add_f32 v106, v106, v110
    v_add_f32 v67, v67, v71
    v_add_f32 v87, v87, v91
    v_add_f32 v107, v107, v111
    v_add_f32 v64, v64, v72
    v_add_f32 v84, v84, v92
    v_add_f32 v104, v104, v112
    v_add_f32 v65, v65, v73
    v_add_f32 v85, v85, v93
    v_add_f32 v105, v105, v113
    v_add_f32 v66, v66, v74
    v_add_f32 v86, v86, v94
    v_add_f32 v106, v106, v114
    v_add_f32 v67, v67, v75
    v_add_f32 v87, v87, v95
    v_add_f32 v107, v107, v115
    v_add_f32 v64, v64, v76
    v_add_f32 v84, v84, v96
    v_add_f32 v104, v104, v116
    v_add_f32 v65, v65, v77
    v_add_f32 v85, v85, v97
    v_add_f32 v105, v105, v117
    v_add_f32 v66, v66, v78
    v_add_f32 v86, v86, v98
    v_add_f32 v106, v106, v118
    v_add_f32 v67, v67, v79
    v_add_f32 v87, v87, v99
    v_add_f32 v107, v107, v119
    v_add_f32 v64, v64, v80
    v_add_f32 v84, v84, v100
    v_add_f32 v104, v104, v120
    v_add_f32 v65, v65, v81
    s_waitcnt lgkmcnt(0)
    s_barrier
    v_add_f32 v85, v85, v101
    v_add_f32 v105, v105, v121
    v_add_f32 v66, v66, v82
    v_add_f32 v86, v86, v102
    v_add_f32 v106, v106, v122
    v_add_f32 v67, v67, v83
    v_add_f32 v87, v87, v103
    v_add_f32 v107, v107, v123
    s_nop 1
    v_permlane32_swap_b32 v64, v66
    v_permlane32_swap_b32 v65, v67
    v_permlane32_swap_b32 v84, v86
    v_permlane32_swap_b32 v85, v87
    v_permlane32_swap_b32 v104, v106
    v_permlane32_swap_b32 v105, v107
    s_nop 1
    v_add_f32 v64, v64, v66
    v_add_f32 v65, v65, v67
    v_add_f32 v88, v84, v86
    v_add_f32 v96, v85, v87
    v_add_f32 v108, v104, v106
    v_add_f32 v116, v105, v107
    v_mul_f32 v15, 0x3acccccd, v64
    v_and_b32 v92, s67, v88
    v_and_b32 v100, s67, v96
    v_mul_f32 v14, 0x3acccccd, v65
    v_and_b32 v112, s67, v108
    v_and_b32 v120, s67, v116
    v_fma_f32 v14, -v15, v15, v14
    v_sub_f32 v92, v88, v92
    v_sub_f32 v100, v96, v100
    v_max_f32 v14, 0, v14
    v_sub_f32 v112, v108, v112
    v_sub_f32 v120, v116, v120
    v_cvt_pk_bf16_f32 v12, v15, v14
    v_lshrrev_b32 v88, 16, v88
    v_lshrrev_b32 v96, 16, v96
    v_lshlrev_b32 v13, 16, v12
    v_lshrrev_b32 v108, 16, v108
    v_lshrrev_b32 v116, 16, v116
    v_and_b32 v14, s67, v12
    v_and_or_b32 v90, v92, s67, v88
    v_and_or_b32 v98, v100, s67, v96
    v_add_f32 v14, 0x3727c5ac, v14
    v_and_or_b32 v110, v112, s67, v108
    v_and_or_b32 v118, v120, s67, v116
    v_cvt_pk_bf16_f32 v14, v14, v14
    v_and_b32 v93, s67, v92
    v_and_b32 v101, s67, v100
    v_and_b32 v14, s67, v14
    v_and_b32 v113, s67, v112
    v_and_b32 v121, s67, v120
    v_sqrt_f32 v14, v14
    v_sub_f32 v93, v92, v93
    v_sub_f32 v101, v100, v101
    v_xor_b32 v12, 0x80000000, v13
    v_sub_f32 v113, v112, v113
    v_sub_f32 v121, v120, v121
    v_cvt_pk_bf16_f32 v14, v14, v14
    v_lshrrev_b32 v91, 16, v93
    v_lshrrev_b32 v99, 16, v101
    v_and_b32 v70, s67, v14
    v_lshrrev_b32 v111, 16, v113
    v_lshrrev_b32 v119, 16, v121
    v_rcp_f32 v69, v70
    v_lshrrev_b32 v14, 16, v12
    v_mul_f32 v71, 0x3fb8aa3b, v69
    v_or_b32 v68, v12, v14
    v_lshrrev_b32 v11, 5, v154
    v_mul_u32_u24 v11, 768, v11
    v_add_u32 v11, 156672, v11
    v_and_b32 v13, 31, v154
    v_lshl_add_u32 v12, v13, 2, v11
    v_lshl_add_u32 v11, v13, 4, v11
    ds_write_b128 v11, v[68:71]
    ds_write_b64 v155, v[90:91] offset:0
    ds_write_b64 v155, v[98:99] offset:8
    ds_write_b64 v157, v[110:111] offset:0
    ds_write_b64 v157, v[118:119] offset:8
    s_waitcnt lgkmcnt(0)
    s_barrier
    s_waitcnt lgkmcnt(0)
    s_barrier
    s_add_u32 m0, s64, 0
    s_nop 0
    buffer_load_dwordx4 v45, s[20:23], 0 offen lds
    s_add_u32 m0, s64, 1024
    s_nop 0
    buffer_load_dwordx4 v45, s[20:23], 0 offen lds
    s_add_u32 m0, s64, 2048
    s_nop 0
    buffer_load_dwordx4 v45, s[20:23], 0 offen lds
    s_add_u32 m0, s64, 3072
    s_nop 0
    buffer_load_dwordx4 v45, s[20:23], 0 offen lds
    s_add_u32 m0, s64, 4096
    s_nop 0
    buffer_load_dwordx4 v45, s[20:23], 0 offen lds
    s_waitcnt lgkmcnt(0)
    s_barrier
    s_add_u32 m0, s64, 5120
    s_nop 0
    buffer_load_dwordx4 v45, s[20:23], 0 offen lds
    s_add_u32 m0, s64, 6144
    s_nop 0
    buffer_load_dwordx4 v45, s[20:23], 0 offen lds
    s_add_u32 m0, s64, 7168
    s_nop 0
    buffer_load_dwordx4 v45, s[20:23], 0 offen lds
    s_add_u32 m0, s64, 8192
    s_nop 0
    buffer_load_dwordx4 v45, s[20:23], 0 offen lds
    s_add_u32 m0, s64, 9216
    s_nop 0
    buffer_load_dwordx4 v45, s[20:23], 0 offen lds
    s_waitcnt lgkmcnt(0)
    s_barrier
    s_waitcnt lgkmcnt(0)
    s_barrier
    s_waitcnt lgkmcnt(0)
    s_barrier
    s_waitcnt lgkmcnt(0)
    s_barrier
    buffer_load_dword v223, v48, s[20:23], 0 offen sc1
    buffer_load_dword v8, v47, s[20:23], 0 offen sc1
    s_waitcnt lgkmcnt(0)
    s_barrier
    s_waitcnt lgkmcnt(0)
    s_barrier
    s_waitcnt vmcnt(1)
    v_cmp_lt_u32 vcc, v223, v52
    s_mov_b32 s82, 0
    s_nop 3
    s_cbranch_vccz L_okSQ2
L_spSQ2:
    s_sleep 4
    buffer_load_dword v223, v48, s[20:23], 0 offen sc1
    s_waitcnt vmcnt(0)
    v_cmp_lt_u32 vcc, v223, v52
    s_add_u32 s82, s82, 1
    s_cmp_lt_u32 s82, 0x40000
    s_cselect_b64 s[94:95], -1, 0
    s_and_b64 vcc, vcc, s[94:95]
    s_cbranch_vccnz L_spSQ2
L_okSQ2:
    s_waitcnt vmcnt(0)
    v_cmp_lt_u32 vcc, v8, v54
    s_mov_b32 s82, 0
    s_nop 3
    s_cbranch_vccz L_okSQ3
L_spSQ3:
    s_sleep 4
    buffer_load_dword v8, v47, s[20:23], 0 offen sc1
    s_waitcnt vmcnt(0)
    v_cmp_lt_u32 vcc, v8, v54
    s_add_u32 s82, s82, 1
    s_cmp_lt_u32 s82, 0x40000
    s_cselect_b64 s[94:95], -1, 0
    s_and_b64 vcc, vcc, s[94:95]
    s_cbranch_vccnz L_spSQ3
L_okSQ3:
    s_mov_b32 s64, 0
    s_lshl_b32 s75, s38, 13
    s_add_u32 s75, s75, 12582912
    s_lshl_b32 s39, s49, 2
    s_add_u32 s39, s39, 152960
    v_mov_b32 v221, s39
    buffer_load_dword v220, v50, s[20:23], 0 offen sc1
    s_waitcnt lgkmcnt(0)
    s_barrier
    s_cmp_eq_u32 s64, 2
    s_cbranch_scc1 L_kvd18
    s_getpc_b64 s[60:61]
L_kvr18:
    s_add_u32 s60, s60, L_kvd18-L_kvr18
    s_addc_u32 s61, s61, 0
    s_cmp_eq_u32 s64, 1
    s_cbranch_scc1 L_kvbuild
    s_branch L_kvpoll
L_kvd18:
    s_waitcnt lgkmcnt(0)
    s_barrier
    s_cmp_eq_u32 s64, 2
    s_cbranch_scc1 L_kvd19
    s_getpc_b64 s[60:61]
L_kvr19:
    s_add_u32 s60, s60, L_kvd19-L_kvr19
    s_addc_u32 s61, s61, 0
    s_cmp_eq_u32 s64, 1
    s_cbranch_scc1 L_kvbuild
    s_branch L_kvpoll
L_kvd19:
    s_waitcnt lgkmcnt(0)
    s_barrier
    s_cmp_eq_u32 s64, 2
    s_cbranch_scc1 L_kvd20
    s_getpc_b64 s[60:61]
L_kvr20:
    s_add_u32 s60, s60, L_kvd20-L_kvr20
    s_addc_u32 s61, s61, 0
    s_cmp_eq_u32 s64, 1
    s_cbranch_scc1 L_kvbuild
    s_branch L_kvpoll
L_kvd20:
    s_waitcnt lgkmcnt(0)
    s_barrier
    s_cmp_eq_u32 s64, 2
    s_cbranch_scc1 L_kvd21
    s_getpc_b64 s[60:61]
L_kvr21:
    s_add_u32 s60, s60, L_kvd21-L_kvr21
    s_addc_u32 s61, s61, 0
    s_cmp_eq_u32 s64, 1
    s_cbranch_scc1 L_kvbuild
    s_branch L_kvpoll
L_kvd21:
    s_waitcnt lgkmcnt(0)
    s_barrier
    s_cmp_eq_u32 s64, 2
    s_cbranch_scc1 L_kvd22
    s_getpc_b64 s[60:61]
L_kvr22:
    s_add_u32 s60, s60, L_kvd22-L_kvr22
    s_addc_u32 s61, s61, 0
    s_cmp_eq_u32 s64, 1
    s_cbranch_scc1 L_kvbuild
    s_branch L_kvpoll
L_kvd22:
    s_waitcnt lgkmcnt(0)
    s_barrier
    s_cmp_eq_u32 s64, 2
    s_cbranch_scc1 L_kvd23
    s_getpc_b64 s[60:61]
L_kvr23:
    s_add_u32 s60, s60, L_kvd23-L_kvr23
    s_addc_u32 s61, s61, 0
    s_cmp_eq_u32 s64, 1
    s_cbranch_scc1 L_kvbuild
    s_branch L_kvpoll
L_kvd23:
    s_waitcnt lgkmcnt(0)
    s_barrier
    s_cmp_eq_u32 s64, 2
    s_cbranch_scc1 L_kvd24
    s_getpc_b64 s[60:61]
L_kvr24:
    s_add_u32 s60, s60, L_kvd24-L_kvr24
    s_addc_u32 s61, s61, 0
    s_cmp_eq_u32 s64, 1
    s_cbranch_scc1 L_kvbuild
    s_branch L_kvpoll
L_kvd24:
    s_waitcnt lgkmcnt(0)
    s_barrier
    s_cmp_eq_u32 s64, 2
    s_cbranch_scc1 L_kvd25
    s_getpc_b64 s[60:61]
L_kvr25:
    s_add_u32 s60, s60, L_kvd25-L_kvr25
    s_addc_u32 s61, s61, 0
    s_cmp_eq_u32 s64, 1
    s_cbranch_scc1 L_kvbuild
    s_branch L_kvpoll
L_kvd25:
    buffer_load_dword v8, v48, s[20:23], 0 offen sc1
    s_waitcnt lgkmcnt(0)
    s_barrier
    s_waitcnt vmcnt(0)
    s_waitcnt vmcnt(0)
    v_cmp_lt_u32 vcc, v8, v53
    s_mov_b32 s82, 0
    s_nop 3
    s_cbranch_vccz L_okSQ4
L_spSQ4:
    s_sleep 4
    buffer_load_dword v8, v48, s[20:23], 0 offen sc1
    s_waitcnt vmcnt(0)
    v_cmp_lt_u32 vcc, v8, v53
    s_add_u32 s82, s82, 1
    s_cmp_lt_u32 s82, 0x40000
    s_cselect_b64 s[94:95], -1, 0
    s_and_b64 vcc, vcc, s[94:95]
    s_cbranch_vccnz L_spSQ4
L_okSQ4:
    s_cmp_eq_u32 s64, 2
    s_cbranch_scc1 L_kvd26
    s_getpc_b64 s[60:61]
L_kvr26:
    s_add_u32 s60, s60, L_kvd26-L_kvr26
    s_addc_u32 s61, s61, 0
    s_cmp_eq_u32 s64, 1
    s_cbranch_scc1 L_kvbuild
    s_branch L_kvpoll
L_kvd26:
    s_waitcnt lgkmcnt(0)
    s_barrier
    s_cmp_eq_u32 s64, 2
    s_cbranch_scc1 L_kvd27
    s_getpc_b64 s[60:61]
L_kvr27:
    s_add_u32 s60, s60, L_kvd27-L_kvr27
    s_addc_u32 s61, s61, 0
    s_cmp_eq_u32 s64, 1
    s_cbranch_scc1 L_kvbuild
    s_branch L_kvpoll
L_kvd27:
    s_waitcnt lgkmcnt(0)
    s_barrier
    s_cmp_eq_u32 s64, 2
    s_cbranch_scc1 L_kvd28
    s_getpc_b64 s[60:61]
L_kvr28:
    s_add_u32 s60, s60, L_kvd28-L_kvr28
    s_addc_u32 s61, s61, 0
    s_cmp_eq_u32 s64, 1
    s_cbranch_scc1 L_kvbuild
    s_branch L_kvpoll
L_kvd28:
    s_waitcnt lgkmcnt(0)
    s_barrier
    s_cmp_eq_u32 s64, 2
    s_cbranch_scc1 L_kvd29
    s_getpc_b64 s[60:61]
L_kvr29:
    s_add_u32 s60, s60, L_kvd29-L_kvr29
    s_addc_u32 s61, s61, 0
    s_cmp_eq_u32 s64, 1
    s_cbranch_scc1 L_kvbuild
    s_waitcnt vmcnt(0)
    s_waitcnt vmcnt(0)
    v_cmp_lt_u32 vcc, v220, v44
    s_mov_b32 s82, 0
    s_nop 3
    s_cbranch_vccz L_okSQ5
L_spSQ5:
    s_sleep 4
    buffer_load_dword v220, v50, s[20:23], 0 offen sc1
    s_waitcnt vmcnt(0)
    v_cmp_lt_u32 vcc, v220, v44
    s_add_u32 s82, s82, 1
    s_cmp_lt_u32 s82, 0x40000
    s_cselect_b64 s[94:95], -1, 0
    s_and_b64 vcc, vcc, s[94:95]
    s_cbranch_vccnz L_spSQ5
L_okSQ5:
    buffer_load_dwordx4 v[64:67], v168, s[20:23], s75 offen sc1
    buffer_load_dwordx4 v[68:71], v169, s[20:23], s75 offen sc1
    buffer_load_dwordx4 v[72:75], v170, s[20:23], s75 offen sc1
    buffer_load_dwordx4 v[76:79], v171, s[20:23], s75 offen sc1
    s_branch L_kvbuild
L_kvd29:
    buffer_load_dword v8, v48, s[20:23], 0 offen sc1
    s_waitcnt lgkmcnt(0)
    s_barrier
    s_waitcnt vmcnt(0)
    s_waitcnt vmcnt(0)
    v_cmp_lt_u32 vcc, v8, v49
    s_mov_b32 s82, 0
    s_nop 3
    s_cbranch_vccz L_okSQ6
L_spSQ6:
    s_sleep 4
    buffer_load_dword v8, v48, s[20:23], 0 offen sc1
    s_waitcnt vmcnt(0)
    v_cmp_lt_u32 vcc, v8, v49
    s_add_u32 s82, s82, 1
    s_cmp_lt_u32 s82, 0x40000
    s_cselect_b64 s[94:95], -1, 0
    s_and_b64 vcc, vcc, s[94:95]
    s_cbranch_vccnz L_spSQ6
L_okSQ6:
    s_waitcnt lgkmcnt(0)
    s_barrier
    s_waitcnt lgkmcnt(0)
    s_barrier
    s_waitcnt lgkmcnt(0)
    s_barrier
    s_waitcnt lgkmcnt(0)
    s_barrier
    s_waitcnt lgkmcnt(0)
    s_barrier
    s_waitcnt lgkmcnt(0)
    s_barrier
    s_waitcnt lgkmcnt(0)
    s_barrier
    s_endpgm
L_kvpoll:
    s_waitcnt vmcnt(0)
    v_cmp_lt_u32 vcc, v220, v44
    s_nop 4
    s_cbranch_vccz L_kvgo
    buffer_load_dword v220, v50, s[20:23], 0 offen sc1
    s_setpc_b64 s[60:61]
L_kvgo:
    buffer_load_dwordx4 v[64:67], v168, s[20:23], s75 offen sc1
    buffer_load_dwordx4 v[68:71], v169, s[20:23], s75 offen sc1
    buffer_load_dwordx4 v[72:75], v170, s[20:23], s75 offen sc1
    buffer_load_dwordx4 v[76:79], v171, s[20:23], s75 offen sc1
    s_mov_b32 s64, 1
    s_setpc_b64 s[60:61]
L_kvbuild:
    s_mov_b32 s64, 2
    s_waitcnt vmcnt(0)
    v_cvt_pk_bf16_f32 v80, v64, v65
    v_cvt_pk_bf16_f32 v81, v66, v67
    ds_write_b64 v160, v[80:81]
    ds_write_b64 v161, v[80:81]
    v_cvt_pk_bf16_f32 v82, v68, v69
    v_cvt_pk_bf16_f32 v83, v70, v71
    ds_write_b64 v162, v[82:83]
    ds_write_b64 v163, v[82:83]
    v_cvt_pk_bf16_f32 v84, v72, v73
    v_cvt_pk_bf16_f32 v85, v74, v75
    ds_write_b64 v164, v[84:85]
    ds_write_b64 v165, v[84:85]
    v_cvt_pk_bf16_f32 v86, v76, v77
    v_cvt_pk_bf16_f32 v87, v78, v79
    ds_write_b64 v166, v[86:87]
    ds_write_b64 v167, v[86:87]
    ds_write_b32 v221, v46
    s_setpc_b64 s[60:61]
L_SQ_end:
L_exit:
    s_endpgm

.section .rodata,"a"
.p2align 6
.amdhsa_kernel parallel_sum__linear_attn_block__dense_activation_relu__prompt_kernel
  .amdhsa_next_free_vgpr 256
  .amdhsa_next_free_sgpr 102
  .amdhsa_accum_offset 256
  .amdhsa_group_segment_fixed_size 0
  .amdhsa_kernarg_size 72
  .amdhsa_user_sgpr_count 2
  .amdhsa_user_sgpr_kernarg_segment_ptr 1
  .amdhsa_system_sgpr_workgroup_id_x 1
.end_amdhsa_kernel
```
